```python
import torch

def _softmax(x, axis=-1):
    return torch.softmax(x, dim=axis)
def _gelu(x):
    return torch.nn.functional.gelu(x, approximate="tanh")
def _silu(x):
    return torch.nn.functional.silu(x)
def _sigmoid(x):
    return torch.sigmoid(x)
def _layernorm(x, axis=-1, eps=1e-5):
    m = x.mean(dim=axis, keepdim=True)
    v = x.var(dim=axis, keepdim=True, unbiased=False)
    return (x - m) / torch.sqrt(v + eps)
def _scatter_add(tgt, idx, src, axis=0):
    return tgt.clone().index_add_(axis, idx, src)
def _segment_sum(src, seg, n):
    out = torch.zeros((n,) + src.shape[1:], dtype=src.dtype)
    return out.index_add_(0, seg, src)
def _pad(x, pw):
    flat = tuple(v for pair in reversed(pw) for v in pair)
    return torch.nn.functional.pad(x, flat)

kernel_name = 'standalone__gqa_block_cached__near_ridge'

def setup_inputs():

    _w = (lambda a: (lambda t: t.to(torch.bfloat16) if t.is_floating_point() else t)(torch.as_tensor(a)))
    B, Sq, D = 16, 128, 640
    Hq, Hkv, Sk, Dh = 32, 32, 1024, 128
    assert Hq % Hkv == 0, (Hq, Hkv)
    return {
        "x": _w((lambda *s: torch.randn(*s, dtype=torch.bfloat16) * 0.8)(B, Sq, D)),
        "k_cache": _w((lambda *s: torch.randn(*s, dtype=torch.bfloat16) * 0.8)(B, Hkv, Sk, Dh)),
        "v_cache": _w((lambda *s: torch.randn(*s, dtype=torch.bfloat16) * 0.05)(B, Hkv, Sk, Dh)),
        "wq": _w((lambda *s: torch.randn(*s, dtype=torch.bfloat16) * 0.8)(D, Hq * Dh) * (D ** -0.5)),
        "wo": _w((lambda *s: torch.randn(*s, dtype=torch.bfloat16) * 0.05)(Hq * Dh, D) * ((Hq * Dh) ** -0.5)),
    }

def reference(x, k_cache, v_cache, wq, wo):
    B, Sq, D = x.shape
    Hq, Dh = 32, 128
    Hkv = k_cache.shape[1]
    rep = Hq // Hkv
    q = (lambda x, *d: x.permute(*d))((x @ wq).reshape(B, Sq, Hq, Dh), 0, 2, 1, 3)
    k = (lambda x, n, axis: torch.repeat_interleave(x, n, dim=axis))(k_cache, rep, axis=1)
    v = (lambda x, n, axis: torch.repeat_interleave(x, n, dim=axis))(v_cache, rep, axis=1)
    scores = torch.einsum("bhqd,bhkd->bhqk", q, k) * (Dh ** -0.5)
    p = _softmax(scores, axis=-1)
    o = torch.einsum("bhqk,bhkd->bhqd", p, v)
    return (lambda x, *d: x.permute(*d))(o, 0, 2, 1, 3).reshape(B, Sq, Hq * Dh) @ wo
```

```asm
; @launch grid=(256,1,1) block=(512,1,1) lds=163840
.amdgcn_target "amdgcn-amd-amdhsa--gfx950"
.text
.globl standalone__gqa_block_cached__near_ridge_kernel
.p2align 8
.type standalone__gqa_block_cached__near_ridge_kernel,@function
standalone__gqa_block_cached__near_ridge_kernel:
    s_cmp_ge_u32 s2, 256
    s_cbranch_scc1 L_end
    s_load_dwordx16 s[64:79], s[0:1], 0
    v_lshrrev_b32 v14, 6, v0
    v_and_b32 v11, 63, v0
    v_readfirstlane_b32 s36, v14
    v_lshrrev_b32 v12, 4, v11
    v_and_b32 v13, 15, v11
    s_and_b32 s51, s2, 7
    s_lshr_b32 s52, s2, 3
    s_and_b32 s60, s51, 1
    s_lshl_b32 s60, s60, 3
    s_lshr_b32 s87, s52, 2
    s_add_u32 s38, s60, s87
    s_and_b32 s62, s52, 3
    s_mul_i32 s56, s62, 5
    s_lshr_b32 s56, s56, 1
    s_add_u32 s56, s56, s87
    s_sub_u32 s57, s56, 10
    s_cmp_ge_u32 s56, 10
    s_cselect_b32 s56, s57, s56
    s_add_u32 s56, s87, s62
    s_and_b32 s56, s56, 3
    s_lshl_b32 s57, s56, 1
    s_and_b32 s61, s51, 6
    s_lshl_b32 s39, s61, 2
    s_add_u32 s39, s39, s62
    s_and_b32 s37, s36, 3
    s_and_b32 s40, s36, 4
    s_add_u32 s54, s39, s40
    s_lshl_b32 s55, s39, 8
    s_mul_i32 s42, s38, 163840
    s_lshl_b32 s92, s37, 12
    s_add_u32 s92, s92, 98304
    s_lshl_b32 s93, s37, 11
    s_add_u32 s93, s93, 131072
    s_lshl_b32 s51, s37, 3
    v_add_u32 v14, s51, v12
    s_and_b32 s51, s51, 8
    v_lshl_add_u32 v15, v12, 1, s51
    v_xor_b32 v15, v15, v13
    v_lshlrev_b32 v15, 4, v15
    v_lshl_add_u32 v7, v14, 13, v15
    v_add_u32 v8, 31744, v7
    s_lshl_b32 s51, s37, 5
    v_lshrrev_b32 v14, 3, v11
    v_add_u32 v14, s51, v14
    v_mul_u32_u24 v14, 1280, v14
    v_and_b32 v15, 7, v11
    v_xor_b32 v15, v15, v12
    v_lshl_add_u32 v9, v15, 4, v14
    v_xor_b32 v10, 64, v9
    v_add_u32 v10, 9216, v10
    s_cmp_eq_u32 s40, 0
    s_cbranch_scc1 L_proA
    s_waitcnt lgkmcnt(0)
    s_mov_b32 s4, s64
    s_mov_b32 s5, s65
    s_mov_b32 s6, 2621440
    s_mov_b32 s7, 0x20000
    s_mov_b32 s8, s70
    s_mov_b32 s9, s71
    s_mov_b32 s10, 5242880
    s_mov_b32 s11, 0x20000
    s_lshl_b32 s52, s56, 7
    s_add_u32 s52, s52, s42
    s_add_u32 m0, s92, 0
    s_nop 0
    buffer_load_dwordx4 v9, s[4:7], s52 offen offset:0 lds
    buffer_load_dwordx4 v10, s[4:7], s52 offen offset:1024 lds
    s_lshl_b32 s52, s56, 7
    s_add_u32 s52, s52, s42
    s_add_u32 s52, s52, 20480
    s_add_u32 m0, s92, 2048
    s_nop 0
    buffer_load_dwordx4 v9, s[4:7], s52 offen offset:0 lds
    buffer_load_dwordx4 v10, s[4:7], s52 offen offset:1024 lds
    s_add_u32 s56, s56, 1
    s_cmp_eq_u32 s56, 10
    s_cselect_b32 s56, 0, s56
    s_lshl_b32 s52, s57, 18
    s_add_u32 s52, s52, s55
    s_add_u32 m0, s93, 0
    s_nop 0
    buffer_load_dwordx4 v7, s[8:11], s52 offen offset:0 lds
    buffer_load_dwordx4 v8, s[8:11], s52 offen offset:1024 lds
    s_add_u32 s57, s57, 1
    s_cmp_eq_u32 s57, 20
    s_cselect_b32 s57, 0, s57
    s_lshl_b32 s52, s57, 18
    s_add_u32 s52, s52, s55
    s_add_u32 m0, s93, 8192
    s_nop 0
    buffer_load_dwordx4 v7, s[8:11], s52 offen offset:0 lds
    buffer_load_dwordx4 v8, s[8:11], s52 offen offset:1024 lds
    s_add_u32 s57, s57, 1
    s_cmp_eq_u32 s57, 20
    s_cselect_b32 s57, 0, s57
    s_lshr_b32 s59, s61, 1
    s_lshl_b32 s85, s38, 2
    s_add_u32 s87, s85, s62
    s_add_u32 s85, s85, s59
    s_mul_i32 s85, s85, 1280
    s_lshl_b32 s98, s62, 4
    s_add_u32 s85, s85, s98
    s_add_u32 s85, s85, 41943040
    s_lshl_b32 s87, s87, 2
    s_add_u32 s98, s59, 1
    s_and_b32 s98, s98, 3
    s_add_u32 s98, s98, s87
    s_mul_i32 s98, s98, 1280
    s_add_u32 s98, s98, 42106880
    s_add_u32 s99, s59, 2
    s_and_b32 s99, s99, 3
    s_add_u32 s99, s99, s87
    s_mul_i32 s99, s99, 1280
    s_add_u32 s99, s99, 42106896
    s_add_u32 s100, s59, 3
    s_and_b32 s100, s100, 3
    s_add_u32 s100, s100, s87
    s_mul_i32 s100, s100, 1280
    s_add_u32 s100, s100, 42106912
    s_mov_b32 s12, s66
    s_mov_b32 s13, s67
    s_mov_b32 s14, 134217728
    s_mov_b32 s15, 0x20000
    s_mov_b32 s16, s68
    s_mov_b32 s17, s69
    s_mov_b32 s18, 134217728
    s_mov_b32 s19, 0x20000
    s_mov_b32 s24, s72
    s_mov_b32 s25, s73
    s_mov_b32 s26, 5242880
    s_mov_b32 s27, 0x20000
    s_mov_b32 s28, s74
    s_mov_b32 s29, s75
    s_mov_b32 s30, 2621440
    s_mov_b32 s31, 0x20000
    s_mov_b32 s32, s76
    s_mov_b32 s33, s77
    s_mov_b32 s34, 256
    s_mov_b32 s35, 0x20000
    s_mov_b32 s20, s78
    s_mov_b32 s21, s79
    s_mov_b32 s22, 67108864
    s_mov_b32 s23, 0x20000
    s_cmp_eq_u32 s36, 4
    s_cbranch_scc0 L_clr
    v_mov_b32 v112, 0
    v_mov_b32 v113, 0
    v_mov_b32 v114, 0
    v_mov_b32 v115, 0
    s_mov_b64 s[90:91], exec
    s_mov_b64 exec, 1
    s_add_u32 s51, s85, 81920
    buffer_store_dwordx4 v[112:115], v112, s[20:23], s85 offen sc1
    buffer_store_dwordx4 v[112:115], v112, s[20:23], s51 offen sc1
    buffer_store_dwordx4 v[112:115], v112, s[20:23], s98 offen sc1
    buffer_store_dwordx4 v[112:115], v112, s[20:23], s99 offen sc1
    buffer_store_dwordx4 v[112:115], v112, s[20:23], s100 offen sc1
    s_mov_b64 exec, s[90:91]
L_clr:
    s_lshl_b32 s87, s37, 2
    s_add_u32 s85, s85, s87
    s_add_u32 s98, s98, s87
    s_add_u32 s99, s99, s87
    s_add_u32 s100, s100, s87
    s_bfe_u32 s86, s2, 0x30003
    s_add_u32 s86, s86, 1
    s_mov_b32 s41, 0
    s_lshl_b32 s45, s37, 12
    s_lshl_b32 s43, s38, 5
    s_add_u32 s43, s43, s39
    s_lshl_b32 s43, s43, 18
    s_add_u32 s44, s43, 1048576
    s_lshl_b32 s51, s37, 4
    v_add_u32 v14, s51, v12
    v_lshlrev_b32 v15, 1, v12
    v_xor_b32 v15, v15, v13
    v_lshlrev_b32 v15, 4, v15
    v_lshl_add_u32 v5, v14, 8, v15
    v_xor_b32 v6, 128, v5
    v_xor_b32 v15, v12, v13
    v_lshlrev_b32 v15, 4, v15
    v_lshl_add_u32 v1, v14, 8, v15
    v_xor_b32 v2, 64, v1
    v_xor_b32 v3, 128, v1
    v_xor_b32 v4, 192, v1
    s_lshl_b32 s45, s37, 12
    v_bfe_u32 v15, v11, 2, 2
    v_lshl_add_u32 v14, v12, 3, v15
    v_lshlrev_b32 v14, 8, v14
    v_bfe_u32 v15, v11, 2, 3
    v_lshl_add_u32 v14, v15, 5, v14
    v_and_b32 v15, 3, v11
    v_lshl_add_u32 v14, v15, 3, v14
    v_add_u32 v244, 131072, v14
    v_xor_b32 v245, 32, v244
    v_xor_b32 v246, 64, v244
    v_xor_b32 v247, 96, v244
    v_xor_b32 v248, 128, v244
    v_xor_b32 v249, 160, v244
    v_xor_b32 v250, 192, v244
    v_xor_b32 v251, 224, v244
    v_lshrrev_b32 v14, 1, v13
    v_xor_b32 v14, v14, v12
    v_lshlrev_b32 v14, 4, v14
    v_lshl_add_u32 v14, v13, 7, v14
    s_add_u32 s51, s45, 98304
    v_add_u32 v252, s51, v14
    v_xor_b32 v253, 64, v252
    s_lshl_b32 s52, s57, 18
    s_add_u32 s52, s52, s55
    s_add_u32 m0, s93, 16384
    s_nop 0
    buffer_load_dwordx4 v7, s[8:11], s52 offen offset:0 lds
    buffer_load_dwordx4 v8, s[8:11], s52 offen offset:1024 lds
    s_add_u32 s57, s57, 1
    s_cmp_eq_u32 s57, 20
    s_cselect_b32 s57, 0, s57
    s_lshl_b32 s52, s56, 7
    s_add_u32 s52, s52, s42
    s_add_u32 m0, s92, 16384
    s_nop 0
    buffer_load_dwordx4 v9, s[4:7], s52 offen offset:0 lds
    buffer_load_dwordx4 v10, s[4:7], s52 offen offset:1024 lds
    s_lshl_b32 s52, s56, 7
    s_add_u32 s52, s52, s42
    s_add_u32 s52, s52, 20480
    s_add_u32 m0, s92, 18432
    s_nop 0
    buffer_load_dwordx4 v9, s[4:7], s52 offen offset:0 lds
    buffer_load_dwordx4 v10, s[4:7], s52 offen offset:1024 lds
    s_add_u32 s56, s56, 1
    s_cmp_eq_u32 s56, 10
    s_cselect_b32 s56, 0, s56
    s_lshl_b32 s52, s57, 18
    s_add_u32 s52, s52, s55
    s_add_u32 m0, s93, 24576
    s_nop 0
    buffer_load_dwordx4 v7, s[8:11], s52 offen offset:0 lds
    buffer_load_dwordx4 v8, s[8:11], s52 offen offset:1024 lds
    s_add_u32 s57, s57, 1
    s_cmp_eq_u32 s57, 20
    s_cselect_b32 s57, 0, s57
    s_waitcnt vmcnt(10)
    s_barrier
    ds_read_b128 v[112:115], v252 offset:0
    ds_read_b128 v[116:119], v252 offset:2048
    ds_read_b128 v[120:123], v253 offset:0
    ds_read_b128 v[124:127], v253 offset:2048
    s_waitcnt lgkmcnt(0)
    s_waitcnt vmcnt(8)
    s_barrier
    s_lshl_b32 s52, s57, 18
    s_add_u32 s52, s52, s55
    s_add_u32 m0, s93, 0
    s_nop 0
    buffer_load_dwordx4 v7, s[8:11], s52 offen offset:0 lds
    buffer_load_dwordx4 v8, s[8:11], s52 offen offset:1024 lds
    s_add_u32 s57, s57, 1
    s_cmp_eq_u32 s57, 20
    s_cselect_b32 s57, 0, s57
    s_lshl_b32 s52, s56, 7
    s_add_u32 s52, s52, s42
    s_add_u32 m0, s92, 0
    s_nop 0
    buffer_load_dwordx4 v9, s[4:7], s52 offen offset:0 lds
    buffer_load_dwordx4 v10, s[4:7], s52 offen offset:1024 lds
    s_lshl_b32 s52, s56, 7
    s_add_u32 s52, s52, s42
    s_add_u32 s52, s52, 20480
    s_add_u32 m0, s92, 2048
    s_nop 0
    buffer_load_dwordx4 v9, s[4:7], s52 offen offset:0 lds
    buffer_load_dwordx4 v10, s[4:7], s52 offen offset:1024 lds
    s_add_u32 s56, s56, 1
    s_cmp_eq_u32 s56, 10
    s_cselect_b32 s56, 0, s56
    s_waitcnt vmcnt(8)
    s_barrier
    ds_read_b128 v[128:131], v252 offset:16384
    ds_read_b128 v[132:135], v252 offset:18432
    ds_read_b128 v[136:139], v253 offset:16384
    ds_read_b128 v[140:143], v253 offset:18432
    s_lshl_b32 s52, s57, 18
    s_add_u32 s52, s52, s55
    s_add_u32 m0, s93, 8192
    s_nop 0
    buffer_load_dwordx4 v7, s[8:11], s52 offen offset:0 lds
    buffer_load_dwordx4 v8, s[8:11], s52 offen offset:1024 lds
    s_add_u32 s57, s57, 1
    s_cmp_eq_u32 s57, 20
    s_cselect_b32 s57, 0, s57
    s_waitcnt lgkmcnt(0)
    s_waitcnt vmcnt(8)
    s_barrier
    s_lshl_b32 s52, s57, 18
    s_add_u32 s52, s52, s55
    s_add_u32 m0, s93, 16384
    s_nop 0
    buffer_load_dwordx4 v7, s[8:11], s52 offen offset:0 lds
    buffer_load_dwordx4 v8, s[8:11], s52 offen offset:1024 lds
    s_add_u32 s57, s57, 1
    s_cmp_eq_u32 s57, 20
    s_cselect_b32 s57, 0, s57
    s_lshl_b32 s52, s56, 7
    s_add_u32 s52, s52, s42
    s_add_u32 m0, s92, 16384
    s_nop 0
    buffer_load_dwordx4 v9, s[4:7], s52 offen offset:0 lds
    buffer_load_dwordx4 v10, s[4:7], s52 offen offset:1024 lds
    s_lshl_b32 s52, s56, 7
    s_add_u32 s52, s52, s42
    s_add_u32 s52, s52, 20480
    s_add_u32 m0, s92, 18432
    s_nop 0
    buffer_load_dwordx4 v9, s[4:7], s52 offen offset:0 lds
    buffer_load_dwordx4 v10, s[4:7], s52 offen offset:1024 lds
    s_add_u32 s56, s56, 1
    s_cmp_eq_u32 s56, 10
    s_cselect_b32 s56, 0, s56
    s_add_u32 s51, s41, 0
    s_and_b32 s51, s51, 15
    s_lshl_b32 s51, s51, 14
    s_add_u32 s51, s51, s43
    s_add_u32 m0, s45, 0
    s_nop 0
    buffer_load_dwordx4 v1, s[12:15], s51 offen offset:0 nt lds
    s_waitcnt vmcnt(9)
    s_barrier
    ds_read_b128 v[144:147], v252 offset:0
    ds_read_b128 v[148:151], v252 offset:2048
    ds_read_b128 v[152:155], v253 offset:0
    ds_read_b128 v[156:159], v253 offset:2048
    s_lshl_b32 s52, s57, 18
    s_add_u32 s52, s52, s55
    s_add_u32 m0, s93, 24576
    s_nop 0
    buffer_load_dwordx4 v7, s[8:11], s52 offen offset:0 lds
    buffer_load_dwordx4 v8, s[8:11], s52 offen offset:1024 lds
    s_add_u32 s57, s57, 1
    s_cmp_eq_u32 s57, 20
    s_cselect_b32 s57, 0, s57
    s_waitcnt lgkmcnt(0)
    s_waitcnt vmcnt(9)
    s_barrier
    s_lshl_b32 s52, s57, 18
    s_add_u32 s52, s52, s55
    s_add_u32 m0, s93, 0
    s_nop 0
    buffer_load_dwordx4 v7, s[8:11], s52 offen offset:0 lds
    buffer_load_dwordx4 v8, s[8:11], s52 offen offset:1024 lds
    s_add_u32 s57, s57, 1
    s_cmp_eq_u32 s57, 20
    s_cselect_b32 s57, 0, s57
    s_lshl_b32 s52, s56, 7
    s_add_u32 s52, s52, s42
    s_add_u32 m0, s92, 0
    s_nop 0
    buffer_load_dwordx4 v9, s[4:7], s52 offen offset:0 lds
    buffer_load_dwordx4 v10, s[4:7], s52 offen offset:1024 lds
    s_lshl_b32 s52, s56, 7
    s_add_u32 s52, s52, s42
    s_add_u32 s52, s52, 20480
    s_add_u32 m0, s92, 2048
    s_nop 0
    buffer_load_dwordx4 v9, s[4:7], s52 offen offset:0 lds
    buffer_load_dwordx4 v10, s[4:7], s52 offen offset:1024 lds
    s_add_u32 s56, s56, 1
    s_cmp_eq_u32 s56, 10
    s_cselect_b32 s56, 0, s56
    s_add_u32 s51, s41, 0
    s_and_b32 s51, s51, 15
    s_lshl_b32 s51, s51, 14
    s_add_u32 s51, s51, s43
    s_add_u32 m0, s45, 0
    s_nop 0
    buffer_load_dwordx4 v2, s[12:15], s51 offen offset:1024 nt lds
    s_waitcnt vmcnt(10)
    s_barrier
    ds_read_b128 v[160:163], v252 offset:16384
    ds_read_b128 v[164:167], v252 offset:18432
    ds_read_b128 v[168:171], v253 offset:16384
    ds_read_b128 v[172:175], v253 offset:18432
    s_lshl_b32 s52, s57, 18
    s_add_u32 s52, s52, s55
    s_add_u32 m0, s93, 8192
    s_nop 0
    buffer_load_dwordx4 v7, s[8:11], s52 offen offset:0 lds
    buffer_load_dwordx4 v8, s[8:11], s52 offen offset:1024 lds
    s_add_u32 s57, s57, 1
    s_cmp_eq_u32 s57, 20
    s_cselect_b32 s57, 0, s57
    s_waitcnt lgkmcnt(0)
    s_waitcnt vmcnt(9)
    s_barrier
    s_lshl_b32 s52, s57, 18
    s_add_u32 s52, s52, s55
    s_add_u32 m0, s93, 16384
    s_nop 0
    buffer_load_dwordx4 v7, s[8:11], s52 offen offset:0 lds
    buffer_load_dwordx4 v8, s[8:11], s52 offen offset:1024 lds
    s_add_u32 s57, s57, 1
    s_cmp_eq_u32 s57, 20
    s_cselect_b32 s57, 0, s57
    s_lshl_b32 s52, s56, 7
    s_add_u32 s52, s52, s42
    s_add_u32 m0, s92, 16384
    s_nop 0
    buffer_load_dwordx4 v9, s[4:7], s52 offen offset:0 lds
    buffer_load_dwordx4 v10, s[4:7], s52 offen offset:1024 lds
    s_lshl_b32 s52, s56, 7
    s_add_u32 s52, s52, s42
    s_add_u32 s52, s52, 20480
    s_add_u32 m0, s92, 18432
    s_nop 0
    buffer_load_dwordx4 v9, s[4:7], s52 offen offset:0 lds
    buffer_load_dwordx4 v10, s[4:7], s52 offen offset:1024 lds
    s_add_u32 s56, s56, 1
    s_cmp_eq_u32 s56, 10
    s_cselect_b32 s56, 0, s56
    s_add_u32 s51, s41, 0
    s_and_b32 s51, s51, 15
    s_lshl_b32 s51, s51, 14
    s_add_u32 s51, s51, s43
    s_add_u32 m0, s45, 0
    s_nop 0
    buffer_load_dwordx4 v3, s[12:15], s51 offen offset:2048 nt lds
    s_waitcnt vmcnt(10)
    s_barrier
    ds_read_b128 v[176:179], v252 offset:0
    ds_read_b128 v[180:183], v252 offset:2048
    ds_read_b128 v[184:187], v253 offset:0
    ds_read_b128 v[188:191], v253 offset:2048
    s_lshl_b32 s52, s57, 18
    s_add_u32 s52, s52, s55
    s_add_u32 m0, s93, 24576
    s_nop 0
    buffer_load_dwordx4 v7, s[8:11], s52 offen offset:0 lds
    buffer_load_dwordx4 v8, s[8:11], s52 offen offset:1024 lds
    s_add_u32 s57, s57, 1
    s_cmp_eq_u32 s57, 20
    s_cselect_b32 s57, 0, s57
    s_add_u32 s51, s41, 0
    s_and_b32 s51, s51, 15
    s_lshl_b32 s51, s51, 14
    s_add_u32 s51, s51, s43
    s_add_u32 m0, s45, 0
    s_nop 0
    buffer_load_dwordx4 v4, s[12:15], s51 offen offset:3072 nt lds
    s_waitcnt lgkmcnt(0)
    s_waitcnt vmcnt(10)
    s_barrier
    s_lshl_b32 s52, s57, 18
    s_add_u32 s52, s52, s55
    s_add_u32 m0, s93, 0
    s_nop 0
    buffer_load_dwordx4 v7, s[8:11], s52 offen offset:0 lds
    buffer_load_dwordx4 v8, s[8:11], s52 offen offset:1024 lds
    s_add_u32 s57, s57, 1
    s_cmp_eq_u32 s57, 20
    s_cselect_b32 s57, 0, s57
    s_lshl_b32 s52, s56, 7
    s_add_u32 s52, s52, s42
    s_add_u32 m0, s92, 0
    s_nop 0
    buffer_load_dwordx4 v9, s[4:7], s52 offen offset:0 lds
    buffer_load_dwordx4 v10, s[4:7], s52 offen offset:1024 lds
    s_lshl_b32 s52, s56, 7
    s_add_u32 s52, s52, s42
    s_add_u32 s52, s52, 20480
    s_add_u32 m0, s92, 2048
    s_nop 0
    buffer_load_dwordx4 v9, s[4:7], s52 offen offset:0 lds
    buffer_load_dwordx4 v10, s[4:7], s52 offen offset:1024 lds
    s_add_u32 s56, s56, 1
    s_cmp_eq_u32 s56, 10
    s_cselect_b32 s56, 0, s56
    s_add_u32 s51, s41, 0
    s_and_b32 s51, s51, 15
    s_lshl_b32 s51, s51, 14
    s_add_u32 s51, s51, s43
    s_add_u32 m0, s45, 16384
    s_nop 0
    buffer_load_dwordx4 v5, s[16:19], s51 offen offset:0 nt lds
    s_waitcnt vmcnt(11)
    s_barrier
    ds_read_b128 v[192:195], v252 offset:16384
    ds_read_b128 v[196:199], v252 offset:18432
    ds_read_b128 v[200:203], v253 offset:16384
    ds_read_b128 v[204:207], v253 offset:18432
    s_lshl_b32 s52, s57, 18
    s_add_u32 s52, s52, s55
    s_add_u32 m0, s93, 8192
    s_nop 0
    buffer_load_dwordx4 v7, s[8:11], s52 offen offset:0 lds
    buffer_load_dwordx4 v8, s[8:11], s52 offen offset:1024 lds
    s_add_u32 s57, s57, 1
    s_cmp_eq_u32 s57, 20
    s_cselect_b32 s57, 0, s57
    s_add_u32 s51, s41, 0
    s_and_b32 s51, s51, 15
    s_lshl_b32 s51, s51, 14
    s_add_u32 s51, s51, s43
    s_add_u32 m0, s45, 16384
    s_nop 0
    buffer_load_dwordx4 v6, s[16:19], s51 offen offset:1024 nt lds
    s_waitcnt lgkmcnt(0)
    s_waitcnt vmcnt(11)
    s_barrier
    s_lshl_b32 s52, s57, 18
    s_add_u32 s52, s52, s55
    s_add_u32 m0, s93, 16384
    s_nop 0
    buffer_load_dwordx4 v7, s[8:11], s52 offen offset:0 lds
    buffer_load_dwordx4 v8, s[8:11], s52 offen offset:1024 lds
    s_add_u32 s57, s57, 1
    s_cmp_eq_u32 s57, 20
    s_cselect_b32 s57, 0, s57
    s_lshl_b32 s52, s56, 7
    s_add_u32 s52, s52, s42
    s_add_u32 m0, s92, 16384
    s_nop 0
    buffer_load_dwordx4 v9, s[4:7], s52 offen offset:0 lds
    buffer_load_dwordx4 v10, s[4:7], s52 offen offset:1024 lds
    s_lshl_b32 s52, s56, 7
    s_add_u32 s52, s52, s42
    s_add_u32 s52, s52, 20480
    s_add_u32 m0, s92, 18432
    s_nop 0
    buffer_load_dwordx4 v9, s[4:7], s52 offen offset:0 lds
    buffer_load_dwordx4 v10, s[4:7], s52 offen offset:1024 lds
    s_add_u32 s56, s56, 1
    s_cmp_eq_u32 s56, 10
    s_cselect_b32 s56, 0, s56
    s_add_u32 s51, s41, 0
    s_and_b32 s51, s51, 15
    s_lshl_b32 s51, s51, 14
    s_add_u32 s51, s51, s43
    s_add_u32 m0, s45, 16384
    s_nop 0
    buffer_load_dwordx4 v5, s[16:19], s51 offen offset:2048 nt lds
    s_waitcnt vmcnt(11)
    s_barrier
    ds_read_b128 v[208:211], v252 offset:0
    ds_read_b128 v[212:215], v252 offset:2048
    ds_read_b128 v[216:219], v253 offset:0
    ds_read_b128 v[220:223], v253 offset:2048
    s_lshl_b32 s52, s57, 18
    s_add_u32 s52, s52, s55
    s_add_u32 m0, s93, 24576
    s_nop 0
    buffer_load_dwordx4 v7, s[8:11], s52 offen offset:0 lds
    buffer_load_dwordx4 v8, s[8:11], s52 offen offset:1024 lds
    s_add_u32 s57, s57, 1
    s_cmp_eq_u32 s57, 20
    s_cselect_b32 s57, 0, s57
    s_add_u32 s51, s41, 0
    s_and_b32 s51, s51, 15
    s_lshl_b32 s51, s51, 14
    s_add_u32 s51, s51, s43
    s_add_u32 m0, s45, 16384
    s_nop 0
    buffer_load_dwordx4 v6, s[16:19], s51 offen offset:3072 nt lds
    s_waitcnt lgkmcnt(0)
    s_waitcnt vmcnt(11)
    s_barrier
    s_lshl_b32 s52, s57, 18
    s_add_u32 s52, s52, s55
    s_add_u32 m0, s93, 0
    s_nop 0
    buffer_load_dwordx4 v7, s[8:11], s52 offen offset:0 lds
    buffer_load_dwordx4 v8, s[8:11], s52 offen offset:1024 lds
    s_add_u32 s57, s57, 1
    s_cmp_eq_u32 s57, 20
    s_cselect_b32 s57, 0, s57
    s_lshl_b32 s52, s56, 7
    s_add_u32 s52, s52, s42
    s_add_u32 m0, s92, 0
    s_nop 0
    buffer_load_dwordx4 v9, s[4:7], s52 offen offset:0 lds
    buffer_load_dwordx4 v10, s[4:7], s52 offen offset:1024 lds
    s_lshl_b32 s52, s56, 7
    s_add_u32 s52, s52, s42
    s_add_u32 s52, s52, 20480
    s_add_u32 m0, s92, 2048
    s_nop 0
    buffer_load_dwordx4 v9, s[4:7], s52 offen offset:0 lds
    buffer_load_dwordx4 v10, s[4:7], s52 offen offset:1024 lds
    s_add_u32 s56, s56, 1
    s_cmp_eq_u32 s56, 10
    s_cselect_b32 s56, 0, s56
    s_add_u32 s51, s41, 1
    s_and_b32 s51, s51, 15
    s_lshl_b32 s51, s51, 14
    s_add_u32 s51, s51, s43
    s_add_u32 m0, s45, 32768
    s_nop 0
    buffer_load_dwordx4 v1, s[12:15], s51 offen offset:0 nt lds
    s_waitcnt vmcnt(11)
    s_barrier
    ds_read_b128 v[224:227], v252 offset:16384
    ds_read_b128 v[228:231], v252 offset:18432
    ds_read_b128 v[232:235], v253 offset:16384
    ds_read_b128 v[236:239], v253 offset:18432
    s_lshl_b32 s52, s57, 18
    s_add_u32 s52, s52, s55
    s_add_u32 m0, s93, 8192
    s_nop 0
    buffer_load_dwordx4 v7, s[8:11], s52 offen offset:0 lds
    buffer_load_dwordx4 v8, s[8:11], s52 offen offset:1024 lds
    s_add_u32 s57, s57, 1
    s_cmp_eq_u32 s57, 20
    s_cselect_b32 s57, 0, s57
    s_add_u32 s51, s41, 1
    s_and_b32 s51, s51, 15
    s_lshl_b32 s51, s51, 14
    s_add_u32 s51, s51, s43
    s_add_u32 m0, s45, 32768
    s_nop 0
    buffer_load_dwordx4 v2, s[12:15], s51 offen offset:1024 nt lds
    s_waitcnt lgkmcnt(0)
    s_waitcnt vmcnt(11)
    s_barrier
    s_lshl_b32 s52, s57, 18
    s_add_u32 s52, s52, s55
    s_add_u32 m0, s93, 16384
    s_nop 0
    buffer_load_dwordx4 v7, s[8:11], s52 offen offset:0 lds
    buffer_load_dwordx4 v8, s[8:11], s52 offen offset:1024 lds
    s_add_u32 s57, s57, 1
    s_cmp_eq_u32 s57, 20
    s_cselect_b32 s57, 0, s57
    s_lshl_b32 s52, s56, 7
    s_add_u32 s52, s52, s42
    s_add_u32 m0, s92, 16384
    s_nop 0
    buffer_load_dwordx4 v9, s[4:7], s52 offen offset:0 lds
    buffer_load_dwordx4 v10, s[4:7], s52 offen offset:1024 lds
    s_lshl_b32 s52, s56, 7
    s_add_u32 s52, s52, s42
    s_add_u32 s52, s52, 20480
    s_add_u32 m0, s92, 18432
    s_nop 0
    buffer_load_dwordx4 v9, s[4:7], s52 offen offset:0 lds
    buffer_load_dwordx4 v10, s[4:7], s52 offen offset:1024 lds
    s_add_u32 s56, s56, 1
    s_cmp_eq_u32 s56, 10
    s_cselect_b32 s56, 0, s56
    s_add_u32 s51, s41, 1
    s_and_b32 s51, s51, 15
    s_lshl_b32 s51, s51, 14
    s_add_u32 s51, s51, s43
    s_add_u32 m0, s45, 32768
    s_nop 0
    buffer_load_dwordx4 v3, s[12:15], s51 offen offset:2048 nt lds
    s_waitcnt vmcnt(11)
    s_barrier
    ds_read_b128 v[16:19], v252 offset:0
    ds_read_b128 v[20:23], v252 offset:2048
    ds_read_b128 v[24:27], v253 offset:0
    ds_read_b128 v[28:31], v253 offset:2048
    s_lshl_b32 s52, s57, 18
    s_add_u32 s52, s52, s55
    s_add_u32 m0, s93, 24576
    s_nop 0
    buffer_load_dwordx4 v7, s[8:11], s52 offen offset:0 lds
    buffer_load_dwordx4 v8, s[8:11], s52 offen offset:1024 lds
    s_add_u32 s57, s57, 1
    s_cmp_eq_u32 s57, 20
    s_cselect_b32 s57, 0, s57
    s_add_u32 s51, s41, 1
    s_and_b32 s51, s51, 15
    s_lshl_b32 s51, s51, 14
    s_add_u32 s51, s51, s43
    s_add_u32 m0, s45, 32768
    s_nop 0
    buffer_load_dwordx4 v4, s[12:15], s51 offen offset:3072 nt lds
    s_waitcnt lgkmcnt(0)
    s_waitcnt vmcnt(11)
    s_barrier
    s_add_u32 s51, s41, 1
    s_and_b32 s51, s51, 15
    s_lshl_b32 s51, s51, 14
    s_add_u32 s51, s51, s43
    s_add_u32 m0, s45, 49152
    s_nop 0
    buffer_load_dwordx4 v5, s[16:19], s51 offen offset:0 nt lds
    s_waitcnt vmcnt(5)
    s_barrier
    ds_read_b128 v[32:35], v252 offset:16384
    ds_read_b128 v[36:39], v252 offset:18432
    ds_read_b128 v[40:43], v253 offset:16384
    ds_read_b128 v[44:47], v253 offset:18432
    s_add_u32 s51, s41, 1
    s_and_b32 s51, s51, 15
    s_lshl_b32 s51, s51, 14
    s_add_u32 s51, s51, s43
    s_add_u32 m0, s45, 49152
    s_nop 0
    buffer_load_dwordx4 v6, s[16:19], s51 offen offset:1024 nt lds
    s_waitcnt lgkmcnt(0)
    s_waitcnt vmcnt(3)
    s_barrier
    s_add_u32 s51, s41, 1
    s_and_b32 s51, s51, 15
    s_lshl_b32 s51, s51, 14
    s_add_u32 s51, s51, s43
    s_add_u32 m0, s45, 49152
    s_nop 0
    buffer_load_dwordx4 v5, s[16:19], s51 offen offset:2048 nt lds
    s_barrier
    s_add_u32 s51, s41, 1
    s_and_b32 s51, s51, 15
    s_lshl_b32 s51, s51, 14
    s_add_u32 s51, s51, s43
    s_add_u32 m0, s45, 49152
    s_nop 0
    buffer_load_dwordx4 v6, s[16:19], s51 offen offset:3072 nt lds
    s_add_u32 s55, s55, 1024
    s_lshl_b32 s52, s57, 18
    s_add_u32 s52, s52, s55
    s_add_u32 m0, s93, 0
    s_nop 0
    buffer_load_dwordx4 v7, s[8:11], s52 offen offset:0 lds
    buffer_load_dwordx4 v8, s[8:11], s52 offen offset:1024 lds
    s_add_u32 s57, s57, 1
    s_cmp_eq_u32 s57, 20
    s_cselect_b32 s57, 0, s57
    s_add_u32 s51, s41, 2
    s_and_b32 s51, s51, 15
    s_lshl_b32 s51, s51, 14
    s_add_u32 s51, s51, s43
    s_add_u32 m0, s45, 65536
    s_waitcnt vmcnt(6)
    buffer_load_dwordx4 v1, s[12:15], s51 offen offset:0 nt lds
    s_waitcnt vmcnt(6)
    buffer_load_dwordx4 v2, s[12:15], s51 offen offset:1024 nt lds
    s_waitcnt vmcnt(6)
    buffer_load_dwordx4 v3, s[12:15], s51 offen offset:2048 nt lds
    s_waitcnt vmcnt(6)
    buffer_load_dwordx4 v4, s[12:15], s51 offen offset:3072 nt lds
    s_add_u32 m0, s45, 81920
    s_waitcnt vmcnt(6)
    buffer_load_dwordx4 v5, s[16:19], s51 offen offset:0 nt lds
    s_waitcnt vmcnt(4)
    buffer_load_dwordx4 v6, s[16:19], s51 offen offset:1024 nt lds
    s_waitcnt vmcnt(4)
    buffer_load_dwordx4 v5, s[16:19], s51 offen offset:2048 nt lds
    s_waitcnt vmcnt(4)
    buffer_load_dwordx4 v6, s[16:19], s51 offen offset:3072 nt lds
    v_lshl_add_u32 v10, v13, 2, 64
    s_barrier
    s_barrier
    s_cmp_eq_u32 s36, 4
    s_cbranch_scc0 L_sig1
    s_cmp_eq_u32 s86, 1
    s_cbranch_scc0 L_sig1
    v_mov_b32 v14, 1
    s_and_b32 s51, s2, 15
    s_lshl_b32 s51, s51, 2
    s_add_u32 s51, s51, 64
    v_mov_b32 v15, s51
    s_mov_b64 s[90:91], exec
    s_mov_b64 exec, 1
    buffer_atomic_add v14, v15, s[32:35], 0 offen
    s_mov_b64 exec, s[90:91]
L_sig1:
    s_lshl_b32 s52, s57, 18
    s_add_u32 s52, s52, s55
    s_add_u32 m0, s93, 8192
    s_nop 0
    buffer_load_dwordx4 v7, s[8:11], s52 offen offset:0 lds
    buffer_load_dwordx4 v8, s[8:11], s52 offen offset:1024 lds
    s_add_u32 s57, s57, 1
    s_cmp_eq_u32 s57, 20
    s_cselect_b32 s57, 0, s57
    s_lshl_b32 s52, s57, 18
    s_add_u32 s52, s52, s55
    s_add_u32 m0, s93, 16384
    s_nop 0
    buffer_load_dwordx4 v7, s[8:11], s52 offen offset:0 lds
    buffer_load_dwordx4 v8, s[8:11], s52 offen offset:1024 lds
    s_add_u32 s57, s57, 1
    s_cmp_eq_u32 s57, 20
    s_cselect_b32 s57, 0, s57
    s_add_u32 s51, s41, 3
    s_and_b32 s51, s51, 15
    s_lshl_b32 s51, s51, 14
    s_add_u32 s51, s51, s43
    s_add_u32 m0, s45, 0
    s_waitcnt vmcnt(8)
    buffer_load_dwordx4 v1, s[12:15], s51 offen offset:0 nt lds
    s_add_u32 s51, s41, 3
    s_and_b32 s51, s51, 15
    s_lshl_b32 s51, s51, 14
    s_add_u32 s51, s51, s43
    s_add_u32 m0, s45, 0
    s_waitcnt vmcnt(8)
    buffer_load_dwordx4 v2, s[12:15], s51 offen offset:1024 nt lds
    s_add_u32 s51, s41, 3
    s_and_b32 s51, s51, 15
    s_lshl_b32 s51, s51, 14
    s_add_u32 s51, s51, s43
    s_add_u32 m0, s45, 0
    s_waitcnt vmcnt(8)
    buffer_load_dwordx4 v3, s[12:15], s51 offen offset:2048 nt lds
    s_add_u32 s51, s41, 3
    s_and_b32 s51, s51, 15
    s_lshl_b32 s51, s51, 14
    s_add_u32 s51, s51, s43
    s_add_u32 m0, s45, 0
    s_waitcnt vmcnt(8)
    buffer_load_dwordx4 v4, s[12:15], s51 offen offset:3072 nt lds
    s_add_u32 s51, s41, 3
    s_and_b32 s51, s51, 15
    s_lshl_b32 s51, s51, 14
    s_add_u32 s51, s51, s43
    s_add_u32 m0, s45, 16384
    s_waitcnt vmcnt(8)
    buffer_load_dwordx4 v5, s[16:19], s51 offen offset:0 nt lds
    s_add_u32 s51, s41, 3
    s_and_b32 s51, s51, 15
    s_lshl_b32 s51, s51, 14
    s_add_u32 s51, s51, s43
    s_add_u32 m0, s45, 16384
    s_waitcnt vmcnt(4)
    buffer_load_dwordx4 v6, s[16:19], s51 offen offset:1024 nt lds
    s_add_u32 s51, s41, 3
    s_and_b32 s51, s51, 15
    s_lshl_b32 s51, s51, 14
    s_add_u32 s51, s51, s43
    s_add_u32 m0, s45, 16384
    s_waitcnt vmcnt(4)
    buffer_load_dwordx4 v5, s[16:19], s51 offen offset:2048 nt lds
    s_add_u32 s51, s41, 3
    s_and_b32 s51, s51, 15
    s_lshl_b32 s51, s51, 14
    s_add_u32 s51, s51, s43
    s_add_u32 m0, s45, 16384
    s_waitcnt vmcnt(4)
    buffer_load_dwordx4 v6, s[16:19], s51 offen offset:3072 nt lds
    ds_read_b64_tr_b16 v[240:241], v244 offset:0
    ds_read_b64_tr_b16 v[242:243], v244 offset:1024
    ds_read_b64_tr_b16 v[252:253], v245 offset:0
    ds_read_b64_tr_b16 v[254:255], v245 offset:1024
    s_waitcnt lgkmcnt(2)
    v_mfma_f32_16x16x32_bf16 v[48:51], v[240:243], v[112:115], 0
    v_mfma_f32_16x16x32_bf16 v[52:55], v[240:243], v[116:119], 0
    ds_read_b64_tr_b16 v[240:241], v246 offset:0
    ds_read_b64_tr_b16 v[242:243], v246 offset:1024
    s_waitcnt lgkmcnt(2)
    v_mfma_f32_16x16x32_bf16 v[56:59], v[252:255], v[112:115], 0
    v_mfma_f32_16x16x32_bf16 v[60:63], v[252:255], v[116:119], 0
    ds_read_b64_tr_b16 v[252:253], v247 offset:0
    ds_read_b64_tr_b16 v[254:255], v247 offset:1024
    s_waitcnt lgkmcnt(2)
    v_mfma_f32_16x16x32_bf16 v[64:67], v[240:243], v[112:115], 0
    v_mfma_f32_16x16x32_bf16 v[68:71], v[240:243], v[116:119], 0
    ds_read_b64_tr_b16 v[240:241], v248 offset:0
    ds_read_b64_tr_b16 v[242:243], v248 offset:1024
    s_waitcnt lgkmcnt(2)
    v_mfma_f32_16x16x32_bf16 v[72:75], v[252:255], v[112:115], 0
    v_mfma_f32_16x16x32_bf16 v[76:79], v[252:255], v[116:119], 0
    ds_read_b64_tr_b16 v[252:253], v249 offset:0
    ds_read_b64_tr_b16 v[254:255], v249 offset:1024
    s_waitcnt lgkmcnt(2)
    v_mfma_f32_16x16x32_bf16 v[80:83], v[240:243], v[112:115], 0
    v_mfma_f32_16x16x32_bf16 v[84:87], v[240:243], v[116:119], 0
    ds_read_b64_tr_b16 v[240:241], v250 offset:0
    ds_read_b64_tr_b16 v[242:243], v250 offset:1024
    s_waitcnt lgkmcnt(2)
    v_mfma_f32_16x16x32_bf16 v[88:91], v[252:255], v[112:115], 0
    v_mfma_f32_16x16x32_bf16 v[92:95], v[252:255], v[116:119], 0
    ds_read_b64_tr_b16 v[252:253], v251 offset:0
    ds_read_b64_tr_b16 v[254:255], v251 offset:1024
    s_waitcnt lgkmcnt(2)
    v_mfma_f32_16x16x32_bf16 v[96:99], v[240:243], v[112:115], 0
    v_mfma_f32_16x16x32_bf16 v[100:103], v[240:243], v[116:119], 0
    s_waitcnt lgkmcnt(0)
    v_mfma_f32_16x16x32_bf16 v[104:107], v[252:255], v[112:115], 0
    v_mfma_f32_16x16x32_bf16 v[108:111], v[252:255], v[116:119], 0
    s_barrier
    s_cmp_eq_u32 s36, 4
    s_cbranch_scc0 L_sig2
    s_cmp_eq_u32 s86, 2
    s_cbranch_scc0 L_sig2
    v_mov_b32 v14, 1
    s_and_b32 s51, s2, 15
    s_lshl_b32 s51, s51, 2
    s_add_u32 s51, s51, 64
    v_mov_b32 v15, s51
    s_mov_b64 s[90:91], exec
    s_mov_b64 exec, 1
    buffer_atomic_add v14, v15, s[32:35], 0 offen
    s_mov_b64 exec, s[90:91]
L_sig2:
    s_lshl_b32 s52, s57, 18
    s_add_u32 s52, s52, s55
    s_add_u32 m0, s93, 24576
    s_nop 0
    buffer_load_dwordx4 v7, s[8:11], s52 offen offset:0 lds
    buffer_load_dwordx4 v8, s[8:11], s52 offen offset:1024 lds
    s_add_u32 s57, s57, 1
    s_cmp_eq_u32 s57, 20
    s_cselect_b32 s57, 0, s57
    s_add_u32 s51, s41, 4
    s_and_b32 s51, s51, 15
    s_lshl_b32 s51, s51, 14
    s_add_u32 s51, s51, s43
    s_add_u32 m0, s45, 32768
    s_waitcnt vmcnt(6)
    buffer_load_dwordx4 v1, s[12:15], s51 offen offset:0 nt lds
    s_add_u32 s51, s41, 4
    s_and_b32 s51, s51, 15
    s_lshl_b32 s51, s51, 14
    s_add_u32 s51, s51, s43
    s_add_u32 m0, s45, 32768
    s_waitcnt vmcnt(6)
    buffer_load_dwordx4 v2, s[12:15], s51 offen offset:1024 nt lds
    s_add_u32 s51, s41, 4
    s_and_b32 s51, s51, 15
    s_lshl_b32 s51, s51, 14
    s_add_u32 s51, s51, s43
    s_add_u32 m0, s45, 32768
    s_waitcnt vmcnt(6)
    buffer_load_dwordx4 v3, s[12:15], s51 offen offset:2048 nt lds
    s_add_u32 s51, s41, 4
    s_and_b32 s51, s51, 15
    s_lshl_b32 s51, s51, 14
    s_add_u32 s51, s51, s43
    s_add_u32 m0, s45, 32768
    s_waitcnt vmcnt(6)
    buffer_load_dwordx4 v4, s[12:15], s51 offen offset:3072 nt lds
    s_add_u32 s51, s41, 4
    s_and_b32 s51, s51, 15
    s_lshl_b32 s51, s51, 14
    s_add_u32 s51, s51, s43
    s_add_u32 m0, s45, 49152
    s_waitcnt vmcnt(6)
    buffer_load_dwordx4 v5, s[16:19], s51 offen offset:0 nt lds
    s_add_u32 s51, s41, 4
    s_and_b32 s51, s51, 15
    s_lshl_b32 s51, s51, 14
    s_add_u32 s51, s51, s43
    s_add_u32 m0, s45, 49152
    s_waitcnt vmcnt(4)
    buffer_load_dwordx4 v6, s[16:19], s51 offen offset:1024 nt lds
    s_add_u32 s51, s41, 4
    s_and_b32 s51, s51, 15
    s_lshl_b32 s51, s51, 14
    s_add_u32 s51, s51, s43
    s_add_u32 m0, s45, 49152
    s_waitcnt vmcnt(4)
    buffer_load_dwordx4 v5, s[16:19], s51 offen offset:2048 nt lds
    s_add_u32 s51, s41, 4
    s_and_b32 s51, s51, 15
    s_lshl_b32 s51, s51, 14
    s_add_u32 s51, s51, s43
    s_add_u32 m0, s45, 49152
    s_waitcnt vmcnt(4)
    buffer_load_dwordx4 v6, s[16:19], s51 offen offset:3072 nt lds
    ds_read_b64_tr_b16 v[240:241], v244 offset:8192
    ds_read_b64_tr_b16 v[242:243], v244 offset:9216
    ds_read_b64_tr_b16 v[252:253], v245 offset:8192
    ds_read_b64_tr_b16 v[254:255], v245 offset:9216
    ds_read_b64_tr_b16 v[112:113], v246 offset:8192
    ds_read_b64_tr_b16 v[114:115], v246 offset:9216
    ds_read_b64_tr_b16 v[116:117], v247 offset:8192
    ds_read_b64_tr_b16 v[118:119], v247 offset:9216
    s_waitcnt lgkmcnt(6)
    v_mfma_f32_16x16x32_bf16 v[48:51], v[240:243], v[120:123], v[48:51]
    v_mfma_f32_16x16x32_bf16 v[52:55], v[240:243], v[124:127], v[52:55]
    ds_read_b64_tr_b16 v[240:241], v248 offset:8192
    ds_read_b64_tr_b16 v[242:243], v248 offset:9216
    s_waitcnt lgkmcnt(6)
    v_mfma_f32_16x16x32_bf16 v[56:59], v[252:255], v[120:123], v[56:59]
    v_mfma_f32_16x16x32_bf16 v[60:63], v[252:255], v[124:127], v[60:63]
    ds_read_b64_tr_b16 v[252:253], v249 offset:8192
    ds_read_b64_tr_b16 v[254:255], v249 offset:9216
    s_waitcnt lgkmcnt(6)
    v_mfma_f32_16x16x32_bf16 v[64:67], v[112:115], v[120:123], v[64:67]
    v_mfma_f32_16x16x32_bf16 v[68:71], v[112:115], v[124:127], v[68:71]
    ds_read_b64_tr_b16 v[112:113], v250 offset:8192
    ds_read_b64_tr_b16 v[114:115], v250 offset:9216
    s_waitcnt lgkmcnt(6)
    v_mfma_f32_16x16x32_bf16 v[72:75], v[116:119], v[120:123], v[72:75]
    v_mfma_f32_16x16x32_bf16 v[76:79], v[116:119], v[124:127], v[76:79]
    ds_read_b64_tr_b16 v[116:117], v251 offset:8192
    ds_read_b64_tr_b16 v[118:119], v251 offset:9216
    s_waitcnt lgkmcnt(6)
    v_mfma_f32_16x16x32_bf16 v[80:83], v[240:243], v[120:123], v[80:83]
    v_mfma_f32_16x16x32_bf16 v[84:87], v[240:243], v[124:127], v[84:87]
    s_waitcnt lgkmcnt(4)
    v_mfma_f32_16x16x32_bf16 v[88:91], v[252:255], v[120:123], v[88:91]
    v_mfma_f32_16x16x32_bf16 v[92:95], v[252:255], v[124:127], v[92:95]
    s_waitcnt lgkmcnt(2)
    v_mfma_f32_16x16x32_bf16 v[96:99], v[112:115], v[120:123], v[96:99]
    v_mfma_f32_16x16x32_bf16 v[100:103], v[112:115], v[124:127], v[100:103]
    s_waitcnt lgkmcnt(0)
    v_mfma_f32_16x16x32_bf16 v[104:107], v[116:119], v[120:123], v[104:107]
    v_mfma_f32_16x16x32_bf16 v[108:111], v[116:119], v[124:127], v[108:111]
    ds_read_b64_tr_b16 v[240:241], v244 offset:16384
    ds_read_b64_tr_b16 v[242:243], v244 offset:17408
    ds_read_b64_tr_b16 v[252:253], v245 offset:16384
    ds_read_b64_tr_b16 v[254:255], v245 offset:17408
    ds_read_b64_tr_b16 v[112:113], v246 offset:16384
    ds_read_b64_tr_b16 v[114:115], v246 offset:17408
    ds_read_b64_tr_b16 v[116:117], v247 offset:16384
    ds_read_b64_tr_b16 v[118:119], v247 offset:17408
    ds_read_b64_tr_b16 v[120:121], v248 offset:16384
    ds_read_b64_tr_b16 v[122:123], v248 offset:17408
    ds_read_b64_tr_b16 v[124:125], v249 offset:16384
    ds_read_b64_tr_b16 v[126:127], v249 offset:17408
    s_waitcnt lgkmcnt(10)
    v_mfma_f32_16x16x32_bf16 v[48:51], v[240:243], v[128:131], v[48:51]
    v_mfma_f32_16x16x32_bf16 v[52:55], v[240:243], v[132:135], v[52:55]
    ds_read_b64_tr_b16 v[240:241], v250 offset:16384
    ds_read_b64_tr_b16 v[242:243], v250 offset:17408
    s_waitcnt lgkmcnt(10)
    v_mfma_f32_16x16x32_bf16 v[56:59], v[252:255], v[128:131], v[56:59]
    v_mfma_f32_16x16x32_bf16 v[60:63], v[252:255], v[132:135], v[60:63]
    ds_read_b64_tr_b16 v[252:253], v251 offset:16384
    ds_read_b64_tr_b16 v[254:255], v251 offset:17408
    s_waitcnt lgkmcnt(10)
    v_mfma_f32_16x16x32_bf16 v[64:67], v[112:115], v[128:131], v[64:67]
    v_mfma_f32_16x16x32_bf16 v[68:71], v[112:115], v[132:135], v[68:71]
    s_waitcnt lgkmcnt(8)
    v_mfma_f32_16x16x32_bf16 v[72:75], v[116:119], v[128:131], v[72:75]
    v_mfma_f32_16x16x32_bf16 v[76:79], v[116:119], v[132:135], v[76:79]
    s_waitcnt lgkmcnt(6)
    v_mfma_f32_16x16x32_bf16 v[80:83], v[120:123], v[128:131], v[80:83]
    v_mfma_f32_16x16x32_bf16 v[84:87], v[120:123], v[132:135], v[84:87]
    s_waitcnt lgkmcnt(4)
    v_mfma_f32_16x16x32_bf16 v[88:91], v[124:127], v[128:131], v[88:91]
    v_mfma_f32_16x16x32_bf16 v[92:95], v[124:127], v[132:135], v[92:95]
    s_waitcnt lgkmcnt(2)
    v_mfma_f32_16x16x32_bf16 v[96:99], v[240:243], v[128:131], v[96:99]
    v_mfma_f32_16x16x32_bf16 v[100:103], v[240:243], v[132:135], v[100:103]
    s_waitcnt lgkmcnt(0)
    v_mfma_f32_16x16x32_bf16 v[104:107], v[252:255], v[128:131], v[104:107]
    v_mfma_f32_16x16x32_bf16 v[108:111], v[252:255], v[132:135], v[108:111]
    s_barrier
    s_cmp_eq_u32 s36, 4
    s_cbranch_scc0 L_sig3
    s_cmp_eq_u32 s86, 3
    s_cbranch_scc0 L_sig3
    v_mov_b32 v14, 1
    s_and_b32 s51, s2, 15
    s_lshl_b32 s51, s51, 2
    s_add_u32 s51, s51, 64
    v_mov_b32 v15, s51
    s_mov_b64 s[90:91], exec
    s_mov_b64 exec, 1
    buffer_atomic_add v14, v15, s[32:35], 0 offen
    s_mov_b64 exec, s[90:91]
L_sig3:
    s_lshl_b32 s52, s57, 18
    s_add_u32 s52, s52, s55
    s_add_u32 m0, s93, 0
    s_nop 0
    buffer_load_dwordx4 v7, s[8:11], s52 offen offset:0 lds
    buffer_load_dwordx4 v8, s[8:11], s52 offen offset:1024 lds
    s_add_u32 s57, s57, 1
    s_cmp_eq_u32 s57, 20
    s_cselect_b32 s57, 0, s57
    s_lshl_b32 s52, s57, 18
    s_add_u32 s52, s52, s55
    s_add_u32 m0, s93, 8192
    s_nop 0
    buffer_load_dwordx4 v7, s[8:11], s52 offen offset:0 lds
    buffer_load_dwordx4 v8, s[8:11], s52 offen offset:1024 lds
    s_add_u32 s57, s57, 1
    s_cmp_eq_u32 s57, 20
    s_cselect_b32 s57, 0, s57
    s_add_u32 s51, s41, 5
    s_and_b32 s51, s51, 15
    s_lshl_b32 s51, s51, 14
    s_add_u32 s51, s51, s43
    s_add_u32 m0, s45, 65536
    s_waitcnt vmcnt(8)
    buffer_load_dwordx4 v1, s[12:15], s51 offen offset:0 nt lds
    s_add_u32 s51, s41, 5
    s_and_b32 s51, s51, 15
    s_lshl_b32 s51, s51, 14
    s_add_u32 s51, s51, s43
    s_add_u32 m0, s45, 65536
    s_waitcnt vmcnt(8)
    buffer_load_dwordx4 v2, s[12:15], s51 offen offset:1024 nt lds
    s_add_u32 s51, s41, 5
    s_and_b32 s51, s51, 15
    s_lshl_b32 s51, s51, 14
    s_add_u32 s51, s51, s43
    s_add_u32 m0, s45, 65536
    s_waitcnt vmcnt(8)
    buffer_load_dwordx4 v3, s[12:15], s51 offen offset:2048 nt lds
    s_add_u32 s51, s41, 5
    s_and_b32 s51, s51, 15
    s_lshl_b32 s51, s51, 14
    s_add_u32 s51, s51, s43
    s_add_u32 m0, s45, 65536
    s_waitcnt vmcnt(8)
    buffer_load_dwordx4 v4, s[12:15], s51 offen offset:3072 nt lds
    s_add_u32 s51, s41, 5
    s_and_b32 s51, s51, 15
    s_lshl_b32 s51, s51, 14
    s_add_u32 s51, s51, s43
    s_add_u32 m0, s45, 81920
    s_waitcnt vmcnt(8)
    buffer_load_dwordx4 v5, s[16:19], s51 offen offset:0 nt lds
    s_add_u32 s51, s41, 5
    s_and_b32 s51, s51, 15
    s_lshl_b32 s51, s51, 14
    s_add_u32 s51, s51, s43
    s_add_u32 m0, s45, 81920
    s_waitcnt vmcnt(4)
    buffer_load_dwordx4 v6, s[16:19], s51 offen offset:1024 nt lds
    s_add_u32 s51, s41, 5
    s_and_b32 s51, s51, 15
    s_lshl_b32 s51, s51, 14
    s_add_u32 s51, s51, s43
    s_add_u32 m0, s45, 81920
    s_waitcnt vmcnt(4)
    buffer_load_dwordx4 v5, s[16:19], s51 offen offset:2048 nt lds
    s_add_u32 s51, s41, 5
    s_and_b32 s51, s51, 15
    s_lshl_b32 s51, s51, 14
    s_add_u32 s51, s51, s43
    s_add_u32 m0, s45, 81920
    s_waitcnt vmcnt(4)
    buffer_load_dwordx4 v6, s[16:19], s51 offen offset:3072 nt lds
    ds_read_b64_tr_b16 v[240:241], v244 offset:24576
    ds_read_b64_tr_b16 v[242:243], v244 offset:25600
    ds_read_b64_tr_b16 v[252:253], v245 offset:24576
    ds_read_b64_tr_b16 v[254:255], v245 offset:25600
    ds_read_b64_tr_b16 v[112:113], v246 offset:24576
    ds_read_b64_tr_b16 v[114:115], v246 offset:25600
    ds_read_b64_tr_b16 v[116:117], v247 offset:24576
    ds_read_b64_tr_b16 v[118:119], v247 offset:25600
    ds_read_b64_tr_b16 v[120:121], v248 offset:24576
    ds_read_b64_tr_b16 v[122:123], v248 offset:25600
    ds_read_b64_tr_b16 v[124:125], v249 offset:24576
    ds_read_b64_tr_b16 v[126:127], v249 offset:25600
    ds_read_b64_tr_b16 v[128:129], v250 offset:24576
    ds_read_b64_tr_b16 v[130:131], v250 offset:25600
    ds_read_b64_tr_b16 v[132:133], v251 offset:24576
    ds_read_b64_tr_b16 v[134:135], v251 offset:25600
    s_waitcnt lgkmcnt(14)
    v_mfma_f32_16x16x32_bf16 v[48:51], v[240:243], v[136:139], v[48:51]
    v_mfma_f32_16x16x32_bf16 v[52:55], v[240:243], v[140:143], v[52:55]
    s_waitcnt lgkmcnt(12)
    v_mfma_f32_16x16x32_bf16 v[56:59], v[252:255], v[136:139], v[56:59]
    v_mfma_f32_16x16x32_bf16 v[60:63], v[252:255], v[140:143], v[60:63]
    s_waitcnt lgkmcnt(10)
    v_mfma_f32_16x16x32_bf16 v[64:67], v[112:115], v[136:139], v[64:67]
    v_mfma_f32_16x16x32_bf16 v[68:71], v[112:115], v[140:143], v[68:71]
    s_waitcnt lgkmcnt(8)
    v_mfma_f32_16x16x32_bf16 v[72:75], v[116:119], v[136:139], v[72:75]
    v_mfma_f32_16x16x32_bf16 v[76:79], v[116:119], v[140:143], v[76:79]
    s_waitcnt lgkmcnt(6)
    v_mfma_f32_16x16x32_bf16 v[80:83], v[120:123], v[136:139], v[80:83]
    v_mfma_f32_16x16x32_bf16 v[84:87], v[120:123], v[140:143], v[84:87]
    s_waitcnt lgkmcnt(4)
    v_mfma_f32_16x16x32_bf16 v[88:91], v[124:127], v[136:139], v[88:91]
    v_mfma_f32_16x16x32_bf16 v[92:95], v[124:127], v[140:143], v[92:95]
    s_waitcnt lgkmcnt(2)
    v_mfma_f32_16x16x32_bf16 v[96:99], v[128:131], v[136:139], v[96:99]
    v_mfma_f32_16x16x32_bf16 v[100:103], v[128:131], v[140:143], v[100:103]
    s_waitcnt lgkmcnt(0)
    v_mfma_f32_16x16x32_bf16 v[104:107], v[132:135], v[136:139], v[104:107]
    v_mfma_f32_16x16x32_bf16 v[108:111], v[132:135], v[140:143], v[108:111]
    s_barrier
    s_cmp_eq_u32 s36, 4
    s_cbranch_scc0 L_sig4
    s_cmp_eq_u32 s86, 4
    s_cbranch_scc0 L_sig4
    v_mov_b32 v14, 1
    s_and_b32 s51, s2, 15
    s_lshl_b32 s51, s51, 2
    s_add_u32 s51, s51, 64
    v_mov_b32 v15, s51
    s_mov_b64 s[90:91], exec
    s_mov_b64 exec, 1
    buffer_atomic_add v14, v15, s[32:35], 0 offen
    s_mov_b64 exec, s[90:91]
L_sig4:
    s_lshl_b32 s52, s57, 18
    s_add_u32 s52, s52, s55
    s_add_u32 m0, s93, 16384
    s_nop 0
    buffer_load_dwordx4 v7, s[8:11], s52 offen offset:0 lds
    buffer_load_dwordx4 v8, s[8:11], s52 offen offset:1024 lds
    s_add_u32 s57, s57, 1
    s_cmp_eq_u32 s57, 20
    s_cselect_b32 s57, 0, s57
    s_add_u32 s51, s41, 6
    s_and_b32 s51, s51, 15
    s_lshl_b32 s51, s51, 14
    s_add_u32 s51, s51, s43
    s_add_u32 m0, s45, 0
    s_waitcnt vmcnt(6)
    buffer_load_dwordx4 v1, s[12:15], s51 offen offset:0 nt lds
    s_add_u32 s51, s41, 6
    s_and_b32 s51, s51, 15
    s_lshl_b32 s51, s51, 14
    s_add_u32 s51, s51, s43
    s_add_u32 m0, s45, 0
    s_waitcnt vmcnt(6)
    buffer_load_dwordx4 v2, s[12:15], s51 offen offset:1024 nt lds
    s_add_u32 s51, s41, 6
    s_and_b32 s51, s51, 15
    s_lshl_b32 s51, s51, 14
    s_add_u32 s51, s51, s43
    s_add_u32 m0, s45, 0
    s_waitcnt vmcnt(6)
    buffer_load_dwordx4 v3, s[12:15], s51 offen offset:2048 nt lds
    s_add_u32 s51, s41, 6
    s_and_b32 s51, s51, 15
    s_lshl_b32 s51, s51, 14
    s_add_u32 s51, s51, s43
    s_add_u32 m0, s45, 0
    s_waitcnt vmcnt(6)
    buffer_load_dwordx4 v4, s[12:15], s51 offen offset:3072 nt lds
    s_add_u32 s51, s41, 6
    s_and_b32 s51, s51, 15
    s_lshl_b32 s51, s51, 14
    s_add_u32 s51, s51, s43
    s_add_u32 m0, s45, 16384
    s_waitcnt vmcnt(6)
    buffer_load_dwordx4 v5, s[16:19], s51 offen offset:0 nt lds
    s_add_u32 s51, s41, 6
    s_and_b32 s51, s51, 15
    s_lshl_b32 s51, s51, 14
    s_add_u32 s51, s51, s43
    s_add_u32 m0, s45, 16384
    s_waitcnt vmcnt(4)
    buffer_load_dwordx4 v6, s[16:19], s51 offen offset:1024 nt lds
    s_add_u32 s51, s41, 6
    s_and_b32 s51, s51, 15
    s_lshl_b32 s51, s51, 14
    s_add_u32 s51, s51, s43
    s_add_u32 m0, s45, 16384
    s_waitcnt vmcnt(4)
    buffer_load_dwordx4 v5, s[16:19], s51 offen offset:2048 nt lds
    s_add_u32 s51, s41, 6
    s_and_b32 s51, s51, 15
    s_lshl_b32 s51, s51, 14
    s_add_u32 s51, s51, s43
    s_add_u32 m0, s45, 16384
    s_waitcnt vmcnt(4)
    buffer_load_dwordx4 v6, s[16:19], s51 offen offset:3072 nt lds
    ds_read_b64_tr_b16 v[240:241], v244 offset:0
    ds_read_b64_tr_b16 v[242:243], v244 offset:1024
    ds_read_b64_tr_b16 v[252:253], v245 offset:0
    ds_read_b64_tr_b16 v[254:255], v245 offset:1024
    ds_read_b64_tr_b16 v[112:113], v246 offset:0
    ds_read_b64_tr_b16 v[114:115], v246 offset:1024
    ds_read_b64_tr_b16 v[116:117], v247 offset:0
    ds_read_b64_tr_b16 v[118:119], v247 offset:1024
    ds_read_b64_tr_b16 v[120:121], v248 offset:0
    ds_read_b64_tr_b16 v[122:123], v248 offset:1024
    ds_read_b64_tr_b16 v[124:125], v249 offset:0
    ds_read_b64_tr_b16 v[126:127], v249 offset:1024
    ds_read_b64_tr_b16 v[128:129], v250 offset:0
    ds_read_b64_tr_b16 v[130:131], v250 offset:1024
    ds_read_b64_tr_b16 v[132:133], v251 offset:0
    ds_read_b64_tr_b16 v[134:135], v251 offset:1024
    s_waitcnt lgkmcnt(14)
    v_mfma_f32_16x16x32_bf16 v[48:51], v[240:243], v[144:147], v[48:51]
    v_mfma_f32_16x16x32_bf16 v[52:55], v[240:243], v[148:151], v[52:55]
    s_waitcnt lgkmcnt(12)
    v_mfma_f32_16x16x32_bf16 v[56:59], v[252:255], v[144:147], v[56:59]
    v_mfma_f32_16x16x32_bf16 v[60:63], v[252:255], v[148:151], v[60:63]
    s_waitcnt lgkmcnt(10)
    v_mfma_f32_16x16x32_bf16 v[64:67], v[112:115], v[144:147], v[64:67]
    v_mfma_f32_16x16x32_bf16 v[68:71], v[112:115], v[148:151], v[68:71]
    s_waitcnt lgkmcnt(8)
    v_mfma_f32_16x16x32_bf16 v[72:75], v[116:119], v[144:147], v[72:75]
    v_mfma_f32_16x16x32_bf16 v[76:79], v[116:119], v[148:151], v[76:79]
    s_waitcnt lgkmcnt(6)
    v_mfma_f32_16x16x32_bf16 v[80:83], v[120:123], v[144:147], v[80:83]
    v_mfma_f32_16x16x32_bf16 v[84:87], v[120:123], v[148:151], v[84:87]
    s_waitcnt lgkmcnt(4)
    v_mfma_f32_16x16x32_bf16 v[88:91], v[124:127], v[144:147], v[88:91]
    v_mfma_f32_16x16x32_bf16 v[92:95], v[124:127], v[148:151], v[92:95]
    s_waitcnt lgkmcnt(2)
    v_mfma_f32_16x16x32_bf16 v[96:99], v[128:131], v[144:147], v[96:99]
    v_mfma_f32_16x16x32_bf16 v[100:103], v[128:131], v[148:151], v[100:103]
    s_waitcnt lgkmcnt(0)
    v_mfma_f32_16x16x32_bf16 v[104:107], v[132:135], v[144:147], v[104:107]
    v_mfma_f32_16x16x32_bf16 v[108:111], v[132:135], v[148:151], v[108:111]
    ds_read_b64_tr_b16 v[240:241], v244 offset:8192
    ds_read_b64_tr_b16 v[242:243], v244 offset:9216
    ds_read_b64_tr_b16 v[252:253], v245 offset:8192
    ds_read_b64_tr_b16 v[254:255], v245 offset:9216
    ds_read_b64_tr_b16 v[112:113], v246 offset:8192
    ds_read_b64_tr_b16 v[114:115], v246 offset:9216
    ds_read_b64_tr_b16 v[116:117], v247 offset:8192
    ds_read_b64_tr_b16 v[118:119], v247 offset:9216
    ds_read_b64_tr_b16 v[120:121], v248 offset:8192
    ds_read_b64_tr_b16 v[122:123], v248 offset:9216
    ds_read_b64_tr_b16 v[124:125], v249 offset:8192
    ds_read_b64_tr_b16 v[126:127], v249 offset:9216
    ds_read_b64_tr_b16 v[128:129], v250 offset:8192
    ds_read_b64_tr_b16 v[130:131], v250 offset:9216
    ds_read_b64_tr_b16 v[132:133], v251 offset:8192
    ds_read_b64_tr_b16 v[134:135], v251 offset:9216
    s_waitcnt lgkmcnt(14)
    v_mfma_f32_16x16x32_bf16 v[48:51], v[240:243], v[152:155], v[48:51]
    v_mfma_f32_16x16x32_bf16 v[52:55], v[240:243], v[156:159], v[52:55]
    s_waitcnt lgkmcnt(12)
    v_mfma_f32_16x16x32_bf16 v[56:59], v[252:255], v[152:155], v[56:59]
    v_mfma_f32_16x16x32_bf16 v[60:63], v[252:255], v[156:159], v[60:63]
    s_waitcnt lgkmcnt(10)
    v_mfma_f32_16x16x32_bf16 v[64:67], v[112:115], v[152:155], v[64:67]
    v_mfma_f32_16x16x32_bf16 v[68:71], v[112:115], v[156:159], v[68:71]
    s_waitcnt lgkmcnt(8)
    v_mfma_f32_16x16x32_bf16 v[72:75], v[116:119], v[152:155], v[72:75]
    v_mfma_f32_16x16x32_bf16 v[76:79], v[116:119], v[156:159], v[76:79]
    s_waitcnt lgkmcnt(6)
    v_mfma_f32_16x16x32_bf16 v[80:83], v[120:123], v[152:155], v[80:83]
    v_mfma_f32_16x16x32_bf16 v[84:87], v[120:123], v[156:159], v[84:87]
    s_waitcnt lgkmcnt(4)
    v_mfma_f32_16x16x32_bf16 v[88:91], v[124:127], v[152:155], v[88:91]
    v_mfma_f32_16x16x32_bf16 v[92:95], v[124:127], v[156:159], v[92:95]
    s_waitcnt lgkmcnt(2)
    v_mfma_f32_16x16x32_bf16 v[96:99], v[128:131], v[152:155], v[96:99]
    v_mfma_f32_16x16x32_bf16 v[100:103], v[128:131], v[156:159], v[100:103]
    s_waitcnt lgkmcnt(0)
    v_mfma_f32_16x16x32_bf16 v[104:107], v[132:135], v[152:155], v[104:107]
    v_mfma_f32_16x16x32_bf16 v[108:111], v[132:135], v[156:159], v[108:111]
    s_barrier
    s_cmp_eq_u32 s36, 4
    s_cbranch_scc0 L_sig5
    s_cmp_eq_u32 s86, 5
    s_cbranch_scc0 L_sig5
    v_mov_b32 v14, 1
    s_and_b32 s51, s2, 15
    s_lshl_b32 s51, s51, 2
    s_add_u32 s51, s51, 64
    v_mov_b32 v15, s51
    s_mov_b64 s[90:91], exec
    s_mov_b64 exec, 1
    buffer_atomic_add v14, v15, s[32:35], 0 offen
    s_mov_b64 exec, s[90:91]
L_sig5:
    s_lshl_b32 s52, s57, 18
    s_add_u32 s52, s52, s55
    s_add_u32 m0, s93, 24576
    s_nop 0
    buffer_load_dwordx4 v7, s[8:11], s52 offen offset:0 lds
    buffer_load_dwordx4 v8, s[8:11], s52 offen offset:1024 lds
    s_add_u32 s57, s57, 1
    s_cmp_eq_u32 s57, 20
    s_cselect_b32 s57, 0, s57
    s_lshl_b32 s52, s57, 18
    s_add_u32 s52, s52, s55
    s_add_u32 m0, s93, 0
    s_nop 0
    buffer_load_dwordx4 v7, s[8:11], s52 offen offset:0 lds
    buffer_load_dwordx4 v8, s[8:11], s52 offen offset:1024 lds
    s_add_u32 s57, s57, 1
    s_cmp_eq_u32 s57, 20
    s_cselect_b32 s57, 0, s57
    s_add_u32 s51, s41, 7
    s_and_b32 s51, s51, 15
    s_lshl_b32 s51, s51, 14
    s_add_u32 s51, s51, s43
    s_add_u32 m0, s45, 32768
    s_waitcnt vmcnt(8)
    buffer_load_dwordx4 v1, s[12:15], s51 offen offset:0 nt lds
    s_add_u32 s51, s41, 7
    s_and_b32 s51, s51, 15
    s_lshl_b32 s51, s51, 14
    s_add_u32 s51, s51, s43
    s_add_u32 m0, s45, 32768
    s_waitcnt vmcnt(8)
    buffer_load_dwordx4 v2, s[12:15], s51 offen offset:1024 nt lds
    s_add_u32 s51, s41, 7
    s_and_b32 s51, s51, 15
    s_lshl_b32 s51, s51, 14
    s_add_u32 s51, s51, s43
    s_add_u32 m0, s45, 32768
    s_waitcnt vmcnt(8)
    buffer_load_dwordx4 v3, s[12:15], s51 offen offset:2048 nt lds
    s_add_u32 s51, s41, 7
    s_and_b32 s51, s51, 15
    s_lshl_b32 s51, s51, 14
    s_add_u32 s51, s51, s43
    s_add_u32 m0, s45, 32768
    s_waitcnt vmcnt(8)
    buffer_load_dwordx4 v4, s[12:15], s51 offen offset:3072 nt lds
    s_add_u32 s51, s41, 7
    s_and_b32 s51, s51, 15
    s_lshl_b32 s51, s51, 14
    s_add_u32 s51, s51, s43
    s_add_u32 m0, s45, 49152
    s_waitcnt vmcnt(8)
    buffer_load_dwordx4 v5, s[16:19], s51 offen offset:0 nt lds
    s_add_u32 s51, s41, 7
    s_and_b32 s51, s51, 15
    s_lshl_b32 s51, s51, 14
    s_add_u32 s51, s51, s43
    s_add_u32 m0, s45, 49152
    s_waitcnt vmcnt(4)
    buffer_load_dwordx4 v6, s[16:19], s51 offen offset:1024 nt lds
    s_add_u32 s51, s41, 7
    s_and_b32 s51, s51, 15
    s_lshl_b32 s51, s51, 14
    s_add_u32 s51, s51, s43
    s_add_u32 m0, s45, 49152
    s_waitcnt vmcnt(4)
    buffer_load_dwordx4 v5, s[16:19], s51 offen offset:2048 nt lds
    s_add_u32 s51, s41, 7
    s_and_b32 s51, s51, 15
    s_lshl_b32 s51, s51, 14
    s_add_u32 s51, s51, s43
    s_add_u32 m0, s45, 49152
    s_waitcnt vmcnt(4)
    buffer_load_dwordx4 v6, s[16:19], s51 offen offset:3072 nt lds
    ds_read_b64_tr_b16 v[240:241], v244 offset:16384
    ds_read_b64_tr_b16 v[242:243], v244 offset:17408
    ds_read_b64_tr_b16 v[252:253], v245 offset:16384
    ds_read_b64_tr_b16 v[254:255], v245 offset:17408
    ds_read_b64_tr_b16 v[112:113], v246 offset:16384
    ds_read_b64_tr_b16 v[114:115], v246 offset:17408
    ds_read_b64_tr_b16 v[116:117], v247 offset:16384
    ds_read_b64_tr_b16 v[118:119], v247 offset:17408
    ds_read_b64_tr_b16 v[120:121], v248 offset:16384
    ds_read_b64_tr_b16 v[122:123], v248 offset:17408
    ds_read_b64_tr_b16 v[124:125], v249 offset:16384
    ds_read_b64_tr_b16 v[126:127], v249 offset:17408
    ds_read_b64_tr_b16 v[128:129], v250 offset:16384
    ds_read_b64_tr_b16 v[130:131], v250 offset:17408
    ds_read_b64_tr_b16 v[132:133], v251 offset:16384
    ds_read_b64_tr_b16 v[134:135], v251 offset:17408
    s_waitcnt lgkmcnt(14)
    v_mfma_f32_16x16x32_bf16 v[48:51], v[240:243], v[160:163], v[48:51]
    v_mfma_f32_16x16x32_bf16 v[52:55], v[240:243], v[164:167], v[52:55]
    s_waitcnt lgkmcnt(12)
    v_mfma_f32_16x16x32_bf16 v[56:59], v[252:255], v[160:163], v[56:59]
    v_mfma_f32_16x16x32_bf16 v[60:63], v[252:255], v[164:167], v[60:63]
    s_waitcnt lgkmcnt(10)
    v_mfma_f32_16x16x32_bf16 v[64:67], v[112:115], v[160:163], v[64:67]
    v_mfma_f32_16x16x32_bf16 v[68:71], v[112:115], v[164:167], v[68:71]
    s_waitcnt lgkmcnt(8)
    v_mfma_f32_16x16x32_bf16 v[72:75], v[116:119], v[160:163], v[72:75]
    v_mfma_f32_16x16x32_bf16 v[76:79], v[116:119], v[164:167], v[76:79]
    s_waitcnt lgkmcnt(6)
    v_mfma_f32_16x16x32_bf16 v[80:83], v[120:123], v[160:163], v[80:83]
    v_mfma_f32_16x16x32_bf16 v[84:87], v[120:123], v[164:167], v[84:87]
    s_waitcnt lgkmcnt(4)
    v_mfma_f32_16x16x32_bf16 v[88:91], v[124:127], v[160:163], v[88:91]
    v_mfma_f32_16x16x32_bf16 v[92:95], v[124:127], v[164:167], v[92:95]
    s_waitcnt lgkmcnt(2)
    v_mfma_f32_16x16x32_bf16 v[96:99], v[128:131], v[160:163], v[96:99]
    v_mfma_f32_16x16x32_bf16 v[100:103], v[128:131], v[164:167], v[100:103]
    s_waitcnt lgkmcnt(0)
    v_mfma_f32_16x16x32_bf16 v[104:107], v[132:135], v[160:163], v[104:107]
    v_mfma_f32_16x16x32_bf16 v[108:111], v[132:135], v[164:167], v[108:111]
    s_barrier
    s_cmp_eq_u32 s36, 4
    s_cbranch_scc0 L_sig6
    s_cmp_eq_u32 s86, 6
    s_cbranch_scc0 L_sig6
    v_mov_b32 v14, 1
    s_and_b32 s51, s2, 15
    s_lshl_b32 s51, s51, 2
    s_add_u32 s51, s51, 64
    v_mov_b32 v15, s51
    s_mov_b64 s[90:91], exec
    s_mov_b64 exec, 1
    buffer_atomic_add v14, v15, s[32:35], 0 offen
    s_mov_b64 exec, s[90:91]
L_sig6:
    s_lshl_b32 s52, s57, 18
    s_add_u32 s52, s52, s55
    s_add_u32 m0, s93, 8192
    s_nop 0
    buffer_load_dwordx4 v7, s[8:11], s52 offen offset:0 lds
    buffer_load_dwordx4 v8, s[8:11], s52 offen offset:1024 lds
    s_add_u32 s57, s57, 1
    s_cmp_eq_u32 s57, 20
    s_cselect_b32 s57, 0, s57
    s_add_u32 s51, s41, 8
    s_and_b32 s51, s51, 15
    s_lshl_b32 s51, s51, 14
    s_add_u32 s51, s51, s43
    s_add_u32 m0, s45, 65536
    s_waitcnt vmcnt(6)
    buffer_load_dwordx4 v1, s[12:15], s51 offen offset:0 nt lds
    s_add_u32 s51, s41, 8
    s_and_b32 s51, s51, 15
    s_lshl_b32 s51, s51, 14
    s_add_u32 s51, s51, s43
    s_add_u32 m0, s45, 65536
    s_waitcnt vmcnt(6)
    buffer_load_dwordx4 v2, s[12:15], s51 offen offset:1024 nt lds
    s_add_u32 s51, s41, 8
    s_and_b32 s51, s51, 15
    s_lshl_b32 s51, s51, 14
    s_add_u32 s51, s51, s43
    s_add_u32 m0, s45, 65536
    s_waitcnt vmcnt(6)
    buffer_load_dwordx4 v3, s[12:15], s51 offen offset:2048 nt lds
    s_add_u32 s51, s41, 8
    s_and_b32 s51, s51, 15
    s_lshl_b32 s51, s51, 14
    s_add_u32 s51, s51, s43
    s_add_u32 m0, s45, 65536
    s_waitcnt vmcnt(6)
    buffer_load_dwordx4 v4, s[12:15], s51 offen offset:3072 nt lds
    s_add_u32 s51, s41, 8
    s_and_b32 s51, s51, 15
    s_lshl_b32 s51, s51, 14
    s_add_u32 s51, s51, s43
    s_add_u32 m0, s45, 81920
    s_waitcnt vmcnt(6)
    buffer_load_dwordx4 v5, s[16:19], s51 offen offset:0 nt lds
    s_add_u32 s51, s41, 8
    s_and_b32 s51, s51, 15
    s_lshl_b32 s51, s51, 14
    s_add_u32 s51, s51, s43
    s_add_u32 m0, s45, 81920
    s_waitcnt vmcnt(4)
    buffer_load_dwordx4 v6, s[16:19], s51 offen offset:1024 nt lds
    s_add_u32 s51, s41, 8
    s_and_b32 s51, s51, 15
    s_lshl_b32 s51, s51, 14
    s_add_u32 s51, s51, s43
    s_add_u32 m0, s45, 81920
    s_waitcnt vmcnt(4)
    buffer_load_dwordx4 v5, s[16:19], s51 offen offset:2048 nt lds
    s_add_u32 s51, s41, 8
    s_and_b32 s51, s51, 15
    s_lshl_b32 s51, s51, 14
    s_add_u32 s51, s51, s43
    s_add_u32 m0, s45, 81920
    s_waitcnt vmcnt(4)
    buffer_load_dwordx4 v6, s[16:19], s51 offen offset:3072 nt lds
    ds_read_b64_tr_b16 v[240:241], v244 offset:24576
    ds_read_b64_tr_b16 v[242:243], v244 offset:25600
    ds_read_b64_tr_b16 v[252:253], v245 offset:24576
    ds_read_b64_tr_b16 v[254:255], v245 offset:25600
    ds_read_b64_tr_b16 v[112:113], v246 offset:24576
    ds_read_b64_tr_b16 v[114:115], v246 offset:25600
    ds_read_b64_tr_b16 v[116:117], v247 offset:24576
    ds_read_b64_tr_b16 v[118:119], v247 offset:25600
    ds_read_b64_tr_b16 v[120:121], v248 offset:24576
    ds_read_b64_tr_b16 v[122:123], v248 offset:25600
    ds_read_b64_tr_b16 v[124:125], v249 offset:24576
    ds_read_b64_tr_b16 v[126:127], v249 offset:25600
    ds_read_b64_tr_b16 v[128:129], v250 offset:24576
    ds_read_b64_tr_b16 v[130:131], v250 offset:25600
    ds_read_b64_tr_b16 v[132:133], v251 offset:24576
    ds_read_b64_tr_b16 v[134:135], v251 offset:25600
    s_waitcnt lgkmcnt(14)
    v_mfma_f32_16x16x32_bf16 v[48:51], v[240:243], v[168:171], v[48:51]
    v_mfma_f32_16x16x32_bf16 v[52:55], v[240:243], v[172:175], v[52:55]
    s_waitcnt lgkmcnt(12)
    v_mfma_f32_16x16x32_bf16 v[56:59], v[252:255], v[168:171], v[56:59]
    v_mfma_f32_16x16x32_bf16 v[60:63], v[252:255], v[172:175], v[60:63]
    s_waitcnt lgkmcnt(10)
    v_mfma_f32_16x16x32_bf16 v[64:67], v[112:115], v[168:171], v[64:67]
    v_mfma_f32_16x16x32_bf16 v[68:71], v[112:115], v[172:175], v[68:71]
    s_waitcnt lgkmcnt(8)
    v_mfma_f32_16x16x32_bf16 v[72:75], v[116:119], v[168:171], v[72:75]
    v_mfma_f32_16x16x32_bf16 v[76:79], v[116:119], v[172:175], v[76:79]
    s_waitcnt lgkmcnt(6)
    v_mfma_f32_16x16x32_bf16 v[80:83], v[120:123], v[168:171], v[80:83]
    v_mfma_f32_16x16x32_bf16 v[84:87], v[120:123], v[172:175], v[84:87]
    s_waitcnt lgkmcnt(4)
    v_mfma_f32_16x16x32_bf16 v[88:91], v[124:127], v[168:171], v[88:91]
    v_mfma_f32_16x16x32_bf16 v[92:95], v[124:127], v[172:175], v[92:95]
    s_waitcnt lgkmcnt(2)
    v_mfma_f32_16x16x32_bf16 v[96:99], v[128:131], v[168:171], v[96:99]
    v_mfma_f32_16x16x32_bf16 v[100:103], v[128:131], v[172:175], v[100:103]
    s_waitcnt lgkmcnt(0)
    v_mfma_f32_16x16x32_bf16 v[104:107], v[132:135], v[168:171], v[104:107]
    v_mfma_f32_16x16x32_bf16 v[108:111], v[132:135], v[172:175], v[108:111]
    ds_read_b64_tr_b16 v[240:241], v244 offset:0
    ds_read_b64_tr_b16 v[242:243], v244 offset:1024
    ds_read_b64_tr_b16 v[252:253], v245 offset:0
    ds_read_b64_tr_b16 v[254:255], v245 offset:1024
    ds_read_b64_tr_b16 v[112:113], v246 offset:0
    ds_read_b64_tr_b16 v[114:115], v246 offset:1024
    ds_read_b64_tr_b16 v[116:117], v247 offset:0
    ds_read_b64_tr_b16 v[118:119], v247 offset:1024
    ds_read_b64_tr_b16 v[120:121], v248 offset:0
    ds_read_b64_tr_b16 v[122:123], v248 offset:1024
    ds_read_b64_tr_b16 v[124:125], v249 offset:0
    ds_read_b64_tr_b16 v[126:127], v249 offset:1024
    ds_read_b64_tr_b16 v[128:129], v250 offset:0
    ds_read_b64_tr_b16 v[130:131], v250 offset:1024
    ds_read_b64_tr_b16 v[132:133], v251 offset:0
    ds_read_b64_tr_b16 v[134:135], v251 offset:1024
    s_waitcnt lgkmcnt(14)
    v_mfma_f32_16x16x32_bf16 v[48:51], v[240:243], v[176:179], v[48:51]
    v_mfma_f32_16x16x32_bf16 v[52:55], v[240:243], v[180:183], v[52:55]
    s_waitcnt lgkmcnt(12)
    v_mfma_f32_16x16x32_bf16 v[56:59], v[252:255], v[176:179], v[56:59]
    v_mfma_f32_16x16x32_bf16 v[60:63], v[252:255], v[180:183], v[60:63]
    s_waitcnt lgkmcnt(10)
    v_mfma_f32_16x16x32_bf16 v[64:67], v[112:115], v[176:179], v[64:67]
    v_mfma_f32_16x16x32_bf16 v[68:71], v[112:115], v[180:183], v[68:71]
    s_waitcnt lgkmcnt(8)
    v_mfma_f32_16x16x32_bf16 v[72:75], v[116:119], v[176:179], v[72:75]
    v_mfma_f32_16x16x32_bf16 v[76:79], v[116:119], v[180:183], v[76:79]
    s_waitcnt lgkmcnt(6)
    v_mfma_f32_16x16x32_bf16 v[80:83], v[120:123], v[176:179], v[80:83]
    v_mfma_f32_16x16x32_bf16 v[84:87], v[120:123], v[180:183], v[84:87]
    s_waitcnt lgkmcnt(4)
    v_mfma_f32_16x16x32_bf16 v[88:91], v[124:127], v[176:179], v[88:91]
    v_mfma_f32_16x16x32_bf16 v[92:95], v[124:127], v[180:183], v[92:95]
    s_waitcnt lgkmcnt(2)
    v_mfma_f32_16x16x32_bf16 v[96:99], v[128:131], v[176:179], v[96:99]
    v_mfma_f32_16x16x32_bf16 v[100:103], v[128:131], v[180:183], v[100:103]
    s_waitcnt lgkmcnt(0)
    v_mfma_f32_16x16x32_bf16 v[104:107], v[132:135], v[176:179], v[104:107]
    v_mfma_f32_16x16x32_bf16 v[108:111], v[132:135], v[180:183], v[108:111]
    s_barrier
    s_cmp_eq_u32 s36, 4
    s_cbranch_scc0 L_sig7
    s_cmp_eq_u32 s86, 7
    s_cbranch_scc0 L_sig7
    v_mov_b32 v14, 1
    s_and_b32 s51, s2, 15
    s_lshl_b32 s51, s51, 2
    s_add_u32 s51, s51, 64
    v_mov_b32 v15, s51
    s_mov_b64 s[90:91], exec
    s_mov_b64 exec, 1
    buffer_atomic_add v14, v15, s[32:35], 0 offen
    s_mov_b64 exec, s[90:91]
L_sig7:
    s_lshl_b32 s52, s57, 18
    s_add_u32 s52, s52, s55
    s_add_u32 m0, s93, 16384
    s_nop 0
    buffer_load_dwordx4 v7, s[8:11], s52 offen offset:0 lds
    buffer_load_dwordx4 v8, s[8:11], s52 offen offset:1024 lds
    s_add_u32 s57, s57, 1
    s_cmp_eq_u32 s57, 20
    s_cselect_b32 s57, 0, s57
    s_lshl_b32 s52, s57, 18
    s_add_u32 s52, s52, s55
    s_add_u32 m0, s93, 24576
    s_nop 0
    buffer_load_dwordx4 v7, s[8:11], s52 offen offset:0 lds
    buffer_load_dwordx4 v8, s[8:11], s52 offen offset:1024 lds
    s_add_u32 s57, s57, 1
    s_cmp_eq_u32 s57, 20
    s_cselect_b32 s57, 0, s57
    s_add_u32 s51, s41, 9
    s_and_b32 s51, s51, 15
    s_lshl_b32 s51, s51, 14
    s_add_u32 s51, s51, s43
    s_add_u32 m0, s45, 0
    s_waitcnt vmcnt(8)
    buffer_load_dwordx4 v1, s[12:15], s51 offen offset:0 nt lds
    s_add_u32 s51, s41, 9
    s_and_b32 s51, s51, 15
    s_lshl_b32 s51, s51, 14
    s_add_u32 s51, s51, s43
    s_add_u32 m0, s45, 0
    s_waitcnt vmcnt(8)
    buffer_load_dwordx4 v2, s[12:15], s51 offen offset:1024 nt lds
    s_add_u32 s51, s41, 9
    s_and_b32 s51, s51, 15
    s_lshl_b32 s51, s51, 14
    s_add_u32 s51, s51, s43
    s_add_u32 m0, s45, 0
    s_waitcnt vmcnt(8)
    buffer_load_dwordx4 v3, s[12:15], s51 offen offset:2048 nt lds
    s_add_u32 s51, s41, 9
    s_and_b32 s51, s51, 15
    s_lshl_b32 s51, s51, 14
    s_add_u32 s51, s51, s43
    s_add_u32 m0, s45, 0
    s_waitcnt vmcnt(8)
    buffer_load_dwordx4 v4, s[12:15], s51 offen offset:3072 nt lds
    s_add_u32 s51, s41, 9
    s_and_b32 s51, s51, 15
    s_lshl_b32 s51, s51, 14
    s_add_u32 s51, s51, s43
    s_add_u32 m0, s45, 16384
    s_waitcnt vmcnt(8)
    buffer_load_dwordx4 v5, s[16:19], s51 offen offset:0 nt lds
    s_add_u32 s51, s41, 9
    s_and_b32 s51, s51, 15
    s_lshl_b32 s51, s51, 14
    s_add_u32 s51, s51, s43
    s_add_u32 m0, s45, 16384
    s_waitcnt vmcnt(4)
    buffer_load_dwordx4 v6, s[16:19], s51 offen offset:1024 nt lds
    s_add_u32 s51, s41, 9
    s_and_b32 s51, s51, 15
    s_lshl_b32 s51, s51, 14
    s_add_u32 s51, s51, s43
    s_add_u32 m0, s45, 16384
    s_waitcnt vmcnt(4)
    buffer_load_dwordx4 v5, s[16:19], s51 offen offset:2048 nt lds
    s_add_u32 s51, s41, 9
    s_and_b32 s51, s51, 15
    s_lshl_b32 s51, s51, 14
    s_add_u32 s51, s51, s43
    s_add_u32 m0, s45, 16384
    s_waitcnt vmcnt(4)
    buffer_load_dwordx4 v6, s[16:19], s51 offen offset:3072 nt lds
    ds_read_b64_tr_b16 v[240:241], v244 offset:8192
    ds_read_b64_tr_b16 v[242:243], v244 offset:9216
    ds_read_b64_tr_b16 v[252:253], v245 offset:8192
    ds_read_b64_tr_b16 v[254:255], v245 offset:9216
    ds_read_b64_tr_b16 v[112:113], v246 offset:8192
    ds_read_b64_tr_b16 v[114:115], v246 offset:9216
    ds_read_b64_tr_b16 v[116:117], v247 offset:8192
    ds_read_b64_tr_b16 v[118:119], v247 offset:9216
    ds_read_b64_tr_b16 v[120:121], v248 offset:8192
    ds_read_b64_tr_b16 v[122:123], v248 offset:9216
    ds_read_b64_tr_b16 v[124:125], v249 offset:8192
    ds_read_b64_tr_b16 v[126:127], v249 offset:9216
    ds_read_b64_tr_b16 v[128:129], v250 offset:8192
    ds_read_b64_tr_b16 v[130:131], v250 offset:9216
    ds_read_b64_tr_b16 v[132:133], v251 offset:8192
    ds_read_b64_tr_b16 v[134:135], v251 offset:9216
    s_waitcnt lgkmcnt(14)
    v_mfma_f32_16x16x32_bf16 v[48:51], v[240:243], v[184:187], v[48:51]
    v_mfma_f32_16x16x32_bf16 v[52:55], v[240:243], v[188:191], v[52:55]
    s_waitcnt lgkmcnt(12)
    v_mfma_f32_16x16x32_bf16 v[56:59], v[252:255], v[184:187], v[56:59]
    v_mfma_f32_16x16x32_bf16 v[60:63], v[252:255], v[188:191], v[60:63]
    s_waitcnt lgkmcnt(10)
    v_mfma_f32_16x16x32_bf16 v[64:67], v[112:115], v[184:187], v[64:67]
    v_mfma_f32_16x16x32_bf16 v[68:71], v[112:115], v[188:191], v[68:71]
    s_waitcnt lgkmcnt(8)
    v_mfma_f32_16x16x32_bf16 v[72:75], v[116:119], v[184:187], v[72:75]
    v_mfma_f32_16x16x32_bf16 v[76:79], v[116:119], v[188:191], v[76:79]
    s_waitcnt lgkmcnt(6)
    v_mfma_f32_16x16x32_bf16 v[80:83], v[120:123], v[184:187], v[80:83]
    v_mfma_f32_16x16x32_bf16 v[84:87], v[120:123], v[188:191], v[84:87]
    s_waitcnt lgkmcnt(4)
    v_mfma_f32_16x16x32_bf16 v[88:91], v[124:127], v[184:187], v[88:91]
    v_mfma_f32_16x16x32_bf16 v[92:95], v[124:127], v[188:191], v[92:95]
    s_waitcnt lgkmcnt(2)
    v_mfma_f32_16x16x32_bf16 v[96:99], v[128:131], v[184:187], v[96:99]
    v_mfma_f32_16x16x32_bf16 v[100:103], v[128:131], v[188:191], v[100:103]
    s_waitcnt lgkmcnt(0)
    v_mfma_f32_16x16x32_bf16 v[104:107], v[132:135], v[184:187], v[104:107]
    v_mfma_f32_16x16x32_bf16 v[108:111], v[132:135], v[188:191], v[108:111]
    s_barrier
    s_cmp_eq_u32 s36, 4
    s_cbranch_scc0 L_sig8
    s_cmp_eq_u32 s86, 8
    s_cbranch_scc0 L_sig8
    v_mov_b32 v14, 1
    s_and_b32 s51, s2, 15
    s_lshl_b32 s51, s51, 2
    s_add_u32 s51, s51, 64
    v_mov_b32 v15, s51
    s_mov_b64 s[90:91], exec
    s_mov_b64 exec, 1
    buffer_atomic_add v14, v15, s[32:35], 0 offen
    s_mov_b64 exec, s[90:91]
L_sig8:
    s_lshl_b32 s52, s57, 18
    s_add_u32 s52, s52, s55
    s_add_u32 m0, s93, 0
    s_nop 0
    buffer_load_dwordx4 v7, s[8:11], s52 offen offset:0 lds
    buffer_load_dwordx4 v8, s[8:11], s52 offen offset:1024 lds
    s_add_u32 s57, s57, 1
    s_cmp_eq_u32 s57, 20
    s_cselect_b32 s57, 0, s57
    s_add_u32 s51, s41, 10
    s_and_b32 s51, s51, 15
    s_lshl_b32 s51, s51, 14
    s_add_u32 s51, s51, s43
    s_add_u32 m0, s45, 32768
    s_waitcnt vmcnt(6)
    buffer_load_dwordx4 v1, s[12:15], s51 offen offset:0 nt lds
    s_add_u32 s51, s41, 10
    s_and_b32 s51, s51, 15
    s_lshl_b32 s51, s51, 14
    s_add_u32 s51, s51, s43
    s_add_u32 m0, s45, 32768
    s_waitcnt vmcnt(6)
    buffer_load_dwordx4 v2, s[12:15], s51 offen offset:1024 nt lds
    s_add_u32 s51, s41, 10
    s_and_b32 s51, s51, 15
    s_lshl_b32 s51, s51, 14
    s_add_u32 s51, s51, s43
    s_add_u32 m0, s45, 32768
    s_waitcnt vmcnt(6)
    buffer_load_dwordx4 v3, s[12:15], s51 offen offset:2048 nt lds
    s_add_u32 s51, s41, 10
    s_and_b32 s51, s51, 15
    s_lshl_b32 s51, s51, 14
    s_add_u32 s51, s51, s43
    s_add_u32 m0, s45, 32768
    s_waitcnt vmcnt(6)
    buffer_load_dwordx4 v4, s[12:15], s51 offen offset:3072 nt lds
    s_add_u32 s51, s41, 10
    s_and_b32 s51, s51, 15
    s_lshl_b32 s51, s51, 14
    s_add_u32 s51, s51, s43
    s_add_u32 m0, s45, 49152
    s_waitcnt vmcnt(6)
    buffer_load_dwordx4 v5, s[16:19], s51 offen offset:0 nt lds
    s_add_u32 s51, s41, 10
    s_and_b32 s51, s51, 15
    s_lshl_b32 s51, s51, 14
    s_add_u32 s51, s51, s43
    s_add_u32 m0, s45, 49152
    s_waitcnt vmcnt(4)
    buffer_load_dwordx4 v6, s[16:19], s51 offen offset:1024 nt lds
    s_add_u32 s51, s41, 10
    s_and_b32 s51, s51, 15
    s_lshl_b32 s51, s51, 14
    s_add_u32 s51, s51, s43
    s_add_u32 m0, s45, 49152
    s_waitcnt vmcnt(4)
    buffer_load_dwordx4 v5, s[16:19], s51 offen offset:2048 nt lds
    s_add_u32 s51, s41, 10
    s_and_b32 s51, s51, 15
    s_lshl_b32 s51, s51, 14
    s_add_u32 s51, s51, s43
    s_add_u32 m0, s45, 49152
    s_waitcnt vmcnt(4)
    buffer_load_dwordx4 v6, s[16:19], s51 offen offset:3072 nt lds
    ds_read_b64_tr_b16 v[240:241], v244 offset:16384
    ds_read_b64_tr_b16 v[242:243], v244 offset:17408
    ds_read_b64_tr_b16 v[252:253], v245 offset:16384
    ds_read_b64_tr_b16 v[254:255], v245 offset:17408
    ds_read_b64_tr_b16 v[112:113], v246 offset:16384
    ds_read_b64_tr_b16 v[114:115], v246 offset:17408
    ds_read_b64_tr_b16 v[116:117], v247 offset:16384
    ds_read_b64_tr_b16 v[118:119], v247 offset:17408
    ds_read_b64_tr_b16 v[120:121], v248 offset:16384
    ds_read_b64_tr_b16 v[122:123], v248 offset:17408
    ds_read_b64_tr_b16 v[124:125], v249 offset:16384
    ds_read_b64_tr_b16 v[126:127], v249 offset:17408
    ds_read_b64_tr_b16 v[128:129], v250 offset:16384
    ds_read_b64_tr_b16 v[130:131], v250 offset:17408
    ds_read_b64_tr_b16 v[132:133], v251 offset:16384
    ds_read_b64_tr_b16 v[134:135], v251 offset:17408
    s_waitcnt lgkmcnt(14)
    v_mfma_f32_16x16x32_bf16 v[48:51], v[240:243], v[192:195], v[48:51]
    v_mfma_f32_16x16x32_bf16 v[52:55], v[240:243], v[196:199], v[52:55]
    s_waitcnt lgkmcnt(12)
    v_mfma_f32_16x16x32_bf16 v[56:59], v[252:255], v[192:195], v[56:59]
    v_mfma_f32_16x16x32_bf16 v[60:63], v[252:255], v[196:199], v[60:63]
    s_waitcnt lgkmcnt(10)
    v_mfma_f32_16x16x32_bf16 v[64:67], v[112:115], v[192:195], v[64:67]
    v_mfma_f32_16x16x32_bf16 v[68:71], v[112:115], v[196:199], v[68:71]
    s_waitcnt lgkmcnt(8)
    v_mfma_f32_16x16x32_bf16 v[72:75], v[116:119], v[192:195], v[72:75]
    v_mfma_f32_16x16x32_bf16 v[76:79], v[116:119], v[196:199], v[76:79]
    s_waitcnt lgkmcnt(6)
    v_mfma_f32_16x16x32_bf16 v[80:83], v[120:123], v[192:195], v[80:83]
    v_mfma_f32_16x16x32_bf16 v[84:87], v[120:123], v[196:199], v[84:87]
    s_waitcnt lgkmcnt(4)
    v_mfma_f32_16x16x32_bf16 v[88:91], v[124:127], v[192:195], v[88:91]
    v_mfma_f32_16x16x32_bf16 v[92:95], v[124:127], v[196:199], v[92:95]
    s_waitcnt lgkmcnt(2)
    v_mfma_f32_16x16x32_bf16 v[96:99], v[128:131], v[192:195], v[96:99]
    v_mfma_f32_16x16x32_bf16 v[100:103], v[128:131], v[196:199], v[100:103]
    s_waitcnt lgkmcnt(0)
    v_mfma_f32_16x16x32_bf16 v[104:107], v[132:135], v[192:195], v[104:107]
    v_mfma_f32_16x16x32_bf16 v[108:111], v[132:135], v[196:199], v[108:111]
    ds_read_b64_tr_b16 v[240:241], v244 offset:24576
    ds_read_b64_tr_b16 v[242:243], v244 offset:25600
    ds_read_b64_tr_b16 v[252:253], v245 offset:24576
    ds_read_b64_tr_b16 v[254:255], v245 offset:25600
    ds_read_b64_tr_b16 v[112:113], v246 offset:24576
    ds_read_b64_tr_b16 v[114:115], v246 offset:25600
    ds_read_b64_tr_b16 v[116:117], v247 offset:24576
    ds_read_b64_tr_b16 v[118:119], v247 offset:25600
    ds_read_b64_tr_b16 v[120:121], v248 offset:24576
    ds_read_b64_tr_b16 v[122:123], v248 offset:25600
    ds_read_b64_tr_b16 v[124:125], v249 offset:24576
    ds_read_b64_tr_b16 v[126:127], v249 offset:25600
    ds_read_b64_tr_b16 v[128:129], v250 offset:24576
    ds_read_b64_tr_b16 v[130:131], v250 offset:25600
    ds_read_b64_tr_b16 v[132:133], v251 offset:24576
    ds_read_b64_tr_b16 v[134:135], v251 offset:25600
    s_waitcnt lgkmcnt(14)
    v_mfma_f32_16x16x32_bf16 v[48:51], v[240:243], v[200:203], v[48:51]
    v_mfma_f32_16x16x32_bf16 v[52:55], v[240:243], v[204:207], v[52:55]
    s_waitcnt lgkmcnt(12)
    v_mfma_f32_16x16x32_bf16 v[56:59], v[252:255], v[200:203], v[56:59]
    v_mfma_f32_16x16x32_bf16 v[60:63], v[252:255], v[204:207], v[60:63]
    s_waitcnt lgkmcnt(10)
    v_mfma_f32_16x16x32_bf16 v[64:67], v[112:115], v[200:203], v[64:67]
    v_mfma_f32_16x16x32_bf16 v[68:71], v[112:115], v[204:207], v[68:71]
    s_waitcnt lgkmcnt(8)
    v_mfma_f32_16x16x32_bf16 v[72:75], v[116:119], v[200:203], v[72:75]
    v_mfma_f32_16x16x32_bf16 v[76:79], v[116:119], v[204:207], v[76:79]
    s_waitcnt lgkmcnt(6)
    v_mfma_f32_16x16x32_bf16 v[80:83], v[120:123], v[200:203], v[80:83]
    v_mfma_f32_16x16x32_bf16 v[84:87], v[120:123], v[204:207], v[84:87]
    s_waitcnt lgkmcnt(4)
    v_mfma_f32_16x16x32_bf16 v[88:91], v[124:127], v[200:203], v[88:91]
    v_mfma_f32_16x16x32_bf16 v[92:95], v[124:127], v[204:207], v[92:95]
    s_waitcnt lgkmcnt(2)
    v_mfma_f32_16x16x32_bf16 v[96:99], v[128:131], v[200:203], v[96:99]
    v_mfma_f32_16x16x32_bf16 v[100:103], v[128:131], v[204:207], v[100:103]
    s_waitcnt lgkmcnt(0)
    v_mfma_f32_16x16x32_bf16 v[104:107], v[132:135], v[200:203], v[104:107]
    v_mfma_f32_16x16x32_bf16 v[108:111], v[132:135], v[204:207], v[108:111]
    s_barrier
    s_and_b32 s51, s62, 3
    s_add_u32 s51, s51, s36
    s_lshl_b32 s52, s37, 4
    s_add_u32 s51, s51, s52
    s_cmp_eq_u32 s51, 4
    s_cbranch_scc0 L_cfi9
    buffer_load_dword v9, v10, s[32:35], 0 offen sc1
L_cfi9:
    s_lshl_b32 s52, s57, 18
    s_add_u32 s52, s52, s55
    s_add_u32 m0, s93, 8192
    s_nop 0
    buffer_load_dwordx4 v7, s[8:11], s52 offen offset:0 lds
    buffer_load_dwordx4 v8, s[8:11], s52 offen offset:1024 lds
    s_add_u32 s57, s57, 1
    s_cmp_eq_u32 s57, 20
    s_cselect_b32 s57, 0, s57
    s_lshl_b32 s52, s57, 18
    s_add_u32 s52, s52, s55
    s_add_u32 m0, s93, 16384
    s_nop 0
    buffer_load_dwordx4 v7, s[8:11], s52 offen offset:0 lds
    buffer_load_dwordx4 v8, s[8:11], s52 offen offset:1024 lds
    s_add_u32 s57, s57, 1
    s_cmp_eq_u32 s57, 20
    s_cselect_b32 s57, 0, s57
    s_add_u32 s51, s41, 11
    s_and_b32 s51, s51, 15
    s_lshl_b32 s51, s51, 14
    s_add_u32 s51, s51, s43
    s_add_u32 m0, s45, 65536
    s_waitcnt vmcnt(8)
    buffer_load_dwordx4 v1, s[12:15], s51 offen offset:0 nt lds
    s_add_u32 s51, s41, 11
    s_and_b32 s51, s51, 15
    s_lshl_b32 s51, s51, 14
    s_add_u32 s51, s51, s43
    s_add_u32 m0, s45, 65536
    s_waitcnt vmcnt(8)
    buffer_load_dwordx4 v2, s[12:15], s51 offen offset:1024 nt lds
    s_add_u32 s51, s41, 11
    s_and_b32 s51, s51, 15
    s_lshl_b32 s51, s51, 14
    s_add_u32 s51, s51, s43
    s_add_u32 m0, s45, 65536
    s_waitcnt vmcnt(8)
    buffer_load_dwordx4 v3, s[12:15], s51 offen offset:2048 nt lds
    s_add_u32 s51, s41, 11
    s_and_b32 s51, s51, 15
    s_lshl_b32 s51, s51, 14
    s_add_u32 s51, s51, s43
    s_add_u32 m0, s45, 65536
    s_waitcnt vmcnt(8)
    buffer_load_dwordx4 v4, s[12:15], s51 offen offset:3072 nt lds
    s_add_u32 s51, s41, 11
    s_and_b32 s51, s51, 15
    s_lshl_b32 s51, s51, 14
    s_add_u32 s51, s51, s43
    s_add_u32 m0, s45, 81920
    s_waitcnt vmcnt(8)
    buffer_load_dwordx4 v5, s[16:19], s51 offen offset:0 nt lds
    s_add_u32 s51, s41, 11
    s_and_b32 s51, s51, 15
    s_lshl_b32 s51, s51, 14
    s_add_u32 s51, s51, s43
    s_add_u32 m0, s45, 81920
    s_waitcnt vmcnt(4)
    buffer_load_dwordx4 v6, s[16:19], s51 offen offset:1024 nt lds
    s_add_u32 s51, s41, 11
    s_and_b32 s51, s51, 15
    s_lshl_b32 s51, s51, 14
    s_add_u32 s51, s51, s43
    s_add_u32 m0, s45, 81920
    s_waitcnt vmcnt(4)
    buffer_load_dwordx4 v5, s[16:19], s51 offen offset:2048 nt lds
    s_add_u32 s51, s41, 11
    s_and_b32 s51, s51, 15
    s_lshl_b32 s51, s51, 14
    s_add_u32 s51, s51, s43
    s_add_u32 m0, s45, 81920
    s_waitcnt vmcnt(4)
    buffer_load_dwordx4 v6, s[16:19], s51 offen offset:3072 nt lds
    ds_read_b64_tr_b16 v[240:241], v244 offset:0
    ds_read_b64_tr_b16 v[242:243], v244 offset:1024
    ds_read_b64_tr_b16 v[252:253], v245 offset:0
    ds_read_b64_tr_b16 v[254:255], v245 offset:1024
    ds_read_b64_tr_b16 v[112:113], v246 offset:0
    ds_read_b64_tr_b16 v[114:115], v246 offset:1024
    ds_read_b64_tr_b16 v[116:117], v247 offset:0
    ds_read_b64_tr_b16 v[118:119], v247 offset:1024
    ds_read_b64_tr_b16 v[120:121], v248 offset:0
    ds_read_b64_tr_b16 v[122:123], v248 offset:1024
    ds_read_b64_tr_b16 v[124:125], v249 offset:0
    ds_read_b64_tr_b16 v[126:127], v249 offset:1024
    ds_read_b64_tr_b16 v[128:129], v250 offset:0
    ds_read_b64_tr_b16 v[130:131], v250 offset:1024
    ds_read_b64_tr_b16 v[132:133], v251 offset:0
    ds_read_b64_tr_b16 v[134:135], v251 offset:1024
    s_waitcnt lgkmcnt(14)
    v_mfma_f32_16x16x32_bf16 v[48:51], v[240:243], v[208:211], v[48:51]
    v_mfma_f32_16x16x32_bf16 v[52:55], v[240:243], v[212:215], v[52:55]
    s_waitcnt lgkmcnt(12)
    v_mfma_f32_16x16x32_bf16 v[56:59], v[252:255], v[208:211], v[56:59]
    v_mfma_f32_16x16x32_bf16 v[60:63], v[252:255], v[212:215], v[60:63]
    s_waitcnt lgkmcnt(10)
    v_mfma_f32_16x16x32_bf16 v[64:67], v[112:115], v[208:211], v[64:67]
    v_mfma_f32_16x16x32_bf16 v[68:71], v[112:115], v[212:215], v[68:71]
    s_waitcnt lgkmcnt(8)
    v_mfma_f32_16x16x32_bf16 v[72:75], v[116:119], v[208:211], v[72:75]
    v_mfma_f32_16x16x32_bf16 v[76:79], v[116:119], v[212:215], v[76:79]
    s_waitcnt lgkmcnt(6)
    v_mfma_f32_16x16x32_bf16 v[80:83], v[120:123], v[208:211], v[80:83]
    v_mfma_f32_16x16x32_bf16 v[84:87], v[120:123], v[212:215], v[84:87]
    s_waitcnt lgkmcnt(4)
    v_mfma_f32_16x16x32_bf16 v[88:91], v[124:127], v[208:211], v[88:91]
    v_mfma_f32_16x16x32_bf16 v[92:95], v[124:127], v[212:215], v[92:95]
    s_waitcnt lgkmcnt(2)
    v_mfma_f32_16x16x32_bf16 v[96:99], v[128:131], v[208:211], v[96:99]
    v_mfma_f32_16x16x32_bf16 v[100:103], v[128:131], v[212:215], v[100:103]
    s_waitcnt lgkmcnt(0)
    v_mfma_f32_16x16x32_bf16 v[104:107], v[132:135], v[208:211], v[104:107]
    v_mfma_f32_16x16x32_bf16 v[108:111], v[132:135], v[212:215], v[108:111]
    s_barrier
    s_and_b32 s51, s62, 3
    s_add_u32 s51, s51, s36
    s_lshl_b32 s52, s37, 4
    s_add_u32 s51, s51, s52
    s_cmp_eq_u32 s51, 5
    s_cbranch_scc0 L_cfi10
    buffer_load_dword v9, v10, s[32:35], 0 offen sc1
L_cfi10:
    s_lshl_b32 s52, s57, 18
    s_add_u32 s52, s52, s55
    s_add_u32 m0, s93, 24576
    s_nop 0
    buffer_load_dwordx4 v7, s[8:11], s52 offen offset:0 lds
    buffer_load_dwordx4 v8, s[8:11], s52 offen offset:1024 lds
    s_add_u32 s57, s57, 1
    s_cmp_eq_u32 s57, 20
    s_cselect_b32 s57, 0, s57
    s_add_u32 s51, s41, 12
    s_and_b32 s51, s51, 15
    s_lshl_b32 s51, s51, 14
    s_add_u32 s51, s51, s43
    s_add_u32 m0, s45, 0
    s_waitcnt vmcnt(6)
    buffer_load_dwordx4 v1, s[12:15], s51 offen offset:0 nt lds
    s_add_u32 s51, s41, 12
    s_and_b32 s51, s51, 15
    s_lshl_b32 s51, s51, 14
    s_add_u32 s51, s51, s43
    s_add_u32 m0, s45, 0
    s_waitcnt vmcnt(6)
    buffer_load_dwordx4 v2, s[12:15], s51 offen offset:1024 nt lds
    s_add_u32 s51, s41, 12
    s_and_b32 s51, s51, 15
    s_lshl_b32 s51, s51, 14
    s_add_u32 s51, s51, s43
    s_add_u32 m0, s45, 0
    s_waitcnt vmcnt(6)
    buffer_load_dwordx4 v3, s[12:15], s51 offen offset:2048 nt lds
    s_add_u32 s51, s41, 12
    s_and_b32 s51, s51, 15
    s_lshl_b32 s51, s51, 14
    s_add_u32 s51, s51, s43
    s_add_u32 m0, s45, 0
    s_waitcnt vmcnt(6)
    buffer_load_dwordx4 v4, s[12:15], s51 offen offset:3072 nt lds
    s_add_u32 s51, s41, 12
    s_and_b32 s51, s51, 15
    s_lshl_b32 s51, s51, 14
    s_add_u32 s51, s51, s43
    s_add_u32 m0, s45, 16384
    s_waitcnt vmcnt(6)
    buffer_load_dwordx4 v5, s[16:19], s51 offen offset:0 nt lds
    s_add_u32 s51, s41, 12
    s_and_b32 s51, s51, 15
    s_lshl_b32 s51, s51, 14
    s_add_u32 s51, s51, s43
    s_add_u32 m0, s45, 16384
    s_waitcnt vmcnt(4)
    buffer_load_dwordx4 v6, s[16:19], s51 offen offset:1024 nt lds
    s_add_u32 s51, s41, 12
    s_and_b32 s51, s51, 15
    s_lshl_b32 s51, s51, 14
    s_add_u32 s51, s51, s43
    s_add_u32 m0, s45, 16384
    s_waitcnt vmcnt(4)
    buffer_load_dwordx4 v5, s[16:19], s51 offen offset:2048 nt lds
    s_add_u32 s51, s41, 12
    s_and_b32 s51, s51, 15
    s_lshl_b32 s51, s51, 14
    s_add_u32 s51, s51, s43
    s_add_u32 m0, s45, 16384
    s_waitcnt vmcnt(4)
    buffer_load_dwordx4 v6, s[16:19], s51 offen offset:3072 nt lds
    ds_read_b64_tr_b16 v[240:241], v244 offset:8192
    ds_read_b64_tr_b16 v[242:243], v244 offset:9216
    ds_read_b64_tr_b16 v[252:253], v245 offset:8192
    ds_read_b64_tr_b16 v[254:255], v245 offset:9216
    ds_read_b64_tr_b16 v[112:113], v246 offset:8192
    ds_read_b64_tr_b16 v[114:115], v246 offset:9216
    ds_read_b64_tr_b16 v[116:117], v247 offset:8192
    ds_read_b64_tr_b16 v[118:119], v247 offset:9216
    ds_read_b64_tr_b16 v[120:121], v248 offset:8192
    ds_read_b64_tr_b16 v[122:123], v248 offset:9216
    ds_read_b64_tr_b16 v[124:125], v249 offset:8192
    ds_read_b64_tr_b16 v[126:127], v249 offset:9216
    ds_read_b64_tr_b16 v[128:129], v250 offset:8192
    ds_read_b64_tr_b16 v[130:131], v250 offset:9216
    ds_read_b64_tr_b16 v[132:133], v251 offset:8192
    ds_read_b64_tr_b16 v[134:135], v251 offset:9216
    s_waitcnt lgkmcnt(14)
    v_mfma_f32_16x16x32_bf16 v[48:51], v[240:243], v[216:219], v[48:51]
    v_mfma_f32_16x16x32_bf16 v[52:55], v[240:243], v[220:223], v[52:55]
    s_waitcnt lgkmcnt(12)
    v_mfma_f32_16x16x32_bf16 v[56:59], v[252:255], v[216:219], v[56:59]
    v_mfma_f32_16x16x32_bf16 v[60:63], v[252:255], v[220:223], v[60:63]
    s_waitcnt lgkmcnt(10)
    v_mfma_f32_16x16x32_bf16 v[64:67], v[112:115], v[216:219], v[64:67]
    v_mfma_f32_16x16x32_bf16 v[68:71], v[112:115], v[220:223], v[68:71]
    s_waitcnt lgkmcnt(8)
    v_mfma_f32_16x16x32_bf16 v[72:75], v[116:119], v[216:219], v[72:75]
    v_mfma_f32_16x16x32_bf16 v[76:79], v[116:119], v[220:223], v[76:79]
    s_waitcnt lgkmcnt(6)
    v_mfma_f32_16x16x32_bf16 v[80:83], v[120:123], v[216:219], v[80:83]
    v_mfma_f32_16x16x32_bf16 v[84:87], v[120:123], v[220:223], v[84:87]
    s_waitcnt lgkmcnt(4)
    v_mfma_f32_16x16x32_bf16 v[88:91], v[124:127], v[216:219], v[88:91]
    v_mfma_f32_16x16x32_bf16 v[92:95], v[124:127], v[220:223], v[92:95]
    s_waitcnt lgkmcnt(2)
    v_mfma_f32_16x16x32_bf16 v[96:99], v[128:131], v[216:219], v[96:99]
    v_mfma_f32_16x16x32_bf16 v[100:103], v[128:131], v[220:223], v[100:103]
    s_waitcnt lgkmcnt(0)
    v_mfma_f32_16x16x32_bf16 v[104:107], v[132:135], v[216:219], v[104:107]
    v_mfma_f32_16x16x32_bf16 v[108:111], v[132:135], v[220:223], v[108:111]
    ds_read_b64_tr_b16 v[240:241], v244 offset:16384
    ds_read_b64_tr_b16 v[242:243], v244 offset:17408
    ds_read_b64_tr_b16 v[252:253], v245 offset:16384
    ds_read_b64_tr_b16 v[254:255], v245 offset:17408
    ds_read_b64_tr_b16 v[112:113], v246 offset:16384
    ds_read_b64_tr_b16 v[114:115], v246 offset:17408
    ds_read_b64_tr_b16 v[116:117], v247 offset:16384
    ds_read_b64_tr_b16 v[118:119], v247 offset:17408
    ds_read_b64_tr_b16 v[120:121], v248 offset:16384
    ds_read_b64_tr_b16 v[122:123], v248 offset:17408
    ds_read_b64_tr_b16 v[124:125], v249 offset:16384
    ds_read_b64_tr_b16 v[126:127], v249 offset:17408
    ds_read_b64_tr_b16 v[128:129], v250 offset:16384
    ds_read_b64_tr_b16 v[130:131], v250 offset:17408
    ds_read_b64_tr_b16 v[132:133], v251 offset:16384
    ds_read_b64_tr_b16 v[134:135], v251 offset:17408
    s_waitcnt lgkmcnt(14)
    v_mfma_f32_16x16x32_bf16 v[48:51], v[240:243], v[224:227], v[48:51]
    v_mfma_f32_16x16x32_bf16 v[52:55], v[240:243], v[228:231], v[52:55]
    s_waitcnt lgkmcnt(12)
    v_mfma_f32_16x16x32_bf16 v[56:59], v[252:255], v[224:227], v[56:59]
    v_mfma_f32_16x16x32_bf16 v[60:63], v[252:255], v[228:231], v[60:63]
    s_waitcnt lgkmcnt(10)
    v_mfma_f32_16x16x32_bf16 v[64:67], v[112:115], v[224:227], v[64:67]
    v_mfma_f32_16x16x32_bf16 v[68:71], v[112:115], v[228:231], v[68:71]
    s_waitcnt lgkmcnt(8)
    v_mfma_f32_16x16x32_bf16 v[72:75], v[116:119], v[224:227], v[72:75]
    v_mfma_f32_16x16x32_bf16 v[76:79], v[116:119], v[228:231], v[76:79]
    s_waitcnt lgkmcnt(6)
    v_mfma_f32_16x16x32_bf16 v[80:83], v[120:123], v[224:227], v[80:83]
    v_mfma_f32_16x16x32_bf16 v[84:87], v[120:123], v[228:231], v[84:87]
    s_waitcnt lgkmcnt(4)
    v_mfma_f32_16x16x32_bf16 v[88:91], v[124:127], v[224:227], v[88:91]
    v_mfma_f32_16x16x32_bf16 v[92:95], v[124:127], v[228:231], v[92:95]
    s_waitcnt lgkmcnt(2)
    v_mfma_f32_16x16x32_bf16 v[96:99], v[128:131], v[224:227], v[96:99]
    v_mfma_f32_16x16x32_bf16 v[100:103], v[128:131], v[228:231], v[100:103]
    s_waitcnt lgkmcnt(0)
    v_mfma_f32_16x16x32_bf16 v[104:107], v[132:135], v[224:227], v[104:107]
    v_mfma_f32_16x16x32_bf16 v[108:111], v[132:135], v[228:231], v[108:111]
    s_barrier
    s_and_b32 s51, s62, 3
    s_add_u32 s51, s51, s36
    s_lshl_b32 s52, s37, 4
    s_add_u32 s51, s51, s52
    s_cmp_eq_u32 s51, 6
    s_cbranch_scc0 L_cfi11
    buffer_load_dword v9, v10, s[32:35], 0 offen sc1
L_cfi11:
    s_lshl_b32 s52, s57, 18
    s_add_u32 s52, s52, s55
    s_add_u32 m0, s93, 0
    s_nop 0
    buffer_load_dwordx4 v7, s[8:11], s52 offen offset:0 lds
    buffer_load_dwordx4 v8, s[8:11], s52 offen offset:1024 lds
    s_add_u32 s57, s57, 1
    s_cmp_eq_u32 s57, 20
    s_cselect_b32 s57, 0, s57
    s_lshl_b32 s52, s57, 18
    s_add_u32 s52, s52, s55
    s_add_u32 m0, s93, 8192
    s_nop 0
    buffer_load_dwordx4 v7, s[8:11], s52 offen offset:0 lds
    buffer_load_dwordx4 v8, s[8:11], s52 offen offset:1024 lds
    s_add_u32 s57, s57, 1
    s_cmp_eq_u32 s57, 20
    s_cselect_b32 s57, 0, s57
    s_add_u32 s51, s41, 13
    s_and_b32 s51, s51, 15
    s_lshl_b32 s51, s51, 14
    s_add_u32 s51, s51, s43
    s_add_u32 m0, s45, 32768
    s_waitcnt vmcnt(8)
    buffer_load_dwordx4 v1, s[12:15], s51 offen offset:0 nt lds
    s_add_u32 s51, s41, 13
    s_and_b32 s51, s51, 15
    s_lshl_b32 s51, s51, 14
    s_add_u32 s51, s51, s43
    s_add_u32 m0, s45, 32768
    s_waitcnt vmcnt(8)
    buffer_load_dwordx4 v2, s[12:15], s51 offen offset:1024 nt lds
    s_add_u32 s51, s41, 13
    s_and_b32 s51, s51, 15
    s_lshl_b32 s51, s51, 14
    s_add_u32 s51, s51, s43
    s_add_u32 m0, s45, 32768
    s_waitcnt vmcnt(8)
    buffer_load_dwordx4 v3, s[12:15], s51 offen offset:2048 nt lds
    s_add_u32 s51, s41, 13
    s_and_b32 s51, s51, 15
    s_lshl_b32 s51, s51, 14
    s_add_u32 s51, s51, s43
    s_add_u32 m0, s45, 32768
    s_waitcnt vmcnt(8)
    buffer_load_dwordx4 v4, s[12:15], s51 offen offset:3072 nt lds
    s_add_u32 s51, s41, 13
    s_and_b32 s51, s51, 15
    s_lshl_b32 s51, s51, 14
    s_add_u32 s51, s51, s43
    s_add_u32 m0, s45, 49152
    s_waitcnt vmcnt(8)
    buffer_load_dwordx4 v5, s[16:19], s51 offen offset:0 nt lds
    s_add_u32 s51, s41, 13
    s_and_b32 s51, s51, 15
    s_lshl_b32 s51, s51, 14
    s_add_u32 s51, s51, s43
    s_add_u32 m0, s45, 49152
    s_waitcnt vmcnt(4)
    buffer_load_dwordx4 v6, s[16:19], s51 offen offset:1024 nt lds
    s_add_u32 s51, s41, 13
    s_and_b32 s51, s51, 15
    s_lshl_b32 s51, s51, 14
    s_add_u32 s51, s51, s43
    s_add_u32 m0, s45, 49152
    s_waitcnt vmcnt(4)
    buffer_load_dwordx4 v5, s[16:19], s51 offen offset:2048 nt lds
    s_add_u32 s51, s41, 13
    s_and_b32 s51, s51, 15
    s_lshl_b32 s51, s51, 14
    s_add_u32 s51, s51, s43
    s_add_u32 m0, s45, 49152
    s_waitcnt vmcnt(4)
    buffer_load_dwordx4 v6, s[16:19], s51 offen offset:3072 nt lds
    ds_read_b64_tr_b16 v[240:241], v244 offset:24576
    ds_read_b64_tr_b16 v[242:243], v244 offset:25600
    ds_read_b64_tr_b16 v[252:253], v245 offset:24576
    ds_read_b64_tr_b16 v[254:255], v245 offset:25600
    ds_read_b64_tr_b16 v[112:113], v246 offset:24576
    ds_read_b64_tr_b16 v[114:115], v246 offset:25600
    ds_read_b64_tr_b16 v[116:117], v247 offset:24576
    ds_read_b64_tr_b16 v[118:119], v247 offset:25600
    ds_read_b64_tr_b16 v[120:121], v248 offset:24576
    ds_read_b64_tr_b16 v[122:123], v248 offset:25600
    ds_read_b64_tr_b16 v[124:125], v249 offset:24576
    ds_read_b64_tr_b16 v[126:127], v249 offset:25600
    ds_read_b64_tr_b16 v[128:129], v250 offset:24576
    ds_read_b64_tr_b16 v[130:131], v250 offset:25600
    ds_read_b64_tr_b16 v[132:133], v251 offset:24576
    ds_read_b64_tr_b16 v[134:135], v251 offset:25600
    s_waitcnt lgkmcnt(14)
    v_mfma_f32_16x16x32_bf16 v[48:51], v[240:243], v[232:235], v[48:51]
    v_mfma_f32_16x16x32_bf16 v[52:55], v[240:243], v[236:239], v[52:55]
    s_waitcnt lgkmcnt(12)
    v_mfma_f32_16x16x32_bf16 v[56:59], v[252:255], v[232:235], v[56:59]
    v_mfma_f32_16x16x32_bf16 v[60:63], v[252:255], v[236:239], v[60:63]
    s_waitcnt lgkmcnt(10)
    v_mfma_f32_16x16x32_bf16 v[64:67], v[112:115], v[232:235], v[64:67]
    v_mfma_f32_16x16x32_bf16 v[68:71], v[112:115], v[236:239], v[68:71]
    s_waitcnt lgkmcnt(8)
    v_mfma_f32_16x16x32_bf16 v[72:75], v[116:119], v[232:235], v[72:75]
    v_mfma_f32_16x16x32_bf16 v[76:79], v[116:119], v[236:239], v[76:79]
    s_waitcnt lgkmcnt(6)
    v_mfma_f32_16x16x32_bf16 v[80:83], v[120:123], v[232:235], v[80:83]
    v_mfma_f32_16x16x32_bf16 v[84:87], v[120:123], v[236:239], v[84:87]
    s_waitcnt lgkmcnt(4)
    v_mfma_f32_16x16x32_bf16 v[88:91], v[124:127], v[232:235], v[88:91]
    v_mfma_f32_16x16x32_bf16 v[92:95], v[124:127], v[236:239], v[92:95]
    s_waitcnt lgkmcnt(2)
    v_mfma_f32_16x16x32_bf16 v[96:99], v[128:131], v[232:235], v[96:99]
    v_mfma_f32_16x16x32_bf16 v[100:103], v[128:131], v[236:239], v[100:103]
    s_waitcnt lgkmcnt(0)
    v_mfma_f32_16x16x32_bf16 v[104:107], v[132:135], v[232:235], v[104:107]
    v_mfma_f32_16x16x32_bf16 v[108:111], v[132:135], v[236:239], v[108:111]
    s_barrier
    s_and_b32 s51, s62, 3
    s_add_u32 s51, s51, s36
    s_lshl_b32 s52, s37, 4
    s_add_u32 s51, s51, s52
    s_cmp_eq_u32 s51, 7
    s_cbranch_scc0 L_cfi12
    buffer_load_dword v9, v10, s[32:35], 0 offen sc1
L_cfi12:
    s_lshl_b32 s52, s57, 18
    s_add_u32 s52, s52, s55
    s_add_u32 m0, s93, 16384
    s_nop 0
    buffer_load_dwordx4 v7, s[8:11], s52 offen offset:0 lds
    buffer_load_dwordx4 v8, s[8:11], s52 offen offset:1024 lds
    s_add_u32 s57, s57, 1
    s_cmp_eq_u32 s57, 20
    s_cselect_b32 s57, 0, s57
    s_lshl_b32 s52, s57, 18
    s_add_u32 s52, s52, s55
    s_add_u32 m0, s93, 24576
    s_nop 0
    buffer_load_dwordx4 v7, s[8:11], s52 offen offset:0 lds
    buffer_load_dwordx4 v8, s[8:11], s52 offen offset:1024 lds
    s_add_u32 s57, s57, 1
    s_cmp_eq_u32 s57, 20
    s_cselect_b32 s57, 0, s57
    s_add_u32 s51, s41, 14
    s_and_b32 s51, s51, 15
    s_lshl_b32 s51, s51, 14
    s_add_u32 s51, s51, s43
    s_add_u32 m0, s45, 65536
    s_waitcnt vmcnt(8)
    buffer_load_dwordx4 v1, s[12:15], s51 offen offset:0 nt lds
    s_add_u32 s51, s41, 14
    s_and_b32 s51, s51, 15
    s_lshl_b32 s51, s51, 14
    s_add_u32 s51, s51, s43
    s_add_u32 m0, s45, 65536
    s_waitcnt vmcnt(8)
    buffer_load_dwordx4 v2, s[12:15], s51 offen offset:1024 nt lds
    s_add_u32 s51, s41, 14
    s_and_b32 s51, s51, 15
    s_lshl_b32 s51, s51, 14
    s_add_u32 s51, s51, s43
    s_add_u32 m0, s45, 65536
    s_waitcnt vmcnt(8)
    buffer_load_dwordx4 v3, s[12:15], s51 offen offset:2048 nt lds
    s_add_u32 s51, s41, 14
    s_and_b32 s51, s51, 15
    s_lshl_b32 s51, s51, 14
    s_add_u32 s51, s51, s43
    s_add_u32 m0, s45, 65536
    s_waitcnt vmcnt(8)
    buffer_load_dwordx4 v4, s[12:15], s51 offen offset:3072 nt lds
    s_add_u32 s51, s41, 14
    s_and_b32 s51, s51, 15
    s_lshl_b32 s51, s51, 14
    s_add_u32 s51, s51, s43
    s_add_u32 m0, s45, 81920
    s_waitcnt vmcnt(8)
    buffer_load_dwordx4 v5, s[16:19], s51 offen offset:0 nt lds
    s_add_u32 s51, s41, 14
    s_and_b32 s51, s51, 15
    s_lshl_b32 s51, s51, 14
    s_add_u32 s51, s51, s43
    s_add_u32 m0, s45, 81920
    s_waitcnt vmcnt(4)
    buffer_load_dwordx4 v6, s[16:19], s51 offen offset:1024 nt lds
    s_add_u32 s51, s41, 14
    s_and_b32 s51, s51, 15
    s_lshl_b32 s51, s51, 14
    s_add_u32 s51, s51, s43
    s_add_u32 m0, s45, 81920
    s_waitcnt vmcnt(4)
    buffer_load_dwordx4 v5, s[16:19], s51 offen offset:2048 nt lds
    s_add_u32 s51, s41, 14
    s_and_b32 s51, s51, 15
    s_lshl_b32 s51, s51, 14
    s_add_u32 s51, s51, s43
    s_add_u32 m0, s45, 81920
    s_waitcnt vmcnt(4)
    buffer_load_dwordx4 v6, s[16:19], s51 offen offset:3072 nt lds
    ds_read_b64_tr_b16 v[240:241], v244 offset:0
    ds_read_b64_tr_b16 v[242:243], v244 offset:1024
    ds_read_b64_tr_b16 v[252:253], v245 offset:0
    ds_read_b64_tr_b16 v[254:255], v245 offset:1024
    ds_read_b64_tr_b16 v[112:113], v246 offset:0
    ds_read_b64_tr_b16 v[114:115], v246 offset:1024
    ds_read_b64_tr_b16 v[116:117], v247 offset:0
    ds_read_b64_tr_b16 v[118:119], v247 offset:1024
    ds_read_b64_tr_b16 v[120:121], v248 offset:0
    ds_read_b64_tr_b16 v[122:123], v248 offset:1024
    ds_read_b64_tr_b16 v[124:125], v249 offset:0
    ds_read_b64_tr_b16 v[126:127], v249 offset:1024
    ds_read_b64_tr_b16 v[128:129], v250 offset:0
    ds_read_b64_tr_b16 v[130:131], v250 offset:1024
    ds_read_b64_tr_b16 v[132:133], v251 offset:0
    ds_read_b64_tr_b16 v[134:135], v251 offset:1024
    s_waitcnt lgkmcnt(14)
    v_mfma_f32_16x16x32_bf16 v[48:51], v[240:243], v[16:19], v[48:51]
    v_mfma_f32_16x16x32_bf16 v[52:55], v[240:243], v[20:23], v[52:55]
    s_waitcnt lgkmcnt(12)
    v_mfma_f32_16x16x32_bf16 v[56:59], v[252:255], v[16:19], v[56:59]
    v_mfma_f32_16x16x32_bf16 v[60:63], v[252:255], v[20:23], v[60:63]
    s_waitcnt lgkmcnt(10)
    v_mfma_f32_16x16x32_bf16 v[64:67], v[112:115], v[16:19], v[64:67]
    v_mfma_f32_16x16x32_bf16 v[68:71], v[112:115], v[20:23], v[68:71]
    s_waitcnt lgkmcnt(8)
    v_mfma_f32_16x16x32_bf16 v[72:75], v[116:119], v[16:19], v[72:75]
    v_mfma_f32_16x16x32_bf16 v[76:79], v[116:119], v[20:23], v[76:79]
    s_waitcnt lgkmcnt(6)
    v_mfma_f32_16x16x32_bf16 v[80:83], v[120:123], v[16:19], v[80:83]
    v_mfma_f32_16x16x32_bf16 v[84:87], v[120:123], v[20:23], v[84:87]
    s_waitcnt lgkmcnt(4)
    v_mfma_f32_16x16x32_bf16 v[88:91], v[124:127], v[16:19], v[88:91]
    v_mfma_f32_16x16x32_bf16 v[92:95], v[124:127], v[20:23], v[92:95]
    s_waitcnt lgkmcnt(2)
    v_mfma_f32_16x16x32_bf16 v[96:99], v[128:131], v[16:19], v[96:99]
    v_mfma_f32_16x16x32_bf16 v[100:103], v[128:131], v[20:23], v[100:103]
    s_waitcnt lgkmcnt(0)
    v_mfma_f32_16x16x32_bf16 v[104:107], v[132:135], v[16:19], v[104:107]
    v_mfma_f32_16x16x32_bf16 v[108:111], v[132:135], v[20:23], v[108:111]
    ds_read_b64_tr_b16 v[240:241], v244 offset:8192
    ds_read_b64_tr_b16 v[242:243], v244 offset:9216
    ds_read_b64_tr_b16 v[252:253], v245 offset:8192
    ds_read_b64_tr_b16 v[254:255], v245 offset:9216
    ds_read_b64_tr_b16 v[112:113], v246 offset:8192
    ds_read_b64_tr_b16 v[114:115], v246 offset:9216
    ds_read_b64_tr_b16 v[116:117], v247 offset:8192
    ds_read_b64_tr_b16 v[118:119], v247 offset:9216
    ds_read_b64_tr_b16 v[120:121], v248 offset:8192
    ds_read_b64_tr_b16 v[122:123], v248 offset:9216
    ds_read_b64_tr_b16 v[124:125], v249 offset:8192
    ds_read_b64_tr_b16 v[126:127], v249 offset:9216
    ds_read_b64_tr_b16 v[128:129], v250 offset:8192
    ds_read_b64_tr_b16 v[130:131], v250 offset:9216
    ds_read_b64_tr_b16 v[132:133], v251 offset:8192
    ds_read_b64_tr_b16 v[134:135], v251 offset:9216
    s_waitcnt lgkmcnt(14)
    v_mfma_f32_16x16x32_bf16 v[48:51], v[240:243], v[24:27], v[48:51]
    v_mfma_f32_16x16x32_bf16 v[52:55], v[240:243], v[28:31], v[52:55]
    s_waitcnt lgkmcnt(12)
    v_mfma_f32_16x16x32_bf16 v[56:59], v[252:255], v[24:27], v[56:59]
    v_mfma_f32_16x16x32_bf16 v[60:63], v[252:255], v[28:31], v[60:63]
    s_waitcnt lgkmcnt(10)
    v_mfma_f32_16x16x32_bf16 v[64:67], v[112:115], v[24:27], v[64:67]
    v_mfma_f32_16x16x32_bf16 v[68:71], v[112:115], v[28:31], v[68:71]
    s_waitcnt lgkmcnt(8)
    v_mfma_f32_16x16x32_bf16 v[72:75], v[116:119], v[24:27], v[72:75]
    v_mfma_f32_16x16x32_bf16 v[76:79], v[116:119], v[28:31], v[76:79]
    s_waitcnt lgkmcnt(6)
    v_mfma_f32_16x16x32_bf16 v[80:83], v[120:123], v[24:27], v[80:83]
    v_mfma_f32_16x16x32_bf16 v[84:87], v[120:123], v[28:31], v[84:87]
    s_waitcnt lgkmcnt(4)
    v_mfma_f32_16x16x32_bf16 v[88:91], v[124:127], v[24:27], v[88:91]
    v_mfma_f32_16x16x32_bf16 v[92:95], v[124:127], v[28:31], v[92:95]
    s_waitcnt lgkmcnt(2)
    v_mfma_f32_16x16x32_bf16 v[96:99], v[128:131], v[24:27], v[96:99]
    v_mfma_f32_16x16x32_bf16 v[100:103], v[128:131], v[28:31], v[100:103]
    s_waitcnt lgkmcnt(0)
    v_mfma_f32_16x16x32_bf16 v[104:107], v[132:135], v[24:27], v[104:107]
    v_mfma_f32_16x16x32_bf16 v[108:111], v[132:135], v[28:31], v[108:111]
    s_barrier
    s_add_u32 s51, s41, 15
    s_and_b32 s51, s51, 15
    s_lshl_b32 s51, s51, 14
    s_add_u32 s51, s51, s43
    s_add_u32 m0, s45, 0
    s_waitcnt vmcnt(4)
    buffer_load_dwordx4 v1, s[12:15], s51 offen offset:0 nt lds
    s_add_u32 s51, s41, 15
    s_and_b32 s51, s51, 15
    s_lshl_b32 s51, s51, 14
    s_add_u32 s51, s51, s43
    s_add_u32 m0, s45, 0
    s_waitcnt vmcnt(4)
    buffer_load_dwordx4 v2, s[12:15], s51 offen offset:1024 nt lds
    s_add_u32 s51, s41, 15
    s_and_b32 s51, s51, 15
    s_lshl_b32 s51, s51, 14
    s_add_u32 s51, s51, s43
    s_add_u32 m0, s45, 0
    s_waitcnt vmcnt(4)
    buffer_load_dwordx4 v3, s[12:15], s51 offen offset:2048 nt lds
    s_add_u32 s51, s41, 15
    s_and_b32 s51, s51, 15
    s_lshl_b32 s51, s51, 14
    s_add_u32 s51, s51, s43
    s_add_u32 m0, s45, 0
    s_waitcnt vmcnt(4)
    buffer_load_dwordx4 v4, s[12:15], s51 offen offset:3072 nt lds
    s_add_u32 s51, s41, 15
    s_and_b32 s51, s51, 15
    s_lshl_b32 s51, s51, 14
    s_add_u32 s51, s51, s43
    s_add_u32 m0, s45, 16384
    s_waitcnt vmcnt(4)
    buffer_load_dwordx4 v5, s[16:19], s51 offen offset:0 nt lds
    s_add_u32 s51, s41, 15
    s_and_b32 s51, s51, 15
    s_lshl_b32 s51, s51, 14
    s_add_u32 s51, s51, s43
    s_add_u32 m0, s45, 16384
    s_waitcnt vmcnt(4)
    buffer_load_dwordx4 v6, s[16:19], s51 offen offset:1024 nt lds
    s_add_u32 s51, s41, 15
    s_and_b32 s51, s51, 15
    s_lshl_b32 s51, s51, 14
    s_add_u32 s51, s51, s43
    s_add_u32 m0, s45, 16384
    s_waitcnt vmcnt(4)
    buffer_load_dwordx4 v5, s[16:19], s51 offen offset:2048 nt lds
    s_add_u32 s51, s41, 15
    s_and_b32 s51, s51, 15
    s_lshl_b32 s51, s51, 14
    s_add_u32 s51, s51, s43
    s_add_u32 m0, s45, 16384
    s_waitcnt vmcnt(4)
    buffer_load_dwordx4 v6, s[16:19], s51 offen offset:3072 nt lds
    ds_read_b64_tr_b16 v[240:241], v244 offset:16384
    ds_read_b64_tr_b16 v[242:243], v244 offset:17408
    ds_read_b64_tr_b16 v[252:253], v245 offset:16384
    ds_read_b64_tr_b16 v[254:255], v245 offset:17408
    ds_read_b64_tr_b16 v[112:113], v246 offset:16384
    ds_read_b64_tr_b16 v[114:115], v246 offset:17408
    ds_read_b64_tr_b16 v[116:117], v247 offset:16384
    ds_read_b64_tr_b16 v[118:119], v247 offset:17408
    ds_read_b64_tr_b16 v[120:121], v248 offset:16384
    ds_read_b64_tr_b16 v[122:123], v248 offset:17408
    ds_read_b64_tr_b16 v[124:125], v249 offset:16384
    ds_read_b64_tr_b16 v[126:127], v249 offset:17408
    ds_read_b64_tr_b16 v[128:129], v250 offset:16384
    ds_read_b64_tr_b16 v[130:131], v250 offset:17408
    ds_read_b64_tr_b16 v[132:133], v251 offset:16384
    ds_read_b64_tr_b16 v[134:135], v251 offset:17408
    s_waitcnt lgkmcnt(14)
    v_mfma_f32_16x16x32_bf16 v[48:51], v[240:243], v[32:35], v[48:51]
    v_mfma_f32_16x16x32_bf16 v[52:55], v[240:243], v[36:39], v[52:55]
    s_waitcnt lgkmcnt(12)
    v_mfma_f32_16x16x32_bf16 v[56:59], v[252:255], v[32:35], v[56:59]
    v_mfma_f32_16x16x32_bf16 v[60:63], v[252:255], v[36:39], v[60:63]
    s_waitcnt lgkmcnt(10)
    v_mfma_f32_16x16x32_bf16 v[64:67], v[112:115], v[32:35], v[64:67]
    v_mfma_f32_16x16x32_bf16 v[68:71], v[112:115], v[36:39], v[68:71]
    s_waitcnt lgkmcnt(8)
    v_mfma_f32_16x16x32_bf16 v[72:75], v[116:119], v[32:35], v[72:75]
    v_mfma_f32_16x16x32_bf16 v[76:79], v[116:119], v[36:39], v[76:79]
    s_waitcnt lgkmcnt(6)
    v_mfma_f32_16x16x32_bf16 v[80:83], v[120:123], v[32:35], v[80:83]
    v_mfma_f32_16x16x32_bf16 v[84:87], v[120:123], v[36:39], v[84:87]
    s_waitcnt lgkmcnt(4)
    v_mfma_f32_16x16x32_bf16 v[88:91], v[124:127], v[32:35], v[88:91]
    v_mfma_f32_16x16x32_bf16 v[92:95], v[124:127], v[36:39], v[92:95]
    s_waitcnt lgkmcnt(2)
    v_mfma_f32_16x16x32_bf16 v[96:99], v[128:131], v[32:35], v[96:99]
    v_mfma_f32_16x16x32_bf16 v[100:103], v[128:131], v[36:39], v[100:103]
    s_waitcnt lgkmcnt(0)
    v_mfma_f32_16x16x32_bf16 v[104:107], v[132:135], v[32:35], v[104:107]
    v_mfma_f32_16x16x32_bf16 v[108:111], v[132:135], v[36:39], v[108:111]
    ds_read_b64_tr_b16 v[240:241], v244 offset:24576
    ds_read_b64_tr_b16 v[242:243], v244 offset:25600
    ds_read_b64_tr_b16 v[252:253], v245 offset:24576
    ds_read_b64_tr_b16 v[254:255], v245 offset:25600
    ds_read_b64_tr_b16 v[112:113], v246 offset:24576
    ds_read_b64_tr_b16 v[114:115], v246 offset:25600
    ds_read_b64_tr_b16 v[116:117], v247 offset:24576
    ds_read_b64_tr_b16 v[118:119], v247 offset:25600
    ds_read_b64_tr_b16 v[120:121], v248 offset:24576
    ds_read_b64_tr_b16 v[122:123], v248 offset:25600
    ds_read_b64_tr_b16 v[124:125], v249 offset:24576
    ds_read_b64_tr_b16 v[126:127], v249 offset:25600
    ds_read_b64_tr_b16 v[128:129], v250 offset:24576
    ds_read_b64_tr_b16 v[130:131], v250 offset:25600
    ds_read_b64_tr_b16 v[132:133], v251 offset:24576
    ds_read_b64_tr_b16 v[134:135], v251 offset:25600
    s_waitcnt lgkmcnt(14)
    v_mfma_f32_16x16x32_bf16 v[48:51], v[240:243], v[40:43], v[48:51]
    v_mfma_f32_16x16x32_bf16 v[52:55], v[240:243], v[44:47], v[52:55]
    s_waitcnt lgkmcnt(12)
    v_mfma_f32_16x16x32_bf16 v[56:59], v[252:255], v[40:43], v[56:59]
    v_mfma_f32_16x16x32_bf16 v[60:63], v[252:255], v[44:47], v[60:63]
    s_waitcnt lgkmcnt(10)
    v_mfma_f32_16x16x32_bf16 v[64:67], v[112:115], v[40:43], v[64:67]
    v_mfma_f32_16x16x32_bf16 v[68:71], v[112:115], v[44:47], v[68:71]
    s_waitcnt lgkmcnt(8)
    v_mfma_f32_16x16x32_bf16 v[72:75], v[116:119], v[40:43], v[72:75]
    v_mfma_f32_16x16x32_bf16 v[76:79], v[116:119], v[44:47], v[76:79]
    s_waitcnt lgkmcnt(6)
    v_mfma_f32_16x16x32_bf16 v[80:83], v[120:123], v[40:43], v[80:83]
    v_mfma_f32_16x16x32_bf16 v[84:87], v[120:123], v[44:47], v[84:87]
    s_waitcnt lgkmcnt(4)
    v_mfma_f32_16x16x32_bf16 v[88:91], v[124:127], v[40:43], v[88:91]
    v_mfma_f32_16x16x32_bf16 v[92:95], v[124:127], v[44:47], v[92:95]
    s_waitcnt lgkmcnt(2)
    v_mfma_f32_16x16x32_bf16 v[96:99], v[128:131], v[40:43], v[96:99]
    v_mfma_f32_16x16x32_bf16 v[100:103], v[128:131], v[44:47], v[100:103]
    s_waitcnt lgkmcnt(0)
    v_mfma_f32_16x16x32_bf16 v[104:107], v[132:135], v[40:43], v[104:107]
    v_mfma_f32_16x16x32_bf16 v[108:111], v[132:135], v[44:47], v[108:111]
    s_barrier
    s_add_u32 s51, s41, 0
    s_and_b32 s51, s51, 15
    s_lshl_b32 s51, s51, 14
    s_add_u32 s51, s51, s44
    s_add_u32 m0, s45, 32768
    s_waitcnt vmcnt(4)
    buffer_load_dwordx4 v1, s[12:15], s51 offen offset:0 nt lds
    s_add_u32 s51, s41, 0
    s_and_b32 s51, s51, 15
    s_lshl_b32 s51, s51, 14
    s_add_u32 s51, s51, s44
    s_add_u32 m0, s45, 32768
    s_waitcnt vmcnt(4)
    buffer_load_dwordx4 v2, s[12:15], s51 offen offset:1024 nt lds
    s_add_u32 s51, s41, 0
    s_and_b32 s51, s51, 15
    s_lshl_b32 s51, s51, 14
    s_add_u32 s51, s51, s44
    s_add_u32 m0, s45, 32768
    s_waitcnt vmcnt(4)
    buffer_load_dwordx4 v3, s[12:15], s51 offen offset:2048 nt lds
    s_add_u32 s51, s41, 0
    s_and_b32 s51, s51, 15
    s_lshl_b32 s51, s51, 14
    s_add_u32 s51, s51, s44
    s_add_u32 m0, s45, 32768
    s_waitcnt vmcnt(4)
    buffer_load_dwordx4 v4, s[12:15], s51 offen offset:3072 nt lds
    s_add_u32 s51, s41, 0
    s_and_b32 s51, s51, 15
    s_lshl_b32 s51, s51, 14
    s_add_u32 s51, s51, s44
    s_add_u32 m0, s45, 49152
    s_waitcnt vmcnt(4)
    buffer_load_dwordx4 v5, s[16:19], s51 offen offset:0 nt lds
    s_add_u32 s51, s41, 0
    s_and_b32 s51, s51, 15
    s_lshl_b32 s51, s51, 14
    s_add_u32 s51, s51, s44
    s_add_u32 m0, s45, 49152
    s_waitcnt vmcnt(4)
    buffer_load_dwordx4 v6, s[16:19], s51 offen offset:1024 nt lds
    s_add_u32 s51, s41, 0
    s_and_b32 s51, s51, 15
    s_lshl_b32 s51, s51, 14
    s_add_u32 s51, s51, s44
    s_add_u32 m0, s45, 49152
    s_waitcnt vmcnt(4)
    buffer_load_dwordx4 v5, s[16:19], s51 offen offset:2048 nt lds
    s_add_u32 s51, s41, 0
    s_and_b32 s51, s51, 15
    s_lshl_b32 s51, s51, 14
    s_add_u32 s51, s51, s44
    s_add_u32 m0, s45, 49152
    s_waitcnt vmcnt(4)
    buffer_load_dwordx4 v6, s[16:19], s51 offen offset:3072 nt lds
    s_mov_b32 s90, 0x3e0293ee
    s_mov_b32 s91, 0x3e0293ee
    v_pk_mul_f32 v[48:49], v[48:49], s[90:91]
    v_pk_mul_f32 v[50:51], v[50:51], s[90:91]
    v_pk_mul_f32 v[56:57], v[56:57], s[90:91]
    v_pk_mul_f32 v[58:59], v[58:59], s[90:91]
    v_cvt_pk_bf16_f32 v16, v48, v49
    v_cvt_pk_bf16_f32 v17, v50, v51
    v_cvt_pk_bf16_f32 v18, v56, v57
    v_cvt_pk_bf16_f32 v19, v58, v59
    v_mov_b64 v[48:49], 0
    v_mov_b64 v[50:51], 0
    v_mov_b64 v[56:57], 0
    v_mov_b64 v[58:59], 0
    v_permlane32_swap_b32 v16, v18
    v_permlane32_swap_b32 v17, v19
    s_nop 0
    v_permlane16_swap_b32 v16, v18
    v_permlane16_swap_b32 v17, v19
    v_pk_mul_f32 v[52:53], v[52:53], s[90:91]
    v_pk_mul_f32 v[54:55], v[54:55], s[90:91]
    v_pk_mul_f32 v[60:61], v[60:61], s[90:91]
    v_pk_mul_f32 v[62:63], v[62:63], s[90:91]
    v_cvt_pk_bf16_f32 v20, v52, v53
    v_cvt_pk_bf16_f32 v21, v54, v55
    v_cvt_pk_bf16_f32 v22, v60, v61
    v_cvt_pk_bf16_f32 v23, v62, v63
    v_mov_b64 v[52:53], 0
    v_mov_b64 v[54:55], 0
    v_mov_b64 v[60:61], 0
    v_mov_b64 v[62:63], 0
    v_permlane32_swap_b32 v20, v22
    v_permlane32_swap_b32 v21, v23
    s_nop 0
    v_permlane16_swap_b32 v20, v22
    v_permlane16_swap_b32 v21, v23
    v_pk_mul_f32 v[64:65], v[64:65], s[90:91]
    v_pk_mul_f32 v[66:67], v[66:67], s[90:91]
    v_pk_mul_f32 v[72:73], v[72:73], s[90:91]
    v_pk_mul_f32 v[74:75], v[74:75], s[90:91]
    v_cvt_pk_bf16_f32 v24, v64, v65
    v_cvt_pk_bf16_f32 v25, v66, v67
    v_cvt_pk_bf16_f32 v26, v72, v73
    v_cvt_pk_bf16_f32 v27, v74, v75
    v_mov_b64 v[64:65], 0
    v_mov_b64 v[66:67], 0
    v_mov_b64 v[72:73], 0
    v_mov_b64 v[74:75], 0
    v_permlane32_swap_b32 v24, v26
    v_permlane32_swap_b32 v25, v27
    s_nop 0
    v_permlane16_swap_b32 v24, v26
    v_permlane16_swap_b32 v25, v27
    v_pk_mul_f32 v[68:69], v[68:69], s[90:91]
    v_pk_mul_f32 v[70:71], v[70:71], s[90:91]
    v_pk_mul_f32 v[76:77], v[76:77], s[90:91]
    v_pk_mul_f32 v[78:79], v[78:79], s[90:91]
    v_cvt_pk_bf16_f32 v28, v68, v69
    v_cvt_pk_bf16_f32 v29, v70, v71
    v_cvt_pk_bf16_f32 v30, v76, v77
    v_cvt_pk_bf16_f32 v31, v78, v79
    v_mov_b64 v[68:69], 0
    v_mov_b64 v[70:71], 0
    v_mov_b64 v[76:77], 0
    v_mov_b64 v[78:79], 0
    v_permlane32_swap_b32 v28, v30
    v_permlane32_swap_b32 v29, v31
    s_nop 0
    v_permlane16_swap_b32 v28, v30
    v_permlane16_swap_b32 v29, v31
    v_pk_mul_f32 v[80:81], v[80:81], s[90:91]
    v_pk_mul_f32 v[82:83], v[82:83], s[90:91]
    v_pk_mul_f32 v[88:89], v[88:89], s[90:91]
    v_pk_mul_f32 v[90:91], v[90:91], s[90:91]
    v_cvt_pk_bf16_f32 v32, v80, v81
    v_cvt_pk_bf16_f32 v33, v82, v83
    v_cvt_pk_bf16_f32 v34, v88, v89
    v_cvt_pk_bf16_f32 v35, v90, v91
    v_mov_b64 v[80:81], 0
    v_mov_b64 v[82:83], 0
    v_mov_b64 v[88:89], 0
    v_mov_b64 v[90:91], 0
    v_permlane32_swap_b32 v32, v34
    v_permlane32_swap_b32 v33, v35
    s_nop 0
    v_permlane16_swap_b32 v32, v34
    v_permlane16_swap_b32 v33, v35
    v_pk_mul_f32 v[84:85], v[84:85], s[90:91]
    v_pk_mul_f32 v[86:87], v[86:87], s[90:91]
    v_pk_mul_f32 v[92:93], v[92:93], s[90:91]
    v_pk_mul_f32 v[94:95], v[94:95], s[90:91]
    v_cvt_pk_bf16_f32 v36, v84, v85
    v_cvt_pk_bf16_f32 v37, v86, v87
    v_cvt_pk_bf16_f32 v38, v92, v93
    v_cvt_pk_bf16_f32 v39, v94, v95
    v_mov_b64 v[84:85], 0
    v_mov_b64 v[86:87], 0
    v_mov_b64 v[92:93], 0
    v_mov_b64 v[94:95], 0
    v_permlane32_swap_b32 v36, v38
    v_permlane32_swap_b32 v37, v39
    s_nop 0
    v_permlane16_swap_b32 v36, v38
    v_permlane16_swap_b32 v37, v39
    v_pk_mul_f32 v[96:97], v[96:97], s[90:91]
    v_pk_mul_f32 v[98:99], v[98:99], s[90:91]
    v_pk_mul_f32 v[104:105], v[104:105], s[90:91]
    v_pk_mul_f32 v[106:107], v[106:107], s[90:91]
    v_cvt_pk_bf16_f32 v40, v96, v97
    v_cvt_pk_bf16_f32 v41, v98, v99
    v_cvt_pk_bf16_f32 v42, v104, v105
    v_cvt_pk_bf16_f32 v43, v106, v107
    v_mov_b64 v[96:97], 0
    v_mov_b64 v[98:99], 0
    v_mov_b64 v[104:105], 0
    v_mov_b64 v[106:107], 0
    v_permlane32_swap_b32 v40, v42
    v_permlane32_swap_b32 v41, v43
    s_nop 0
    v_permlane16_swap_b32 v40, v42
    v_permlane16_swap_b32 v41, v43
    v_pk_mul_f32 v[100:101], v[100:101], s[90:91]
    v_pk_mul_f32 v[102:103], v[102:103], s[90:91]
    v_pk_mul_f32 v[108:109], v[108:109], s[90:91]
    v_pk_mul_f32 v[110:111], v[110:111], s[90:91]
    v_cvt_pk_bf16_f32 v44, v100, v101
    v_cvt_pk_bf16_f32 v45, v102, v103
    v_cvt_pk_bf16_f32 v46, v108, v109
    v_cvt_pk_bf16_f32 v47, v110, v111
    v_mov_b64 v[100:101], 0
    v_mov_b64 v[102:103], 0
    v_mov_b64 v[108:109], 0
    v_mov_b64 v[110:111], 0
    v_permlane32_swap_b32 v44, v46
    v_permlane32_swap_b32 v45, v47
    s_nop 0
    v_permlane16_swap_b32 v44, v46
    v_permlane16_swap_b32 v45, v47
    s_cmp_eq_u32 s36, 4
    s_cbranch_scc0 L_cf_ok
    s_mov_b32 s89, 0
L_cf_c:
    v_cmp_gt_u32 vcc, 16, v9
    s_nop 0
    s_cbranch_vccz L_cf_ok
    s_add_u32 s89, s89, 1
    s_cmp_gt_u32 s89, 0x40000
    s_cbranch_scc1 L_cf_ok
    s_sleep 4
    buffer_load_dword v9, v10, s[32:35], 0 offen sc1
        s_waitcnt vmcnt(0)
    s_branch L_cf_c
L_cf_ok:
    s_barrier
    s_add_u32 s51, s41, 1
    s_and_b32 s51, s51, 15
    s_lshl_b32 s51, s51, 14
    s_add_u32 s51, s51, s44
    s_add_u32 m0, s45, 65536
    s_waitcnt vmcnt(4)
    buffer_load_dwordx4 v1, s[12:15], s51 offen offset:0 nt lds
    s_add_u32 s51, s41, 1
    s_and_b32 s51, s51, 15
    s_lshl_b32 s51, s51, 14
    s_add_u32 s51, s51, s44
    s_add_u32 m0, s45, 65536
    s_waitcnt vmcnt(4)
    buffer_load_dwordx4 v2, s[12:15], s51 offen offset:1024 nt lds
    s_add_u32 s51, s41, 1
    s_and_b32 s51, s51, 15
    s_lshl_b32 s51, s51, 14
    s_add_u32 s51, s51, s44
    s_add_u32 m0, s45, 65536
    s_waitcnt vmcnt(4)
    buffer_load_dwordx4 v3, s[12:15], s51 offen offset:2048 nt lds
    s_add_u32 s51, s41, 1
    s_and_b32 s51, s51, 15
    s_lshl_b32 s51, s51, 14
    s_add_u32 s51, s51, s44
    s_add_u32 m0, s45, 65536
    s_waitcnt vmcnt(4)
    buffer_load_dwordx4 v4, s[12:15], s51 offen offset:3072 nt lds
    s_add_u32 s51, s41, 1
    s_and_b32 s51, s51, 15
    s_lshl_b32 s51, s51, 14
    s_add_u32 s51, s51, s44
    s_add_u32 m0, s45, 81920
    s_waitcnt vmcnt(4)
    buffer_load_dwordx4 v5, s[16:19], s51 offen offset:0 nt lds
    s_add_u32 s51, s41, 1
    s_and_b32 s51, s51, 15
    s_lshl_b32 s51, s51, 14
    s_add_u32 s51, s51, s44
    s_add_u32 m0, s45, 81920
    s_waitcnt vmcnt(4)
    buffer_load_dwordx4 v6, s[16:19], s51 offen offset:1024 nt lds
    s_add_u32 s51, s41, 1
    s_and_b32 s51, s51, 15
    s_lshl_b32 s51, s51, 14
    s_add_u32 s51, s51, s44
    s_add_u32 m0, s45, 81920
    s_waitcnt vmcnt(4)
    buffer_load_dwordx4 v5, s[16:19], s51 offen offset:2048 nt lds
    s_add_u32 s51, s41, 1
    s_and_b32 s51, s51, 15
    s_lshl_b32 s51, s51, 14
    s_add_u32 s51, s51, s44
    s_add_u32 m0, s45, 81920
    s_waitcnt vmcnt(4)
    buffer_load_dwordx4 v6, s[16:19], s51 offen offset:3072 nt lds
    v_bfe_u32 v15, v11, 2, 2
    v_lshl_add_u32 v14, v12, 2, v15
    v_lshlrev_b32 v14, 8, v14
    v_bfe_u32 v15, v11, 2, 3
    v_lshl_add_u32 v14, v15, 5, v14
    v_and_b32 v15, 3, v11
    v_lshl_add_u32 v14, v15, 3, v14
    v_add_u32 v244, 32768, v14
    v_xor_b32 v245, 32, v244
    v_xor_b32 v246, 64, v244
    v_xor_b32 v247, 96, v244
    v_xor_b32 v248, 128, v244
    v_xor_b32 v249, 160, v244
    v_xor_b32 v250, 192, v244
    v_xor_b32 v251, 224, v244
    v_xor_b32 v14, v12, v13
    v_lshlrev_b32 v14, 4, v14
    v_lshl_add_u32 v240, v13, 8, v14
    v_add_u32 v240, 32768, v240
    v_xor_b32 v241, 64, v240
    v_xor_b32 v242, 128, v240
    v_xor_b32 v243, 192, v240
    v_mov_b64 v[144:145], 0
    v_mov_b64 v[146:147], 0
    v_mov_b64 v[148:149], 0
    v_mov_b64 v[150:151], 0
    v_mov_b64 v[152:153], 0
    v_mov_b64 v[154:155], 0
    v_mov_b64 v[156:157], 0
    v_mov_b64 v[158:159], 0
    v_mov_b32 v252, 0x3f803f80
    v_mov_b32 v253, 0x3f803f80
    v_mov_b32 v254, 0x3f803f80
    v_mov_b32 v255, 0x3f803f80
    v_mov_b32 v128, 0xff800000
    v_mov_b32 v129, 0xff800000
    v_mov_b32 v130, 0xff800000
    v_mov_b32 v131, 0xff800000
    v_mov_b32 v132, 0xff800000
    v_mov_b32 v133, 0xff800000
    v_mov_b32 v134, 0xff800000
    v_mov_b32 v135, 0xff800000
    v_mov_b32 v136, 0xff800000
    v_mov_b32 v137, 0xff800000
    v_mov_b32 v138, 0xff800000
    v_mov_b32 v139, 0xff800000
    v_mov_b32 v140, 0xff800000
    v_mov_b32 v141, 0xff800000
    v_mov_b32 v142, 0xff800000
    v_mov_b32 v143, 0xff800000
    s_mov_b32 s47, 1
    s_mov_b32 s46, 0
    s_mov_b32 s49, 0xff800000
    s_mov_b32 s50, 0xff7fffff
    s_mov_b32 s58, 0
    s_branch L_att0
L_proA:
    s_cmp_eq_u32 s36, 0
    s_cbranch_scc0 L_cpf
    s_getpc_b64 s[90:91]
L_pc:
    s_sub_u32 s90, s90, L_pc-standalone__gqa_block_cached__near_ridge_kernel
    s_subb_u32 s91, s91, 0
    s_lshr_b32 s51, s2, 3
    s_mul_i32 s51, s51, 12
    v_min_u32 v14, 11, v11
    v_add_lshl_u32 v14, v14, s51, 7
    v_min_u32 v14, L_codeend-standalone__gqa_block_cached__near_ridge_kernel-4, v14
    global_load_dword v16, v14, s[90:91]
L_cpf:
    s_lshl_b32 s45, s37, 12
    v_bfe_u32 v15, v11, 2, 2
    v_lshl_add_u32 v14, v12, 3, v15
    v_lshlrev_b32 v14, 8, v14
    v_bfe_u32 v15, v11, 2, 3
    v_lshl_add_u32 v14, v15, 5, v14
    v_and_b32 v15, 3, v11
    v_lshl_add_u32 v14, v15, 3, v14
    v_add_u32 v244, 131072, v14
    v_xor_b32 v245, 32, v244
    v_xor_b32 v246, 64, v244
    v_xor_b32 v247, 96, v244
    v_xor_b32 v248, 128, v244
    v_xor_b32 v249, 160, v244
    v_xor_b32 v250, 192, v244
    v_xor_b32 v251, 224, v244
    v_lshrrev_b32 v14, 1, v13
    v_xor_b32 v14, v14, v12
    v_lshlrev_b32 v14, 4, v14
    v_lshl_add_u32 v14, v13, 7, v14
    s_add_u32 s51, s45, 98304
    v_add_u32 v252, s51, v14
    v_xor_b32 v253, 64, v252
    s_lshr_b32 s59, s61, 1
    s_lshl_b32 s85, s38, 2
    s_add_u32 s87, s85, s62
    s_add_u32 s85, s85, s59
    s_mul_i32 s85, s85, 1280
    s_lshl_b32 s98, s62, 4
    s_add_u32 s85, s85, s98
    s_add_u32 s85, s85, 41943040
    s_lshl_b32 s87, s87, 2
    s_add_u32 s98, s59, 1
    s_and_b32 s98, s98, 3
    s_add_u32 s98, s98, s87
    s_mul_i32 s98, s98, 1280
    s_add_u32 s98, s98, 42106880
    s_add_u32 s99, s59, 2
    s_and_b32 s99, s99, 3
    s_add_u32 s99, s99, s87
    s_mul_i32 s99, s99, 1280
    s_add_u32 s99, s99, 42106896
    s_add_u32 s100, s59, 3
    s_and_b32 s100, s100, 3
    s_add_u32 s100, s100, s87
    s_mul_i32 s100, s100, 1280
    s_add_u32 s100, s100, 42106912
    s_lshl_b32 s87, s37, 2
    s_add_u32 s85, s85, s87
    s_add_u32 s98, s98, s87
    s_add_u32 s99, s99, s87
    s_add_u32 s100, s100, s87
    s_bfe_u32 s86, s2, 0x30003
    s_add_u32 s86, s86, 1
    s_mov_b32 s41, 0
    s_lshl_b32 s45, s37, 12
    s_lshl_b32 s43, s38, 5
    s_add_u32 s43, s43, s39
    s_lshl_b32 s43, s43, 18
    s_add_u32 s44, s43, 1048576
    s_lshl_b32 s51, s37, 4
    v_add_u32 v14, s51, v12
    v_lshlrev_b32 v15, 1, v12
    v_xor_b32 v15, v15, v13
    v_lshlrev_b32 v15, 4, v15
    v_lshl_add_u32 v5, v14, 8, v15
    v_xor_b32 v6, 128, v5
    v_xor_b32 v15, v12, v13
    v_lshlrev_b32 v15, 4, v15
    v_lshl_add_u32 v1, v14, 8, v15
    v_xor_b32 v2, 64, v1
    v_xor_b32 v3, 128, v1
    v_xor_b32 v4, 192, v1
    s_waitcnt lgkmcnt(0)
    s_mov_b32 s12, s66
    s_mov_b32 s13, s67
    s_mov_b32 s14, 134217728
    s_mov_b32 s15, 0x20000
    s_mov_b32 s16, s68
    s_mov_b32 s17, s69
    s_mov_b32 s18, 134217728
    s_mov_b32 s19, 0x20000
    s_mov_b32 s24, s72
    s_mov_b32 s25, s73
    s_mov_b32 s26, 5242880
    s_mov_b32 s27, 0x20000
    s_mov_b32 s28, s74
    s_mov_b32 s29, s75
    s_mov_b32 s30, 2621440
    s_mov_b32 s31, 0x20000
    s_mov_b32 s32, s76
    s_mov_b32 s33, s77
    s_mov_b32 s34, 256
    s_mov_b32 s35, 0x20000
    s_mov_b32 s20, s78
    s_mov_b32 s21, s79
    s_mov_b32 s22, 67108864
    s_mov_b32 s23, 0x20000
    v_mov_b64 v[48:49], 0
    v_mov_b64 v[50:51], 0
    v_mov_b64 v[52:53], 0
    v_mov_b64 v[54:55], 0
    v_mov_b64 v[56:57], 0
    v_mov_b64 v[58:59], 0
    v_mov_b64 v[60:61], 0
    v_mov_b64 v[62:63], 0
    v_mov_b64 v[64:65], 0
    v_mov_b64 v[66:67], 0
    v_mov_b64 v[68:69], 0
    v_mov_b64 v[70:71], 0
    v_mov_b64 v[72:73], 0
    v_mov_b64 v[74:75], 0
    v_mov_b64 v[76:77], 0
    v_mov_b64 v[78:79], 0
    v_mov_b64 v[80:81], 0
    v_mov_b64 v[82:83], 0
    v_mov_b64 v[84:85], 0
    v_mov_b64 v[86:87], 0
    v_mov_b64 v[88:89], 0
    v_mov_b64 v[90:91], 0
    v_mov_b64 v[92:93], 0
    v_mov_b64 v[94:95], 0
    v_mov_b64 v[96:97], 0
    v_mov_b64 v[98:99], 0
    v_mov_b64 v[100:101], 0
    v_mov_b64 v[102:103], 0
    v_mov_b64 v[104:105], 0
    v_mov_b64 v[106:107], 0
    v_mov_b64 v[108:109], 0
    v_mov_b64 v[110:111], 0
    s_mov_b32 s46, 0
    s_barrier
    ds_read_b128 v[112:115], v252 offset:0
    ds_read_b128 v[116:119], v252 offset:2048
    ds_read_b64_tr_b16 v[176:177], v244 offset:0
    ds_read_b64_tr_b16 v[178:179], v244 offset:1024
    ds_read_b64_tr_b16 v[180:181], v245 offset:0
    ds_read_b64_tr_b16 v[182:183], v245 offset:1024
    ds_read_b64_tr_b16 v[184:185], v246 offset:0
    ds_read_b64_tr_b16 v[186:187], v246 offset:1024
    ds_read_b64_tr_b16 v[188:189], v247 offset:0
    ds_read_b64_tr_b16 v[190:191], v247 offset:1024
    ds_read_b64_tr_b16 v[192:193], v248 offset:0
    ds_read_b64_tr_b16 v[194:195], v248 offset:1024
    ds_read_b64_tr_b16 v[196:197], v249 offset:0
    ds_read_b64_tr_b16 v[198:199], v249 offset:1024
    ds_read_b64_tr_b16 v[200:201], v250 offset:0
    ds_read_b64_tr_b16 v[202:203], v250 offset:1024
    ds_read_b64_tr_b16 v[204:205], v251 offset:0
    ds_read_b64_tr_b16 v[206:207], v251 offset:1024
    ds_read_b128 v[120:123], v253 offset:0
    ds_read_b128 v[124:127], v253 offset:2048
    s_waitcnt lgkmcnt(0)
L_qa:
    s_barrier
    v_mfma_f32_16x16x32_bf16 v[48:51], v[176:179], v[112:115], v[48:51]
    ds_read_b64_tr_b16 v[208:209], v244 offset:8192
    ds_read_b64_tr_b16 v[210:211], v244 offset:9216
    v_mfma_f32_16x16x32_bf16 v[52:55], v[176:179], v[116:119], v[52:55]
    ds_read_b64_tr_b16 v[212:213], v245 offset:8192
    ds_read_b64_tr_b16 v[214:215], v245 offset:9216
    v_mfma_f32_16x16x32_bf16 v[56:59], v[180:183], v[112:115], v[56:59]
    ds_read_b64_tr_b16 v[216:217], v246 offset:8192
    ds_read_b64_tr_b16 v[218:219], v246 offset:9216
    v_mfma_f32_16x16x32_bf16 v[60:63], v[180:183], v[116:119], v[60:63]
    ds_read_b64_tr_b16 v[220:221], v247 offset:8192
    ds_read_b64_tr_b16 v[222:223], v247 offset:9216
    v_mfma_f32_16x16x32_bf16 v[64:67], v[184:187], v[112:115], v[64:67]
    ds_read_b64_tr_b16 v[224:225], v248 offset:8192
    ds_read_b64_tr_b16 v[226:227], v248 offset:9216
    v_mfma_f32_16x16x32_bf16 v[68:71], v[184:187], v[116:119], v[68:71]
    ds_read_b64_tr_b16 v[228:229], v249 offset:8192
    ds_read_b64_tr_b16 v[230:231], v249 offset:9216
    v_mfma_f32_16x16x32_bf16 v[72:75], v[188:191], v[112:115], v[72:75]
    ds_read_b64_tr_b16 v[232:233], v250 offset:8192
    ds_read_b64_tr_b16 v[234:235], v250 offset:9216
    v_mfma_f32_16x16x32_bf16 v[76:79], v[188:191], v[116:119], v[76:79]
    ds_read_b64_tr_b16 v[236:237], v251 offset:8192
    ds_read_b64_tr_b16 v[238:239], v251 offset:9216
    v_mfma_f32_16x16x32_bf16 v[80:83], v[192:195], v[112:115], v[80:83]
    v_mfma_f32_16x16x32_bf16 v[84:87], v[192:195], v[116:119], v[84:87]
    v_mfma_f32_16x16x32_bf16 v[88:91], v[196:199], v[112:115], v[88:91]
    v_mfma_f32_16x16x32_bf16 v[92:95], v[196:199], v[116:119], v[92:95]
    v_mfma_f32_16x16x32_bf16 v[96:99], v[200:203], v[112:115], v[96:99]
    v_mfma_f32_16x16x32_bf16 v[100:103], v[200:203], v[116:119], v[100:103]
    v_mfma_f32_16x16x32_bf16 v[104:107], v[204:207], v[112:115], v[104:107]
    v_mfma_f32_16x16x32_bf16 v[108:111], v[204:207], v[116:119], v[108:111]
    s_waitcnt lgkmcnt(0)
    s_barrier
    v_mfma_f32_16x16x32_bf16 v[48:51], v[208:211], v[120:123], v[48:51]
    ds_read_b128 v[128:131], v252 offset:16384
    ds_read_b128 v[132:135], v252 offset:18432
    v_mfma_f32_16x16x32_bf16 v[52:55], v[208:211], v[124:127], v[52:55]
    ds_read_b64_tr_b16 v[176:177], v244 offset:16384
    ds_read_b64_tr_b16 v[178:179], v244 offset:17408
    v_mfma_f32_16x16x32_bf16 v[56:59], v[212:215], v[120:123], v[56:59]
    ds_read_b64_tr_b16 v[180:181], v245 offset:16384
    ds_read_b64_tr_b16 v[182:183], v245 offset:17408
    v_mfma_f32_16x16x32_bf16 v[60:63], v[212:215], v[124:127], v[60:63]
    ds_read_b64_tr_b16 v[184:185], v246 offset:16384
    ds_read_b64_tr_b16 v[186:187], v246 offset:17408
    v_mfma_f32_16x16x32_bf16 v[64:67], v[216:219], v[120:123], v[64:67]
    ds_read_b64_tr_b16 v[188:189], v247 offset:16384
    ds_read_b64_tr_b16 v[190:191], v247 offset:17408
    v_mfma_f32_16x16x32_bf16 v[68:71], v[216:219], v[124:127], v[68:71]
    ds_read_b64_tr_b16 v[192:193], v248 offset:16384
    ds_read_b64_tr_b16 v[194:195], v248 offset:17408
    v_mfma_f32_16x16x32_bf16 v[72:75], v[220:223], v[120:123], v[72:75]
    ds_read_b64_tr_b16 v[196:197], v249 offset:16384
    ds_read_b64_tr_b16 v[198:199], v249 offset:17408
    v_mfma_f32_16x16x32_bf16 v[76:79], v[220:223], v[124:127], v[76:79]
    ds_read_b64_tr_b16 v[200:201], v250 offset:16384
    ds_read_b64_tr_b16 v[202:203], v250 offset:17408
    v_mfma_f32_16x16x32_bf16 v[80:83], v[224:227], v[120:123], v[80:83]
    ds_read_b64_tr_b16 v[204:205], v251 offset:16384
    ds_read_b64_tr_b16 v[206:207], v251 offset:17408
    v_mfma_f32_16x16x32_bf16 v[84:87], v[224:227], v[124:127], v[84:87]
    ds_read_b128 v[136:139], v253 offset:16384
    ds_read_b128 v[140:143], v253 offset:18432
    v_mfma_f32_16x16x32_bf16 v[88:91], v[228:231], v[120:123], v[88:91]
    v_mfma_f32_16x16x32_bf16 v[92:95], v[228:231], v[124:127], v[92:95]
    v_mfma_f32_16x16x32_bf16 v[96:99], v[232:235], v[120:123], v[96:99]
    v_mfma_f32_16x16x32_bf16 v[100:103], v[232:235], v[124:127], v[100:103]
    v_mfma_f32_16x16x32_bf16 v[104:107], v[236:239], v[120:123], v[104:107]
    v_mfma_f32_16x16x32_bf16 v[108:111], v[236:239], v[124:127], v[108:111]
    s_waitcnt lgkmcnt(0)
    s_barrier
    v_mfma_f32_16x16x32_bf16 v[48:51], v[176:179], v[128:131], v[48:51]
    ds_read_b64_tr_b16 v[208:209], v244 offset:24576
    ds_read_b64_tr_b16 v[210:211], v244 offset:25600
    v_mfma_f32_16x16x32_bf16 v[52:55], v[176:179], v[132:135], v[52:55]
    ds_read_b64_tr_b16 v[212:213], v245 offset:24576
    ds_read_b64_tr_b16 v[214:215], v245 offset:25600
    v_mfma_f32_16x16x32_bf16 v[56:59], v[180:183], v[128:131], v[56:59]
    ds_read_b64_tr_b16 v[216:217], v246 offset:24576
    ds_read_b64_tr_b16 v[218:219], v246 offset:25600
    v_mfma_f32_16x16x32_bf16 v[60:63], v[180:183], v[132:135], v[60:63]
    ds_read_b64_tr_b16 v[220:221], v247 offset:24576
    ds_read_b64_tr_b16 v[222:223], v247 offset:25600
    v_mfma_f32_16x16x32_bf16 v[64:67], v[184:187], v[128:131], v[64:67]
    ds_read_b64_tr_b16 v[224:225], v248 offset:24576
    ds_read_b64_tr_b16 v[226:227], v248 offset:25600
    v_mfma_f32_16x16x32_bf16 v[68:71], v[184:187], v[132:135], v[68:71]
    ds_read_b64_tr_b16 v[228:229], v249 offset:24576
    ds_read_b64_tr_b16 v[230:231], v249 offset:25600
    v_mfma_f32_16x16x32_bf16 v[72:75], v[188:191], v[128:131], v[72:75]
    ds_read_b64_tr_b16 v[232:233], v250 offset:24576
    ds_read_b64_tr_b16 v[234:235], v250 offset:25600
    v_mfma_f32_16x16x32_bf16 v[76:79], v[188:191], v[132:135], v[76:79]
    ds_read_b64_tr_b16 v[236:237], v251 offset:24576
    ds_read_b64_tr_b16 v[238:239], v251 offset:25600
    v_mfma_f32_16x16x32_bf16 v[80:83], v[192:195], v[128:131], v[80:83]
    v_mfma_f32_16x16x32_bf16 v[84:87], v[192:195], v[132:135], v[84:87]
    v_mfma_f32_16x16x32_bf16 v[88:91], v[196:199], v[128:131], v[88:91]
    v_mfma_f32_16x16x32_bf16 v[92:95], v[196:199], v[132:135], v[92:95]
    v_mfma_f32_16x16x32_bf16 v[96:99], v[200:203], v[128:131], v[96:99]
    v_mfma_f32_16x16x32_bf16 v[100:103], v[200:203], v[132:135], v[100:103]
    v_mfma_f32_16x16x32_bf16 v[104:107], v[204:207], v[128:131], v[104:107]
    v_mfma_f32_16x16x32_bf16 v[108:111], v[204:207], v[132:135], v[108:111]
    s_waitcnt lgkmcnt(0)
    s_barrier
    v_mfma_f32_16x16x32_bf16 v[48:51], v[208:211], v[136:139], v[48:51]
    ds_read_b128 v[112:115], v252 offset:0
    ds_read_b128 v[116:119], v252 offset:2048
    v_mfma_f32_16x16x32_bf16 v[52:55], v[208:211], v[140:143], v[52:55]
    ds_read_b64_tr_b16 v[176:177], v244 offset:0
    ds_read_b64_tr_b16 v[178:179], v244 offset:1024
    v_mfma_f32_16x16x32_bf16 v[56:59], v[212:215], v[136:139], v[56:59]
    ds_read_b64_tr_b16 v[180:181], v245 offset:0
    ds_read_b64_tr_b16 v[182:183], v245 offset:1024
    v_mfma_f32_16x16x32_bf16 v[60:63], v[212:215], v[140:143], v[60:63]
    ds_read_b64_tr_b16 v[184:185], v246 offset:0
    ds_read_b64_tr_b16 v[186:187], v246 offset:1024
    v_mfma_f32_16x16x32_bf16 v[64:67], v[216:219], v[136:139], v[64:67]
    ds_read_b64_tr_b16 v[188:189], v247 offset:0
    ds_read_b64_tr_b16 v[190:191], v247 offset:1024
    v_mfma_f32_16x16x32_bf16 v[68:71], v[216:219], v[140:143], v[68:71]
    ds_read_b64_tr_b16 v[192:193], v248 offset:0
    ds_read_b64_tr_b16 v[194:195], v248 offset:1024
    v_mfma_f32_16x16x32_bf16 v[72:75], v[220:223], v[136:139], v[72:75]
    ds_read_b64_tr_b16 v[196:197], v249 offset:0
    ds_read_b64_tr_b16 v[198:199], v249 offset:1024
    v_mfma_f32_16x16x32_bf16 v[76:79], v[220:223], v[140:143], v[76:79]
    ds_read_b64_tr_b16 v[200:201], v250 offset:0
    ds_read_b64_tr_b16 v[202:203], v250 offset:1024
    v_mfma_f32_16x16x32_bf16 v[80:83], v[224:227], v[136:139], v[80:83]
    ds_read_b64_tr_b16 v[204:205], v251 offset:0
    ds_read_b64_tr_b16 v[206:207], v251 offset:1024
    v_mfma_f32_16x16x32_bf16 v[84:87], v[224:227], v[140:143], v[84:87]
    ds_read_b128 v[120:123], v253 offset:0
    ds_read_b128 v[124:127], v253 offset:2048
    v_mfma_f32_16x16x32_bf16 v[88:91], v[228:231], v[136:139], v[88:91]
    v_mfma_f32_16x16x32_bf16 v[92:95], v[228:231], v[140:143], v[92:95]
    v_mfma_f32_16x16x32_bf16 v[96:99], v[232:235], v[136:139], v[96:99]
    v_mfma_f32_16x16x32_bf16 v[100:103], v[232:235], v[140:143], v[100:103]
    v_mfma_f32_16x16x32_bf16 v[104:107], v[236:239], v[136:139], v[104:107]
    v_mfma_f32_16x16x32_bf16 v[108:111], v[236:239], v[140:143], v[108:111]
    s_waitcnt lgkmcnt(0)
    s_add_u32 s46, s46, 1
    s_cmp_lt_u32 s46, 5
    s_cbranch_scc1 L_qa
    s_nop 7
    s_waitcnt vmcnt(0)
    s_mov_b32 s90, 0x3e0293ee
    s_mov_b32 s91, 0x3e0293ee
    v_pk_mul_f32 v[48:49], v[48:49], s[90:91]
    v_pk_mul_f32 v[50:51], v[50:51], s[90:91]
    v_pk_mul_f32 v[56:57], v[56:57], s[90:91]
    v_pk_mul_f32 v[58:59], v[58:59], s[90:91]
    v_cvt_pk_bf16_f32 v16, v48, v49
    v_cvt_pk_bf16_f32 v17, v50, v51
    v_cvt_pk_bf16_f32 v18, v56, v57
    v_cvt_pk_bf16_f32 v19, v58, v59
    v_mov_b64 v[48:49], 0
    v_mov_b64 v[50:51], 0
    v_mov_b64 v[56:57], 0
    v_mov_b64 v[58:59], 0
    v_permlane32_swap_b32 v16, v18
    v_permlane32_swap_b32 v17, v19
    s_nop 0
    v_permlane16_swap_b32 v16, v18
    v_permlane16_swap_b32 v17, v19
    v_pk_mul_f32 v[52:53], v[52:53], s[90:91]
    v_pk_mul_f32 v[54:55], v[54:55], s[90:91]
    v_pk_mul_f32 v[60:61], v[60:61], s[90:91]
    v_pk_mul_f32 v[62:63], v[62:63], s[90:91]
    v_cvt_pk_bf16_f32 v20, v52, v53
    v_cvt_pk_bf16_f32 v21, v54, v55
    v_cvt_pk_bf16_f32 v22, v60, v61
    v_cvt_pk_bf16_f32 v23, v62, v63
    v_mov_b64 v[52:53], 0
    v_mov_b64 v[54:55], 0
    v_mov_b64 v[60:61], 0
    v_mov_b64 v[62:63], 0
    v_permlane32_swap_b32 v20, v22
    v_permlane32_swap_b32 v21, v23
    s_nop 0
    v_permlane16_swap_b32 v20, v22
    v_permlane16_swap_b32 v21, v23
    v_pk_mul_f32 v[64:65], v[64:65], s[90:91]
    v_pk_mul_f32 v[66:67], v[66:67], s[90:91]
    v_pk_mul_f32 v[72:73], v[72:73], s[90:91]
    v_pk_mul_f32 v[74:75], v[74:75], s[90:91]
    v_cvt_pk_bf16_f32 v24, v64, v65
    v_cvt_pk_bf16_f32 v25, v66, v67
    v_cvt_pk_bf16_f32 v26, v72, v73
    v_cvt_pk_bf16_f32 v27, v74, v75
    v_mov_b64 v[64:65], 0
    v_mov_b64 v[66:67], 0
    v_mov_b64 v[72:73], 0
    v_mov_b64 v[74:75], 0
    v_permlane32_swap_b32 v24, v26
    v_permlane32_swap_b32 v25, v27
    s_nop 0
    v_permlane16_swap_b32 v24, v26
    v_permlane16_swap_b32 v25, v27
    v_pk_mul_f32 v[68:69], v[68:69], s[90:91]
    v_pk_mul_f32 v[70:71], v[70:71], s[90:91]
    v_pk_mul_f32 v[76:77], v[76:77], s[90:91]
    v_pk_mul_f32 v[78:79], v[78:79], s[90:91]
    v_cvt_pk_bf16_f32 v28, v68, v69
    v_cvt_pk_bf16_f32 v29, v70, v71
    v_cvt_pk_bf16_f32 v30, v76, v77
    v_cvt_pk_bf16_f32 v31, v78, v79
    v_mov_b64 v[68:69], 0
    v_mov_b64 v[70:71], 0
    v_mov_b64 v[76:77], 0
    v_mov_b64 v[78:79], 0
    v_permlane32_swap_b32 v28, v30
    v_permlane32_swap_b32 v29, v31
    s_nop 0
    v_permlane16_swap_b32 v28, v30
    v_permlane16_swap_b32 v29, v31
    v_pk_mul_f32 v[80:81], v[80:81], s[90:91]
    v_pk_mul_f32 v[82:83], v[82:83], s[90:91]
    v_pk_mul_f32 v[88:89], v[88:89], s[90:91]
    v_pk_mul_f32 v[90:91], v[90:91], s[90:91]
    v_cvt_pk_bf16_f32 v32, v80, v81
    v_cvt_pk_bf16_f32 v33, v82, v83
    v_cvt_pk_bf16_f32 v34, v88, v89
    v_cvt_pk_bf16_f32 v35, v90, v91
    v_mov_b64 v[80:81], 0
    v_mov_b64 v[82:83], 0
    v_mov_b64 v[88:89], 0
    v_mov_b64 v[90:91], 0
    v_permlane32_swap_b32 v32, v34
    v_permlane32_swap_b32 v33, v35
    s_nop 0
    v_permlane16_swap_b32 v32, v34
    v_permlane16_swap_b32 v33, v35
    v_pk_mul_f32 v[84:85], v[84:85], s[90:91]
    v_pk_mul_f32 v[86:87], v[86:87], s[90:91]
    v_pk_mul_f32 v[92:93], v[92:93], s[90:91]
    v_pk_mul_f32 v[94:95], v[94:95], s[90:91]
    v_cvt_pk_bf16_f32 v36, v84, v85
    v_cvt_pk_bf16_f32 v37, v86, v87
    v_cvt_pk_bf16_f32 v38, v92, v93
    v_cvt_pk_bf16_f32 v39, v94, v95
    v_mov_b64 v[84:85], 0
    v_mov_b64 v[86:87], 0
    v_mov_b64 v[92:93], 0
    v_mov_b64 v[94:95], 0
    v_permlane32_swap_b32 v36, v38
    v_permlane32_swap_b32 v37, v39
    s_nop 0
    v_permlane16_swap_b32 v36, v38
    v_permlane16_swap_b32 v37, v39
    v_pk_mul_f32 v[96:97], v[96:97], s[90:91]
    v_pk_mul_f32 v[98:99], v[98:99], s[90:91]
    v_pk_mul_f32 v[104:105], v[104:105], s[90:91]
    v_pk_mul_f32 v[106:107], v[106:107], s[90:91]
    v_cvt_pk_bf16_f32 v40, v96, v97
    v_cvt_pk_bf16_f32 v41, v98, v99
    v_cvt_pk_bf16_f32 v42, v104, v105
    v_cvt_pk_bf16_f32 v43, v106, v107
    v_mov_b64 v[96:97], 0
    v_mov_b64 v[98:99], 0
    v_mov_b64 v[104:105], 0
    v_mov_b64 v[106:107], 0
    v_permlane32_swap_b32 v40, v42
    v_permlane32_swap_b32 v41, v43
    s_nop 0
    v_permlane16_swap_b32 v40, v42
    v_permlane16_swap_b32 v41, v43
    v_pk_mul_f32 v[100:101], v[100:101], s[90:91]
    v_pk_mul_f32 v[102:103], v[102:103], s[90:91]
    v_pk_mul_f32 v[108:109], v[108:109], s[90:91]
    v_pk_mul_f32 v[110:111], v[110:111], s[90:91]
    v_cvt_pk_bf16_f32 v44, v100, v101
    v_cvt_pk_bf16_f32 v45, v102, v103
    v_cvt_pk_bf16_f32 v46, v108, v109
    v_cvt_pk_bf16_f32 v47, v110, v111
    v_mov_b64 v[100:101], 0
    v_mov_b64 v[102:103], 0
    v_mov_b64 v[108:109], 0
    v_mov_b64 v[110:111], 0
    v_permlane32_swap_b32 v44, v46
    v_permlane32_swap_b32 v45, v47
    s_nop 0
    v_permlane16_swap_b32 v44, v46
    v_permlane16_swap_b32 v45, v47
    v_bfe_u32 v15, v11, 2, 2
    v_lshl_add_u32 v14, v12, 2, v15
    v_lshlrev_b32 v14, 8, v14
    v_bfe_u32 v15, v11, 2, 3
    v_lshl_add_u32 v14, v15, 5, v14
    v_and_b32 v15, 3, v11
    v_lshl_add_u32 v14, v15, 3, v14
    v_add_u32 v244, 0, v14
    v_xor_b32 v245, 32, v244
    v_xor_b32 v246, 64, v244
    v_xor_b32 v247, 96, v244
    v_xor_b32 v248, 128, v244
    v_xor_b32 v249, 160, v244
    v_xor_b32 v250, 192, v244
    v_xor_b32 v251, 224, v244
    v_xor_b32 v14, v12, v13
    v_lshlrev_b32 v14, 4, v14
    v_lshl_add_u32 v240, v13, 8, v14
    v_xor_b32 v241, 64, v240
    v_xor_b32 v242, 128, v240
    v_xor_b32 v243, 192, v240
    v_mov_b64 v[144:145], 0
    v_mov_b64 v[146:147], 0
    v_mov_b64 v[148:149], 0
    v_mov_b64 v[150:151], 0
    v_mov_b64 v[152:153], 0
    v_mov_b64 v[154:155], 0
    v_mov_b64 v[156:157], 0
    v_mov_b64 v[158:159], 0
    v_mov_b32 v252, 0x3f803f80
    v_mov_b32 v253, 0x3f803f80
    v_mov_b32 v254, 0x3f803f80
    v_mov_b32 v255, 0x3f803f80
    v_mov_b32 v128, 0xff800000
    v_mov_b32 v129, 0xff800000
    v_mov_b32 v130, 0xff800000
    v_mov_b32 v131, 0xff800000
    v_mov_b32 v132, 0xff800000
    v_mov_b32 v133, 0xff800000
    v_mov_b32 v134, 0xff800000
    v_mov_b32 v135, 0xff800000
    v_mov_b32 v136, 0xff800000
    v_mov_b32 v137, 0xff800000
    v_mov_b32 v138, 0xff800000
    v_mov_b32 v139, 0xff800000
    v_mov_b32 v140, 0xff800000
    v_mov_b32 v141, 0xff800000
    v_mov_b32 v142, 0xff800000
    v_mov_b32 v143, 0xff800000
    s_mov_b32 s47, 0
    s_mov_b32 s46, 0
    s_mov_b32 s49, 0xff800000
    s_mov_b32 s50, 0xff7fffff
    s_mov_b32 s58, 1
L_att0:
    s_setprio 0
L_att:
    s_barrier
    ds_read_b128 v[176:179], v240 offset:0
    ds_read_b128 v[180:183], v241 offset:0
    ds_read_b128 v[184:187], v242 offset:0
    ds_read_b128 v[188:191], v243 offset:0
    ds_read_b128 v[192:195], v240 offset:4096
    ds_read_b128 v[196:199], v241 offset:4096
    ds_read_b128 v[200:203], v242 offset:4096
    ds_read_b128 v[204:207], v243 offset:4096
    v_exp_f32 v128, v128
    v_exp_f32 v129, v129
    v_exp_f32 v130, v130
    v_exp_f32 v131, v131
    v_cvt_pk_bf16_f32 v168, v128, v129
    v_exp_f32 v136, v136
    v_exp_f32 v137, v137
    s_waitcnt lgkmcnt(4)
    v_mfma_f32_16x16x32_bf16 v[112:115], v[176:179], v[16:19], v[144:147]
    v_cvt_pk_bf16_f32 v169, v130, v131
    v_exp_f32 v138, v138
    v_mfma_f32_16x16x32_bf16 v[116:119], v[176:179], v[20:23], v[148:151]
    v_exp_f32 v139, v139
    v_mfma_f32_16x16x32_bf16 v[112:115], v[180:183], v[24:27], v[112:115]
    v_cvt_pk_bf16_f32 v170, v136, v137
    v_exp_f32 v132, v132
    v_mfma_f32_16x16x32_bf16 v[116:119], v[180:183], v[28:31], v[116:119]
    v_exp_f32 v133, v133
    v_mfma_f32_16x16x32_bf16 v[112:115], v[184:187], v[32:35], v[112:115]
    v_cvt_pk_bf16_f32 v171, v138, v139
    v_exp_f32 v134, v134
    v_mfma_f32_16x16x32_bf16 v[116:119], v[184:187], v[36:39], v[116:119]
    v_exp_f32 v135, v135
    v_mfma_f32_16x16x32_bf16 v[112:115], v[188:191], v[40:43], v[112:115]
    v_cvt_pk_bf16_f32 v172, v132, v133
    v_exp_f32 v140, v140
    v_mfma_f32_16x16x32_bf16 v[116:119], v[188:191], v[44:47], v[116:119]
    v_exp_f32 v141, v141
    s_waitcnt lgkmcnt(0)
    v_mfma_f32_16x16x32_bf16 v[120:123], v[192:195], v[16:19], v[144:147]
    v_cvt_pk_bf16_f32 v173, v134, v135
    v_exp_f32 v142, v142
    v_mfma_f32_16x16x32_bf16 v[124:127], v[192:195], v[20:23], v[148:151]
    v_exp_f32 v143, v143
    v_mfma_f32_16x16x32_bf16 v[120:123], v[196:199], v[24:27], v[120:123]
    v_cvt_pk_bf16_f32 v174, v140, v141
    v_cvt_pk_bf16_f32 v175, v142, v143
    v_mfma_f32_16x16x32_bf16 v[124:127], v[196:199], v[28:31], v[124:127]
    ds_read_b128 v[176:179], v240 offset:8192
    ds_read_b128 v[180:183], v241 offset:8192
    v_mfma_f32_16x16x32_bf16 v[120:123], v[200:203], v[32:35], v[120:123]
    ds_read_b128 v[184:187], v242 offset:8192
    ds_read_b128 v[188:191], v243 offset:8192
    v_mfma_f32_16x16x32_bf16 v[124:127], v[200:203], v[36:39], v[124:127]
    ds_read_b128 v[192:195], v240 offset:12288
    ds_read_b128 v[196:199], v241 offset:12288
    v_mfma_f32_16x16x32_bf16 v[120:123], v[204:207], v[40:43], v[120:123]
    ds_read_b128 v[200:203], v242 offset:12288
    v_mfma_f32_16x16x32_bf16 v[124:127], v[204:207], v[44:47], v[124:127]
    ds_read_b128 v[204:207], v243 offset:12288
    v_mfma_f32_16x16x32_bf16 v[48:51], v[208:211], v[168:171], v[48:51]
    v_mfma_f32_16x16x32_bf16 v[52:55], v[208:211], v[172:175], v[52:55]
    ds_read_b64_tr_b16 v[208:209], v244 offset:16384
    ds_read_b64_tr_b16 v[210:211], v244 offset:20480
    v_mfma_f32_16x16x32_bf16 v[56:59], v[212:215], v[168:171], v[56:59]
    v_max3_f32 v14, v112, v113, v114
    v_max3_f32 v14, v14, v115, v116
    v_mfma_f32_16x16x32_bf16 v[60:63], v[212:215], v[172:175], v[60:63]
    v_max3_f32 v14, v14, v117, v118
    v_max3_f32 v14, v14, v119, v120
    v_mfma_f32_16x16x32_bf16 v[64:67], v[216:219], v[168:171], v[64:67]
    v_max3_f32 v14, v14, v121, v122
    v_max3_f32 v14, v14, v123, v124
    v_mfma_f32_16x16x32_bf16 v[68:71], v[216:219], v[172:175], v[68:71]
    v_max3_f32 v14, v14, v125, v126
    v_max_f32 v14, v14, v127
    v_mfma_f32_16x16x32_bf16 v[72:75], v[220:223], v[168:171], v[72:75]
    v_cmp_lt_f32 vcc, s49, v14
    s_nop 0
    s_cbranch_vccnz L_rare0
L_back0:
    v_mfma_f32_16x16x32_bf16 v[76:79], v[220:223], v[172:175], v[76:79]
    ds_read_b64_tr_b16 v[212:213], v245 offset:16384
    ds_read_b64_tr_b16 v[214:215], v245 offset:20480
    v_mfma_f32_16x16x32_bf16 v[80:83], v[224:227], v[168:171], v[80:83]
    ds_read_b64_tr_b16 v[216:217], v246 offset:16384
    ds_read_b64_tr_b16 v[218:219], v246 offset:20480
    v_mfma_f32_16x16x32_bf16 v[84:87], v[224:227], v[172:175], v[84:87]
    ds_read_b64_tr_b16 v[220:221], v247 offset:16384
    ds_read_b64_tr_b16 v[222:223], v247 offset:20480
    v_mfma_f32_16x16x32_bf16 v[88:91], v[228:231], v[168:171], v[88:91]
    v_exp_f32 v112, v112
    v_mfma_f32_16x16x32_bf16 v[92:95], v[228:231], v[172:175], v[92:95]
    v_exp_f32 v113, v113
    v_mfma_f32_16x16x32_bf16 v[96:99], v[232:235], v[168:171], v[96:99]
    ds_read_b64_tr_b16 v[224:225], v248 offset:16384
    ds_read_b64_tr_b16 v[226:227], v248 offset:20480
    v_mfma_f32_16x16x32_bf16 v[100:103], v[232:235], v[172:175], v[100:103]
    v_exp_f32 v114, v114
    v_mfma_f32_16x16x32_bf16 v[104:107], v[236:239], v[168:171], v[104:107]
    v_exp_f32 v115, v115
    v_mfma_f32_16x16x32_bf16 v[108:111], v[236:239], v[172:175], v[108:111]
    ds_read_b64_tr_b16 v[228:229], v249 offset:16384
    ds_read_b64_tr_b16 v[230:231], v249 offset:20480
    v_mfma_f32_16x16x32_bf16 v[152:155], v[252:255], v[168:171], v[152:155]
    ds_read_b64_tr_b16 v[232:233], v250 offset:16384
    ds_read_b64_tr_b16 v[234:235], v250 offset:20480
    v_mfma_f32_16x16x32_bf16 v[156:159], v[252:255], v[172:175], v[156:159]
    ds_read_b64_tr_b16 v[236:237], v251 offset:16384
    ds_read_b64_tr_b16 v[238:239], v251 offset:20480
    s_waitcnt lgkmcnt(15)
    v_mfma_f32_16x16x32_bf16 v[128:131], v[176:179], v[16:19], v[144:147]
    v_cvt_pk_bf16_f32 v160, v112, v113
    v_exp_f32 v120, v120
    v_mfma_f32_16x16x32_bf16 v[132:135], v[176:179], v[20:23], v[148:151]
    v_exp_f32 v121, v121
    v_mfma_f32_16x16x32_bf16 v[128:131], v[180:183], v[24:27], v[128:131]
    v_cvt_pk_bf16_f32 v161, v114, v115
    v_exp_f32 v122, v122
    v_mfma_f32_16x16x32_bf16 v[132:135], v[180:183], v[28:31], v[132:135]
    v_exp_f32 v123, v123
    v_mfma_f32_16x16x32_bf16 v[128:131], v[184:187], v[32:35], v[128:131]
    v_cvt_pk_bf16_f32 v162, v120, v121
    v_exp_f32 v116, v116
    v_mfma_f32_16x16x32_bf16 v[132:135], v[184:187], v[36:39], v[132:135]
    v_exp_f32 v117, v117
    v_mfma_f32_16x16x32_bf16 v[128:131], v[188:191], v[40:43], v[128:131]
    v_cvt_pk_bf16_f32 v163, v122, v123
    v_exp_f32 v118, v118
    v_mfma_f32_16x16x32_bf16 v[132:135], v[188:191], v[44:47], v[132:135]
    v_exp_f32 v119, v119
    v_mfma_f32_16x16x32_bf16 v[136:139], v[192:195], v[16:19], v[144:147]
    v_cvt_pk_bf16_f32 v164, v116, v117
    v_exp_f32 v124, v124
    v_mfma_f32_16x16x32_bf16 v[140:143], v[192:195], v[20:23], v[148:151]
    v_exp_f32 v125, v125
    v_mfma_f32_16x16x32_bf16 v[136:139], v[196:199], v[24:27], v[136:139]
    v_cvt_pk_bf16_f32 v165, v118, v119
    v_exp_f32 v126, v126
    v_mfma_f32_16x16x32_bf16 v[140:143], v[196:199], v[28:31], v[140:143]
    v_exp_f32 v127, v127
    v_mfma_f32_16x16x32_bf16 v[136:139], v[200:203], v[32:35], v[136:139]
    v_cvt_pk_bf16_f32 v166, v124, v125
    v_cvt_pk_bf16_f32 v167, v126, v127
    v_mfma_f32_16x16x32_bf16 v[140:143], v[200:203], v[36:39], v[140:143]
    v_mfma_f32_16x16x32_bf16 v[136:139], v[204:207], v[40:43], v[136:139]
    v_mfma_f32_16x16x32_bf16 v[140:143], v[204:207], v[44:47], v[140:143]
    s_waitcnt lgkmcnt(0)
    v_mfma_f32_16x16x32_bf16 v[48:51], v[208:211], v[160:163], v[48:51]
    s_mov_b32 s48, 32768
    s_add_u32 s47, s47, 1
    s_cmp_eq_u32 s47, 3
    s_cselect_b32 s48, 0xffff0000, s48
    v_mfma_f32_16x16x32_bf16 v[52:55], v[208:211], v[164:167], v[52:55]
    s_cselect_b32 s47, 0, s47
    s_add_u32 s46, s46, 1
    v_add_u32 v240, s48, v240
    v_mfma_f32_16x16x32_bf16 v[56:59], v[212:215], v[160:163], v[56:59]
    v_add_u32 v241, s48, v241
    v_add_u32 v242, s48, v242
    v_mfma_f32_16x16x32_bf16 v[60:63], v[212:215], v[164:167], v[60:63]
    v_add_u32 v243, s48, v243
    ds_read_b64_tr_b16 v[208:209], v244 offset:24576
    v_mfma_f32_16x16x32_bf16 v[64:67], v[216:219], v[160:163], v[64:67]
    ds_read_b64_tr_b16 v[210:211], v244 offset:28672
    v_add_u32 v244, s48, v244
    v_mfma_f32_16x16x32_bf16 v[68:71], v[216:219], v[164:167], v[68:71]
    v_max3_f32 v14, v128, v129, v130
    v_max3_f32 v14, v14, v131, v132
    v_mfma_f32_16x16x32_bf16 v[72:75], v[220:223], v[160:163], v[72:75]
    v_max3_f32 v14, v14, v133, v134
    v_max3_f32 v14, v14, v135, v136
    v_mfma_f32_16x16x32_bf16 v[76:79], v[220:223], v[164:167], v[76:79]
    v_max3_f32 v14, v14, v137, v138
    v_max3_f32 v14, v14, v139, v140
    v_mfma_f32_16x16x32_bf16 v[80:83], v[224:227], v[160:163], v[80:83]
    v_max3_f32 v14, v14, v141, v142
    v_max_f32 v14, v14, v143
    v_mfma_f32_16x16x32_bf16 v[84:87], v[224:227], v[164:167], v[84:87]
    v_cmp_lt_f32 vcc, s49, v14
    s_nop 0
    s_cbranch_vccnz L_rare1
L_back1:
    v_mfma_f32_16x16x32_bf16 v[88:91], v[228:231], v[160:163], v[88:91]
    ds_read_b64_tr_b16 v[212:213], v245 offset:24576
    ds_read_b64_tr_b16 v[214:215], v245 offset:28672
    v_mfma_f32_16x16x32_bf16 v[92:95], v[228:231], v[164:167], v[92:95]
    v_add_u32 v245, s48, v245
    ds_read_b64_tr_b16 v[216:217], v246 offset:24576
    v_mfma_f32_16x16x32_bf16 v[96:99], v[232:235], v[160:163], v[96:99]
    ds_read_b64_tr_b16 v[218:219], v246 offset:28672
    v_add_u32 v246, s48, v246
    v_mfma_f32_16x16x32_bf16 v[100:103], v[232:235], v[164:167], v[100:103]
    ds_read_b64_tr_b16 v[220:221], v247 offset:24576
    ds_read_b64_tr_b16 v[222:223], v247 offset:28672
    v_mfma_f32_16x16x32_bf16 v[104:107], v[236:239], v[160:163], v[104:107]
    v_add_u32 v247, s48, v247
    ds_read_b64_tr_b16 v[224:225], v248 offset:24576
    v_mfma_f32_16x16x32_bf16 v[108:111], v[236:239], v[164:167], v[108:111]
    ds_read_b64_tr_b16 v[226:227], v248 offset:28672
    v_add_u32 v248, s48, v248
    v_mfma_f32_16x16x32_bf16 v[152:155], v[252:255], v[160:163], v[152:155]
    ds_read_b64_tr_b16 v[228:229], v249 offset:24576
    ds_read_b64_tr_b16 v[230:231], v249 offset:28672
    v_mfma_f32_16x16x32_bf16 v[156:159], v[252:255], v[164:167], v[156:159]
    v_add_u32 v249, s48, v249
    ds_read_b64_tr_b16 v[232:233], v250 offset:24576
    ds_read_b64_tr_b16 v[234:235], v250 offset:28672
    v_add_u32 v250, s48, v250
    ds_read_b64_tr_b16 v[236:237], v251 offset:24576
    ds_read_b64_tr_b16 v[238:239], v251 offset:28672
    v_add_u32 v251, s48, v251
    s_cmp_lt_u32 s46, 16
    s_waitcnt vmcnt(0) lgkmcnt(0)
    s_cbranch_scc1 L_att
    s_setprio 0
    s_cmp_eq_u32 s40, 0
    s_cbranch_scc0 L_tailB
    s_barrier
    s_add_u32 s51, s41, 2
    s_and_b32 s51, s51, 15
    s_lshl_b32 s51, s51, 14
    s_add_u32 s51, s51, s44
    s_add_u32 m0, s45, 0
    s_nop 0
    buffer_load_dwordx4 v1, s[12:15], s51 offen offset:0 nt lds
    v_exp_f32 v128, v128
    v_exp_f32 v129, v129
    v_exp_f32 v130, v130
    v_exp_f32 v131, v131
    v_cvt_pk_bf16_f32 v168, v128, v129
    v_exp_f32 v136, v136
    v_exp_f32 v137, v137
    v_cvt_pk_bf16_f32 v169, v130, v131
    v_exp_f32 v138, v138
    v_exp_f32 v139, v139
    v_cvt_pk_bf16_f32 v170, v136, v137
    v_exp_f32 v132, v132
    v_exp_f32 v133, v133
    v_cvt_pk_bf16_f32 v171, v138, v139
    v_exp_f32 v134, v134
    s_add_u32 s51, s41, 2
    s_and_b32 s51, s51, 15
    s_lshl_b32 s51, s51, 14
    s_add_u32 s51, s51, s44
    s_add_u32 m0, s45, 0
    s_nop 0
    buffer_load_dwordx4 v2, s[12:15], s51 offen offset:1024 nt lds
    v_exp_f32 v135, v135
    v_cvt_pk_bf16_f32 v172, v132, v133
    v_exp_f32 v140, v140
    v_exp_f32 v141, v141
    v_cvt_pk_bf16_f32 v173, v134, v135
    v_exp_f32 v142, v142
    v_exp_f32 v143, v143
    v_cvt_pk_bf16_f32 v174, v140, v141
    v_cvt_pk_bf16_f32 v175, v142, v143
    v_mfma_f32_16x16x32_bf16 v[48:51], v[208:211], v[168:171], v[48:51]
    s_nop 0
    v_mfma_f32_16x16x32_bf16 v[52:55], v[208:211], v[172:175], v[52:55]
    v_mfma_f32_16x16x32_bf16 v[56:59], v[212:215], v[168:171], v[56:59]
    v_mfma_f32_16x16x32_bf16 v[60:63], v[212:215], v[172:175], v[60:63]
    v_mfma_f32_16x16x32_bf16 v[64:67], v[216:219], v[168:171], v[64:67]
    v_mfma_f32_16x16x32_bf16 v[68:71], v[216:219], v[172:175], v[68:71]
    s_add_u32 s51, s41, 2
    s_and_b32 s51, s51, 15
    s_lshl_b32 s51, s51, 14
    s_add_u32 s51, s51, s44
    s_add_u32 m0, s45, 0
    s_nop 0
    buffer_load_dwordx4 v3, s[12:15], s51 offen offset:2048 nt lds
    v_mfma_f32_16x16x32_bf16 v[72:75], v[220:223], v[168:171], v[72:75]
    v_mfma_f32_16x16x32_bf16 v[76:79], v[220:223], v[172:175], v[76:79]
    v_mfma_f32_16x16x32_bf16 v[80:83], v[224:227], v[168:171], v[80:83]
    v_mfma_f32_16x16x32_bf16 v[84:87], v[224:227], v[172:175], v[84:87]
    v_mfma_f32_16x16x32_bf16 v[88:91], v[228:231], v[168:171], v[88:91]
    v_mfma_f32_16x16x32_bf16 v[92:95], v[228:231], v[172:175], v[92:95]
    v_mfma_f32_16x16x32_bf16 v[96:99], v[232:235], v[168:171], v[96:99]
    v_mfma_f32_16x16x32_bf16 v[100:103], v[232:235], v[172:175], v[100:103]
    v_mfma_f32_16x16x32_bf16 v[104:107], v[236:239], v[168:171], v[104:107]
    v_mfma_f32_16x16x32_bf16 v[108:111], v[236:239], v[172:175], v[108:111]
    v_mfma_f32_16x16x32_bf16 v[152:155], v[252:255], v[168:171], v[152:155]
    v_mfma_f32_16x16x32_bf16 v[156:159], v[252:255], v[172:175], v[156:159]
    s_nop 6
    v_rcp_f32 v176, v152
    v_rcp_f32 v178, v156
    v_lshlrev_b32 v10, 4, v11
    s_add_u32 s51, s41, 2
    s_and_b32 s51, s51, 15
    s_lshl_b32 s51, s51, 14
    s_add_u32 s51, s51, s44
    s_add_u32 m0, s45, 0
    s_nop 0
    buffer_load_dwordx4 v4, s[12:15], s51 offen offset:3072 nt lds
    s_lshl_b32 s53, s38, 5
    s_add_u32 s53, s53, s54
    s_lshl_b32 s53, s53, 15
    s_lshl_b32 s87, s37, 11
    s_add_u32 s53, s53, s87
    v_mov_b32 v177, v176
    v_mov_b32 v179, v178
    v_pk_mul_f32 v[48:49], v[48:49], v[176:177]
    v_pk_mul_f32 v[50:51], v[50:51], v[176:177]
    v_pk_mul_f32 v[56:57], v[56:57], v[176:177]
    v_pk_mul_f32 v[58:59], v[58:59], v[176:177]
    v_cvt_pk_bf16_f32 v112, v48, v49
    v_cvt_pk_bf16_f32 v113, v50, v51
    v_cvt_pk_bf16_f32 v114, v56, v57
    v_cvt_pk_bf16_f32 v115, v58, v59
    s_add_u32 s51, s41, 2
    s_and_b32 s51, s51, 15
    s_lshl_b32 s51, s51, 14
    s_add_u32 s51, s51, s44
    s_add_u32 m0, s45, 16384
    s_nop 0
    buffer_load_dwordx4 v5, s[16:19], s51 offen offset:0 nt lds
    v_pk_mul_f32 v[52:53], v[52:53], v[178:179]
    v_pk_mul_f32 v[54:55], v[54:55], v[178:179]
    v_pk_mul_f32 v[60:61], v[60:61], v[178:179]
    v_pk_mul_f32 v[62:63], v[62:63], v[178:179]
    v_cvt_pk_bf16_f32 v116, v52, v53
    v_cvt_pk_bf16_f32 v117, v54, v55
    v_cvt_pk_bf16_f32 v118, v60, v61
    v_cvt_pk_bf16_f32 v119, v62, v63
    v_pk_mul_f32 v[64:65], v[64:65], v[176:177]
    v_pk_mul_f32 v[66:67], v[66:67], v[176:177]
    v_pk_mul_f32 v[72:73], v[72:73], v[176:177]
    v_pk_mul_f32 v[74:75], v[74:75], v[176:177]
    v_cvt_pk_bf16_f32 v120, v64, v65
    v_cvt_pk_bf16_f32 v121, v66, v67
    v_cvt_pk_bf16_f32 v122, v72, v73
    s_add_u32 s51, s41, 2
    s_and_b32 s51, s51, 15
    s_lshl_b32 s51, s51, 14
    s_add_u32 s51, s51, s44
    s_add_u32 m0, s45, 16384
    s_waitcnt vmcnt(4)
    buffer_load_dwordx4 v6, s[16:19], s51 offen offset:1024 nt lds
    v_cvt_pk_bf16_f32 v123, v74, v75
    v_pk_mul_f32 v[68:69], v[68:69], v[178:179]
    v_pk_mul_f32 v[70:71], v[70:71], v[178:179]
    v_pk_mul_f32 v[76:77], v[76:77], v[178:179]
    v_pk_mul_f32 v[78:79], v[78:79], v[178:179]
    v_cvt_pk_bf16_f32 v124, v68, v69
    v_cvt_pk_bf16_f32 v125, v70, v71
    v_cvt_pk_bf16_f32 v126, v76, v77
    v_cvt_pk_bf16_f32 v127, v78, v79
    v_pk_mul_f32 v[80:81], v[80:81], v[176:177]
    v_pk_mul_f32 v[82:83], v[82:83], v[176:177]
    v_pk_mul_f32 v[88:89], v[88:89], v[176:177]
    v_pk_mul_f32 v[90:91], v[90:91], v[176:177]
    v_cvt_pk_bf16_f32 v128, v80, v81
    v_cvt_pk_bf16_f32 v129, v82, v83
    s_add_u32 s51, s41, 2
    s_and_b32 s51, s51, 15
    s_lshl_b32 s51, s51, 14
    s_add_u32 s51, s51, s44
    s_add_u32 m0, s45, 16384
    s_waitcnt vmcnt(4)
    buffer_load_dwordx4 v5, s[16:19], s51 offen offset:2048 nt lds
    v_cvt_pk_bf16_f32 v130, v88, v89
    v_cvt_pk_bf16_f32 v131, v90, v91
    v_pk_mul_f32 v[84:85], v[84:85], v[178:179]
    v_pk_mul_f32 v[86:87], v[86:87], v[178:179]
    v_pk_mul_f32 v[92:93], v[92:93], v[178:179]
    v_pk_mul_f32 v[94:95], v[94:95], v[178:179]
    v_cvt_pk_bf16_f32 v132, v84, v85
    v_cvt_pk_bf16_f32 v133, v86, v87
    v_cvt_pk_bf16_f32 v134, v92, v93
    v_cvt_pk_bf16_f32 v135, v94, v95
    v_pk_mul_f32 v[96:97], v[96:97], v[176:177]
    v_pk_mul_f32 v[98:99], v[98:99], v[176:177]
    v_pk_mul_f32 v[104:105], v[104:105], v[176:177]
    v_pk_mul_f32 v[106:107], v[106:107], v[176:177]
    v_cvt_pk_bf16_f32 v136, v96, v97
    s_add_u32 s51, s41, 2
    s_and_b32 s51, s51, 15
    s_lshl_b32 s51, s51, 14
    s_add_u32 s51, s51, s44
    s_add_u32 m0, s45, 16384
    s_waitcnt vmcnt(4)
    buffer_load_dwordx4 v6, s[16:19], s51 offen offset:3072 nt lds
    v_cvt_pk_bf16_f32 v137, v98, v99
    v_cvt_pk_bf16_f32 v138, v104, v105
    v_cvt_pk_bf16_f32 v139, v106, v107
    v_pk_mul_f32 v[100:101], v[100:101], v[178:179]
    v_pk_mul_f32 v[102:103], v[102:103], v[178:179]
    v_pk_mul_f32 v[108:109], v[108:109], v[178:179]
    v_pk_mul_f32 v[110:111], v[110:111], v[178:179]
    v_cvt_pk_bf16_f32 v140, v100, v101
    v_cvt_pk_bf16_f32 v141, v102, v103
    v_cvt_pk_bf16_f32 v142, v108, v109
    v_cvt_pk_bf16_f32 v143, v110, v111
    s_barrier
    s_add_u32 s51, s41, 3
    s_and_b32 s51, s51, 15
    s_lshl_b32 s51, s51, 14
    s_add_u32 s51, s51, s44
    s_add_u32 m0, s45, 32768
    s_waitcnt vmcnt(4)
    buffer_load_dwordx4 v1, s[12:15], s51 offen offset:0 nt lds
    s_add_u32 s51, s41, 3
    s_and_b32 s51, s51, 15
    s_lshl_b32 s51, s51, 14
    s_add_u32 s51, s51, s44
    s_add_u32 m0, s45, 32768
    s_waitcnt vmcnt(4)
    buffer_load_dwordx4 v2, s[12:15], s51 offen offset:1024 nt lds
    s_add_u32 s51, s41, 3
    s_and_b32 s51, s51, 15
    s_lshl_b32 s51, s51, 14
    s_add_u32 s51, s51, s44
    s_add_u32 m0, s45, 32768
    s_waitcnt vmcnt(4)
    buffer_load_dwordx4 v3, s[12:15], s51 offen offset:2048 nt lds
    s_add_u32 s51, s41, 3
    s_and_b32 s51, s51, 15
    s_lshl_b32 s51, s51, 14
    s_add_u32 s51, s51, s44
    s_add_u32 m0, s45, 32768
    s_waitcnt vmcnt(4)
    buffer_load_dwordx4 v4, s[12:15], s51 offen offset:3072 nt lds
    s_add_u32 s51, s41, 3
    s_and_b32 s51, s51, 15
    s_lshl_b32 s51, s51, 14
    s_add_u32 s51, s51, s44
    s_add_u32 m0, s45, 49152
    s_waitcnt vmcnt(4)
    buffer_load_dwordx4 v5, s[16:19], s51 offen offset:0 nt lds
    s_add_u32 s51, s41, 3
    s_and_b32 s51, s51, 15
    s_lshl_b32 s51, s51, 14
    s_add_u32 s51, s51, s44
    s_add_u32 m0, s45, 49152
    s_waitcnt vmcnt(4)
    buffer_load_dwordx4 v6, s[16:19], s51 offen offset:1024 nt lds
    s_add_u32 s51, s41, 3
    s_and_b32 s51, s51, 15
    s_lshl_b32 s51, s51, 14
    s_add_u32 s51, s51, s44
    s_add_u32 m0, s45, 49152
    s_waitcnt vmcnt(4)
    buffer_load_dwordx4 v5, s[16:19], s51 offen offset:2048 nt lds
    s_add_u32 s51, s41, 3
    s_and_b32 s51, s51, 15
    s_lshl_b32 s51, s51, 14
    s_add_u32 s51, s51, s44
    s_add_u32 m0, s45, 49152
    s_waitcnt vmcnt(4)
    buffer_load_dwordx4 v6, s[16:19], s51 offen offset:3072 nt lds
    v_add_u32 v14, 0, v11
    v_mul_u32_u24 v15, 3277, v14
    v_lshrrev_b32 v15, 16, v15
    v_mul_u32_u24 v230, 20, v15
    v_sub_u32 v14, v14, v230
    v_bfe_u32 v230, v15, 2, 1
    v_lshlrev_b32 v230, 1, v230
    v_xor_b32 v14, v14, v230
    v_mul_u32_u24 v15, 1280, v15
    v_lshl_add_u32 v216, v14, 4, v15
    v_add_u32 v14, 64, v11
    v_mul_u32_u24 v15, 3277, v14
    v_lshrrev_b32 v15, 16, v15
    v_mul_u32_u24 v230, 20, v15
    v_sub_u32 v14, v14, v230
    v_bfe_u32 v230, v15, 2, 1
    v_lshlrev_b32 v230, 1, v230
    v_xor_b32 v14, v14, v230
    v_mul_u32_u24 v15, 1280, v15
    v_lshl_add_u32 v217, v14, 4, v15
    v_subrev_u32 v217, 1024, v217
    v_add_u32 v14, 128, v11
    v_mul_u32_u24 v15, 3277, v14
    v_lshrrev_b32 v15, 16, v15
    v_mul_u32_u24 v230, 20, v15
    v_sub_u32 v14, v14, v230
    v_bfe_u32 v230, v15, 2, 1
    v_lshlrev_b32 v230, 1, v230
    v_xor_b32 v14, v14, v230
    v_mul_u32_u24 v15, 1280, v15
    v_lshl_add_u32 v218, v14, 4, v15
    v_subrev_u32 v218, 2048, v218
    v_add_u32 v14, 192, v11
    v_mul_u32_u24 v15, 3277, v14
    v_lshrrev_b32 v15, 16, v15
    v_mul_u32_u24 v230, 20, v15
    v_sub_u32 v14, v14, v230
    v_bfe_u32 v230, v15, 2, 1
    v_lshlrev_b32 v230, 1, v230
    v_xor_b32 v14, v14, v230
    v_mul_u32_u24 v15, 1280, v15
    v_lshl_add_u32 v219, v14, 4, v15
    v_subrev_u32 v219, 3072, v219
    v_add_u32 v14, 256, v11
    v_mul_u32_u24 v15, 3277, v14
    v_lshrrev_b32 v15, 16, v15
    v_mul_u32_u24 v230, 20, v15
    v_sub_u32 v14, v14, v230
    v_bfe_u32 v230, v15, 2, 1
    v_lshlrev_b32 v230, 1, v230
    v_xor_b32 v14, v14, v230
    v_mul_u32_u24 v15, 1280, v15
    v_lshl_add_u32 v220, v14, 4, v15
    v_lshlrev_b32 v221, 4, v11
    s_lshl_b32 s83, s38, 2
    s_add_u32 s83, s83, s59
    s_mul_i32 s96, s83, 1280
    s_add_u32 s96, s96, 41943040
    s_lshl_b32 s83, s83, 18
    s_add_u32 s83, s83, s45
    s_lshl_b32 s84, s59, 6
    s_add_u32 s84, s84, s37
    s_mul_i32 s84, s84, 20480
    s_mul_i32 s51, s62, 320
    s_add_u32 s84, s84, s51
    s_mul_i32 s88, s37, 5120
    s_and_b32 s63, s38, 3
    s_lshl_b32 s51, s62, 1
    s_add_u32 s63, s63, s51
    s_add_u32 s63, s63, 2
    v_lshlrev_b32 v229, 2, v13
    s_barrier
    s_add_u32 s51, s41, 4
    s_and_b32 s51, s51, 15
    s_lshl_b32 s51, s51, 14
    s_add_u32 s51, s51, s44
    s_add_u32 m0, s45, 65536
    s_waitcnt vmcnt(4)
    buffer_load_dwordx4 v1, s[12:15], s51 offen offset:0 nt lds
    s_add_u32 s51, s41, 4
    s_and_b32 s51, s51, 15
    s_lshl_b32 s51, s51, 14
    s_add_u32 s51, s51, s44
    s_add_u32 m0, s45, 65536
    s_waitcnt vmcnt(4)
    buffer_load_dwordx4 v2, s[12:15], s51 offen offset:1024 nt lds
    s_add_u32 s51, s41, 4
    s_and_b32 s51, s51, 15
    s_lshl_b32 s51, s51, 14
    s_add_u32 s51, s51, s44
    s_add_u32 m0, s45, 65536
    s_waitcnt vmcnt(4)
    buffer_load_dwordx4 v3, s[12:15], s51 offen offset:2048 nt lds
    s_add_u32 s51, s41, 4
    s_and_b32 s51, s51, 15
    s_lshl_b32 s51, s51, 14
    s_add_u32 s51, s51, s44
    s_add_u32 m0, s45, 65536
    s_waitcnt vmcnt(4)
    buffer_load_dwordx4 v4, s[12:15], s51 offen offset:3072 nt lds
    s_add_u32 s51, s41, 4
    s_and_b32 s51, s51, 15
    s_lshl_b32 s51, s51, 14
    s_add_u32 s51, s51, s44
    s_add_u32 m0, s45, 81920
    s_waitcnt vmcnt(4)
    buffer_load_dwordx4 v5, s[16:19], s51 offen offset:0 nt lds
    s_add_u32 s51, s41, 4
    s_and_b32 s51, s51, 15
    s_lshl_b32 s51, s51, 14
    s_add_u32 s51, s51, s44
    s_add_u32 m0, s45, 81920
    s_waitcnt vmcnt(4)
    buffer_load_dwordx4 v6, s[16:19], s51 offen offset:1024 nt lds
    s_add_u32 s51, s41, 4
    s_and_b32 s51, s51, 15
    s_lshl_b32 s51, s51, 14
    s_add_u32 s51, s51, s44
    s_add_u32 m0, s45, 81920
    s_waitcnt vmcnt(4)
    buffer_load_dwordx4 v5, s[16:19], s51 offen offset:2048 nt lds
    s_add_u32 s51, s41, 4
    s_and_b32 s51, s51, 15
    s_lshl_b32 s51, s51, 14
    s_add_u32 s51, s51, s44
    s_add_u32 m0, s45, 81920
    s_waitcnt vmcnt(4)
    buffer_load_dwordx4 v6, s[16:19], s51 offen offset:3072 nt lds
    v_bfe_u32 v14, v11, 2, 1
    v_lshl_add_u32 v14, v14, 1, s63
    v_bfe_u32 v14, v14, 1, 2
    v_and_b32 v15, 3, v11
    v_lshl_add_u32 v14, v14, 2, v15
    v_lshlrev_b32 v232, 2, v14
    s_and_b32 s52, s37, 2
    s_lshl_b32 s52, s52, 1
    s_add_u32 s51, s59, 0
    s_and_b32 s51, s51, 3
    s_add_u32 s51, s51, s52
    s_lshl_b32 s51, s51, 10
    s_add_u32 s51, s51, 147456
    v_add_u32 v222, s51, v221
    s_add_u32 s51, s59, 1
    s_and_b32 s51, s51, 3
    s_add_u32 s51, s51, s52
    s_lshl_b32 s51, s51, 10
    s_add_u32 s51, s51, 147456
    v_add_u32 v223, s51, v221
    s_add_u32 s51, s59, 2
    s_and_b32 s51, s51, 3
    s_add_u32 s51, s51, s52
    s_lshl_b32 s51, s51, 10
    s_add_u32 s51, s51, 147456
    v_add_u32 v224, s51, v221
    s_add_u32 s51, s59, 3
    s_and_b32 s51, s51, 3
    s_add_u32 s51, s51, s52
    s_lshl_b32 s51, s51, 10
    s_add_u32 s51, s51, 147456
    v_add_u32 v225, s51, v221
    v_lshrrev_b32 v14, 2, v11
    v_mul_u32_u24 v14, 320, v14
    v_and_b32 v15, 3, v11
    v_lshl_add_u32 v14, v15, 3, v14
    s_and_b32 s52, s37, 1
    s_mul_i32 s51, s52, 160
    s_add_u32 s51, s51, 126976
    v_add_u32 v14, s51, v14
    v_and_b32 v15, 1, v12
    s_mul_i32 s52, s52, -64
    s_add_u32 s52, s52, 32
    v_mul_lo_u32 v15, v15, s52
    v_add_u32 v226, v14, v15
    v_sub_u32 v227, v14, v15
    s_barrier
    s_add_u32 s51, s41, 5
    s_and_b32 s51, s51, 15
    s_lshl_b32 s51, s51, 14
    s_add_u32 s51, s51, s44
    s_add_u32 m0, s45, 0
    s_waitcnt vmcnt(4)
    buffer_load_dwordx4 v1, s[12:15], s51 offen offset:0 nt lds
    s_add_u32 s51, s41, 5
    s_and_b32 s51, s51, 15
    s_lshl_b32 s51, s51, 14
    s_add_u32 s51, s51, s44
    s_add_u32 m0, s45, 0
    s_waitcnt vmcnt(4)
    buffer_load_dwordx4 v2, s[12:15], s51 offen offset:1024 nt lds
    s_add_u32 s51, s41, 5
    s_and_b32 s51, s51, 15
    s_lshl_b32 s51, s51, 14
    s_add_u32 s51, s51, s44
    s_add_u32 m0, s45, 0
    s_waitcnt vmcnt(4)
    buffer_load_dwordx4 v3, s[12:15], s51 offen offset:2048 nt lds
    s_add_u32 s51, s41, 5
    s_and_b32 s51, s51, 15
    s_lshl_b32 s51, s51, 14
    s_add_u32 s51, s51, s44
    s_add_u32 m0, s45, 0
    s_waitcnt vmcnt(4)
    buffer_load_dwordx4 v4, s[12:15], s51 offen offset:3072 nt lds
    s_add_u32 s51, s41, 5
    s_and_b32 s51, s51, 15
    s_lshl_b32 s51, s51, 14
    s_add_u32 s51, s51, s44
    s_add_u32 m0, s45, 16384
    s_waitcnt vmcnt(4)
    buffer_load_dwordx4 v5, s[16:19], s51 offen offset:0 nt lds
    s_add_u32 s51, s41, 5
    s_and_b32 s51, s51, 15
    s_lshl_b32 s51, s51, 14
    s_add_u32 s51, s51, s44
    s_add_u32 m0, s45, 16384
    s_waitcnt vmcnt(4)
    buffer_load_dwordx4 v6, s[16:19], s51 offen offset:1024 nt lds
    s_add_u32 s51, s41, 5
    s_and_b32 s51, s51, 15
    s_lshl_b32 s51, s51, 14
    s_add_u32 s51, s51, s44
    s_add_u32 m0, s45, 16384
    s_waitcnt vmcnt(4)
    buffer_load_dwordx4 v5, s[16:19], s51 offen offset:2048 nt lds
    s_add_u32 s51, s41, 5
    s_and_b32 s51, s51, 15
    s_lshl_b32 s51, s51, 14
    s_add_u32 s51, s51, s44
    s_add_u32 m0, s45, 16384
    s_waitcnt vmcnt(4)
    buffer_load_dwordx4 v6, s[16:19], s51 offen offset:3072 nt lds
    s_lshl_b32 s82, s38, 2
    s_add_u32 s82, s82, s62
    s_lshl_b32 s82, s82, 2
    s_mul_i32 s95, s37, 2560
    s_add_u32 s95, s95, 16777216
    s_add_u32 s86, s82, s59
    s_mul_i32 s86, s86, 1280
    s_lshl_b32 s51, s37, 2
    s_add_u32 s86, s86, s51
    s_add_u32 s86, s86, 42106880
    s_lshl_b32 s3, s38, 3
    s_and_b32 s52, s37, 2
    s_lshl_b32 s52, s52, 1
    s_add_u32 s3, s3, s52
    s_add_u32 s3, s3, s59
    s_mul_i32 s3, s3, 20480
    s_lshl_b32 s52, s62, 1
    s_and_b32 s87, s37, 1
    s_add_u32 s52, s52, s87
    s_mul_i32 s52, s52, 160
    s_add_u32 s3, s3, s52
    s_add_u32 s51, s59, 0
    s_and_b32 s51, s51, 3
    s_add_u32 s51, s51, s82
    s_mul_i32 s51, s51, 30720
    s_add_u32 s51, s51, 0
    s_add_u32 s92, s51, s95
    s_add_u32 s51, s59, 0
    s_and_b32 s51, s51, 3
    s_add_u32 s51, s51, s82
    s_mul_i32 s51, s51, 30720
    s_add_u32 s51, s51, 10240
    s_add_u32 s93, s51, s95
    s_add_u32 s51, s59, 0
    s_and_b32 s51, s51, 3
    s_add_u32 s51, s51, s82
    s_mul_i32 s51, s51, 30720
    s_add_u32 s51, s51, 20480
    s_add_u32 s94, s51, s95
    s_add_u32 s51, s59, 1
    s_and_b32 s51, s51, 3
    s_add_u32 s51, s51, s82
    s_mul_i32 s51, s51, 30720
    s_add_u32 s51, s51, 0
    s_add_u32 s60, s51, s95
    s_add_u32 s51, s59, 2
    s_and_b32 s51, s51, 3
    s_add_u32 s51, s51, s82
    s_mul_i32 s51, s51, 30720
    s_add_u32 s51, s51, 10240
    s_add_u32 s61, s51, s95
    s_add_u32 s51, s59, 3
    s_and_b32 s51, s51, 3
    s_add_u32 s51, s51, s82
    s_mul_i32 s51, s51, 30720
    s_add_u32 s51, s51, 20480
    s_add_u32 s56, s51, s95
    v_lshlrev_b32 v241, 3, v11
    s_add_u32 s52, s45, 49152
    v_mul_u32_u24 v233, 176, v13
    v_lshl_add_u32 v233, v12, 3, v233
    v_add_u32 v233, s52, v233
    v_add_u32 v14, 0, v11
    v_mul_u32_u24 v15, 6554, v14
    v_lshrrev_b32 v15, 16, v15
    v_add_u32 v234, v14, v15
    v_lshl_add_u32 v234, v234, 4, s52
    v_mul_u32_u24 v15, 1120, v15
    v_lshl_add_u32 v237, v14, 4, v15
    v_add_u32 v14, 64, v11
    v_mul_u32_u24 v15, 6554, v14
    v_lshrrev_b32 v15, 16, v15
    v_add_u32 v235, v14, v15
    v_lshl_add_u32 v235, v235, 4, s52
    v_mul_u32_u24 v15, 1120, v15
    v_lshl_add_u32 v238, v14, 4, v15
    v_add_u32 v14, 128, v11
    v_mul_u32_u24 v15, 6554, v14
    v_lshrrev_b32 v15, 16, v15
    v_add_u32 v236, v14, v15
    v_lshl_add_u32 v236, v236, 4, s52
    v_mul_u32_u24 v15, 1120, v15
    v_lshl_add_u32 v239, v14, 4, v15
    v_and_b32 v240, 3, v11
    v_min_u32 v240, 2, v240
    v_lshlrev_b32 v240, 4, v240
    s_barrier
    s_add_u32 s51, s41, 6
    s_and_b32 s51, s51, 15
    s_lshl_b32 s51, s51, 14
    s_add_u32 s51, s51, s44
    s_add_u32 m0, s45, 32768
    s_waitcnt vmcnt(4)
    buffer_load_dwordx4 v1, s[12:15], s51 offen offset:0 nt lds
    s_add_u32 s51, s41, 6
    s_and_b32 s51, s51, 15
    s_lshl_b32 s51, s51, 14
    s_add_u32 s51, s51, s44
    s_add_u32 m0, s45, 32768
    s_waitcnt vmcnt(4)
    buffer_load_dwordx4 v2, s[12:15], s51 offen offset:1024 nt lds
    s_add_u32 s51, s41, 6
    s_and_b32 s51, s51, 15
    s_lshl_b32 s51, s51, 14
    s_add_u32 s51, s51, s44
    s_add_u32 m0, s45, 32768
    s_waitcnt vmcnt(4)
    buffer_load_dwordx4 v3, s[12:15], s51 offen offset:2048 nt lds
    s_add_u32 s51, s41, 6
    s_and_b32 s51, s51, 15
    s_lshl_b32 s51, s51, 14
    s_add_u32 s51, s51, s44
    s_add_u32 m0, s45, 32768
    s_waitcnt vmcnt(4)
    buffer_load_dwordx4 v4, s[12:15], s51 offen offset:3072 nt lds
    s_add_u32 s51, s41, 6
    s_and_b32 s51, s51, 15
    s_lshl_b32 s51, s51, 14
    s_add_u32 s51, s51, s44
    s_add_u32 m0, s45, 49152
    s_waitcnt vmcnt(4)
    buffer_load_dwordx4 v5, s[16:19], s51 offen offset:0 nt lds
    s_add_u32 s51, s41, 6
    s_and_b32 s51, s51, 15
    s_lshl_b32 s51, s51, 14
    s_add_u32 s51, s51, s44
    s_add_u32 m0, s45, 49152
    s_waitcnt vmcnt(4)
    buffer_load_dwordx4 v6, s[16:19], s51 offen offset:1024 nt lds
    s_add_u32 s51, s41, 6
    s_and_b32 s51, s51, 15
    s_lshl_b32 s51, s51, 14
    s_add_u32 s51, s51, s44
    s_add_u32 m0, s45, 49152
    s_waitcnt vmcnt(4)
    buffer_load_dwordx4 v5, s[16:19], s51 offen offset:2048 nt lds
    s_add_u32 s51, s41, 6
    s_and_b32 s51, s51, 15
    s_lshl_b32 s51, s51, 14
    s_add_u32 s51, s51, s44
    s_add_u32 m0, s45, 49152
    s_waitcnt vmcnt(4)
    buffer_load_dwordx4 v6, s[16:19], s51 offen offset:3072 nt lds
    s_barrier
    s_add_u32 s51, s41, 7
    s_and_b32 s51, s51, 15
    s_lshl_b32 s51, s51, 14
    s_add_u32 s51, s51, s44
    s_add_u32 m0, s45, 65536
    s_waitcnt vmcnt(4)
    buffer_load_dwordx4 v1, s[12:15], s51 offen offset:0 nt lds
    s_add_u32 s51, s41, 7
    s_and_b32 s51, s51, 15
    s_lshl_b32 s51, s51, 14
    s_add_u32 s51, s51, s44
    s_add_u32 m0, s45, 65536
    s_waitcnt vmcnt(4)
    buffer_load_dwordx4 v2, s[12:15], s51 offen offset:1024 nt lds
    s_add_u32 s51, s41, 7
    s_and_b32 s51, s51, 15
    s_lshl_b32 s51, s51, 14
    s_add_u32 s51, s51, s44
    s_add_u32 m0, s45, 65536
    s_waitcnt vmcnt(4)
    buffer_load_dwordx4 v3, s[12:15], s51 offen offset:2048 nt lds
    s_add_u32 s51, s41, 7
    s_and_b32 s51, s51, 15
    s_lshl_b32 s51, s51, 14
    s_add_u32 s51, s51, s44
    s_add_u32 m0, s45, 65536
    s_waitcnt vmcnt(4)
    buffer_load_dwordx4 v4, s[12:15], s51 offen offset:3072 nt lds
    s_add_u32 s51, s41, 7
    s_and_b32 s51, s51, 15
    s_lshl_b32 s51, s51, 14
    s_add_u32 s51, s51, s44
    s_add_u32 m0, s45, 81920
    s_waitcnt vmcnt(4)
    buffer_load_dwordx4 v5, s[16:19], s51 offen offset:0 nt lds
    s_add_u32 s51, s41, 7
    s_and_b32 s51, s51, 15
    s_lshl_b32 s51, s51, 14
    s_add_u32 s51, s51, s44
    s_add_u32 m0, s45, 81920
    s_waitcnt vmcnt(4)
    buffer_load_dwordx4 v6, s[16:19], s51 offen offset:1024 nt lds
    s_add_u32 s51, s41, 7
    s_and_b32 s51, s51, 15
    s_lshl_b32 s51, s51, 14
    s_add_u32 s51, s51, s44
    s_add_u32 m0, s45, 81920
    s_waitcnt vmcnt(4)
    buffer_load_dwordx4 v5, s[16:19], s51 offen offset:2048 nt lds
    s_add_u32 s51, s41, 7
    s_and_b32 s51, s51, 15
    s_lshl_b32 s51, s51, 14
    s_add_u32 s51, s51, s44
    s_add_u32 m0, s45, 81920
    s_waitcnt vmcnt(4)
    buffer_load_dwordx4 v6, s[16:19], s51 offen offset:3072 nt lds
    s_barrier
    s_add_u32 s51, s41, 8
    s_and_b32 s51, s51, 15
    s_lshl_b32 s51, s51, 14
    s_add_u32 s51, s51, s44
    s_add_u32 m0, s45, 0
    s_waitcnt vmcnt(4)
    buffer_load_dwordx4 v1, s[12:15], s51 offen offset:0 nt lds
    s_add_u32 s51, s41, 8
    s_and_b32 s51, s51, 15
    s_lshl_b32 s51, s51, 14
    s_add_u32 s51, s51, s44
    s_add_u32 m0, s45, 0
    s_waitcnt vmcnt(4)
    buffer_load_dwordx4 v2, s[12:15], s51 offen offset:1024 nt lds
    s_add_u32 s51, s41, 8
    s_and_b32 s51, s51, 15
    s_lshl_b32 s51, s51, 14
    s_add_u32 s51, s51, s44
    s_add_u32 m0, s45, 0
    s_waitcnt vmcnt(4)
    buffer_load_dwordx4 v3, s[12:15], s51 offen offset:2048 nt lds
    s_add_u32 s51, s41, 8
    s_and_b32 s51, s51, 15
    s_lshl_b32 s51, s51, 14
    s_add_u32 s51, s51, s44
    s_add_u32 m0, s45, 0
    s_waitcnt vmcnt(4)
    buffer_load_dwordx4 v4, s[12:15], s51 offen offset:3072 nt lds
    s_add_u32 s51, s41, 8
    s_and_b32 s51, s51, 15
    s_lshl_b32 s51, s51, 14
    s_add_u32 s51, s51, s44
    s_add_u32 m0, s45, 16384
    s_waitcnt vmcnt(4)
    buffer_load_dwordx4 v5, s[16:19], s51 offen offset:0 nt lds
    s_add_u32 s51, s41, 8
    s_and_b32 s51, s51, 15
    s_lshl_b32 s51, s51, 14
    s_add_u32 s51, s51, s44
    s_add_u32 m0, s45, 16384
    s_waitcnt vmcnt(4)
    buffer_load_dwordx4 v6, s[16:19], s51 offen offset:1024 nt lds
    s_add_u32 s51, s41, 8
    s_and_b32 s51, s51, 15
    s_lshl_b32 s51, s51, 14
    s_add_u32 s51, s51, s44
    s_add_u32 m0, s45, 16384
    s_waitcnt vmcnt(4)
    buffer_load_dwordx4 v5, s[16:19], s51 offen offset:2048 nt lds
    s_add_u32 s51, s41, 8
    s_and_b32 s51, s51, 15
    s_lshl_b32 s51, s51, 14
    s_add_u32 s51, s51, s44
    s_add_u32 m0, s45, 16384
    s_waitcnt vmcnt(4)
    buffer_load_dwordx4 v6, s[16:19], s51 offen offset:3072 nt lds
    s_barrier
    s_add_u32 s51, s41, 9
    s_and_b32 s51, s51, 15
    s_lshl_b32 s51, s51, 14
    s_add_u32 s51, s51, s44
    s_add_u32 m0, s45, 32768
    s_waitcnt vmcnt(4)
    buffer_load_dwordx4 v1, s[12:15], s51 offen offset:0 nt lds
    s_add_u32 s51, s41, 9
    s_and_b32 s51, s51, 15
    s_lshl_b32 s51, s51, 14
    s_add_u32 s51, s51, s44
    s_add_u32 m0, s45, 32768
    s_waitcnt vmcnt(4)
    buffer_load_dwordx4 v2, s[12:15], s51 offen offset:1024 nt lds
    s_add_u32 s51, s41, 9
    s_and_b32 s51, s51, 15
    s_lshl_b32 s51, s51, 14
    s_add_u32 s51, s51, s44
    s_add_u32 m0, s45, 32768
    s_waitcnt vmcnt(4)
    buffer_load_dwordx4 v3, s[12:15], s51 offen offset:2048 nt lds
    s_add_u32 s51, s41, 9
    s_and_b32 s51, s51, 15
    s_lshl_b32 s51, s51, 14
    s_add_u32 s51, s51, s44
    s_add_u32 m0, s45, 32768
    s_waitcnt vmcnt(4)
    buffer_load_dwordx4 v4, s[12:15], s51 offen offset:3072 nt lds
    s_add_u32 s51, s41, 9
    s_and_b32 s51, s51, 15
    s_lshl_b32 s51, s51, 14
    s_add_u32 s51, s51, s44
    s_add_u32 m0, s45, 49152
    s_waitcnt vmcnt(4)
    buffer_load_dwordx4 v5, s[16:19], s51 offen offset:0 nt lds
    s_add_u32 s51, s41, 9
    s_and_b32 s51, s51, 15
    s_lshl_b32 s51, s51, 14
    s_add_u32 s51, s51, s44
    s_add_u32 m0, s45, 49152
    s_waitcnt vmcnt(4)
    buffer_load_dwordx4 v6, s[16:19], s51 offen offset:1024 nt lds
    s_add_u32 s51, s41, 9
    s_and_b32 s51, s51, 15
    s_lshl_b32 s51, s51, 14
    s_add_u32 s51, s51, s44
    s_add_u32 m0, s45, 49152
    s_waitcnt vmcnt(4)
    buffer_load_dwordx4 v5, s[16:19], s51 offen offset:2048 nt lds
    s_add_u32 s51, s41, 9
    s_and_b32 s51, s51, 15
    s_lshl_b32 s51, s51, 14
    s_add_u32 s51, s51, s44
    s_add_u32 m0, s45, 49152
    s_waitcnt vmcnt(4)
    buffer_load_dwordx4 v6, s[16:19], s51 offen offset:3072 nt lds
    s_barrier
    s_add_u32 s51, s41, 10
    s_and_b32 s51, s51, 15
    s_lshl_b32 s51, s51, 14
    s_add_u32 s51, s51, s44
    s_add_u32 m0, s45, 65536
    s_waitcnt vmcnt(4)
    buffer_load_dwordx4 v1, s[12:15], s51 offen offset:0 nt lds
    s_add_u32 s51, s41, 10
    s_and_b32 s51, s51, 15
    s_lshl_b32 s51, s51, 14
    s_add_u32 s51, s51, s44
    s_add_u32 m0, s45, 65536
    s_waitcnt vmcnt(4)
    buffer_load_dwordx4 v2, s[12:15], s51 offen offset:1024 nt lds
    s_add_u32 s51, s41, 10
    s_and_b32 s51, s51, 15
    s_lshl_b32 s51, s51, 14
    s_add_u32 s51, s51, s44
    s_add_u32 m0, s45, 65536
    s_waitcnt vmcnt(4)
    buffer_load_dwordx4 v3, s[12:15], s51 offen offset:2048 nt lds
    s_add_u32 s51, s41, 10
    s_and_b32 s51, s51, 15
    s_lshl_b32 s51, s51, 14
    s_add_u32 s51, s51, s44
    s_add_u32 m0, s45, 65536
    s_waitcnt vmcnt(4)
    buffer_load_dwordx4 v4, s[12:15], s51 offen offset:3072 nt lds
    s_add_u32 s51, s41, 10
    s_and_b32 s51, s51, 15
    s_lshl_b32 s51, s51, 14
    s_add_u32 s51, s51, s44
    s_add_u32 m0, s45, 81920
    s_waitcnt vmcnt(4)
    buffer_load_dwordx4 v5, s[16:19], s51 offen offset:0 nt lds
    s_add_u32 s51, s41, 10
    s_and_b32 s51, s51, 15
    s_lshl_b32 s51, s51, 14
    s_add_u32 s51, s51, s44
    s_add_u32 m0, s45, 81920
    s_waitcnt vmcnt(4)
    buffer_load_dwordx4 v6, s[16:19], s51 offen offset:1024 nt lds
    s_add_u32 s51, s41, 10
    s_and_b32 s51, s51, 15
    s_lshl_b32 s51, s51, 14
    s_add_u32 s51, s51, s44
    s_add_u32 m0, s45, 81920
    s_waitcnt vmcnt(4)
    buffer_load_dwordx4 v5, s[16:19], s51 offen offset:2048 nt lds
    s_add_u32 s51, s41, 10
    s_and_b32 s51, s51, 15
    s_lshl_b32 s51, s51, 14
    s_add_u32 s51, s51, s44
    s_add_u32 m0, s45, 81920
    s_waitcnt vmcnt(4)
    buffer_load_dwordx4 v6, s[16:19], s51 offen offset:3072 nt lds
    s_barrier
    s_add_u32 s51, s41, 11
    s_and_b32 s51, s51, 15
    s_lshl_b32 s51, s51, 14
    s_add_u32 s51, s51, s44
    s_add_u32 m0, s45, 0
    s_waitcnt vmcnt(4)
    buffer_load_dwordx4 v1, s[12:15], s51 offen offset:0 nt lds
    s_add_u32 s51, s41, 11
    s_and_b32 s51, s51, 15
    s_lshl_b32 s51, s51, 14
    s_add_u32 s51, s51, s44
    s_add_u32 m0, s45, 0
    s_waitcnt vmcnt(4)
    buffer_load_dwordx4 v2, s[12:15], s51 offen offset:1024 nt lds
    s_add_u32 s51, s41, 11
    s_and_b32 s51, s51, 15
    s_lshl_b32 s51, s51, 14
    s_add_u32 s51, s51, s44
    s_add_u32 m0, s45, 0
    s_waitcnt vmcnt(4)
    buffer_load_dwordx4 v3, s[12:15], s51 offen offset:2048 nt lds
    s_add_u32 s51, s41, 11
    s_and_b32 s51, s51, 15
    s_lshl_b32 s51, s51, 14
    s_add_u32 s51, s51, s44
    s_add_u32 m0, s45, 0
    s_waitcnt vmcnt(4)
    buffer_load_dwordx4 v4, s[12:15], s51 offen offset:3072 nt lds
    s_add_u32 s51, s41, 11
    s_and_b32 s51, s51, 15
    s_lshl_b32 s51, s51, 14
    s_add_u32 s51, s51, s44
    s_add_u32 m0, s45, 16384
    s_waitcnt vmcnt(4)
    buffer_load_dwordx4 v5, s[16:19], s51 offen offset:0 nt lds
    s_add_u32 s51, s41, 11
    s_and_b32 s51, s51, 15
    s_lshl_b32 s51, s51, 14
    s_add_u32 s51, s51, s44
    s_add_u32 m0, s45, 16384
    s_waitcnt vmcnt(4)
    buffer_load_dwordx4 v6, s[16:19], s51 offen offset:1024 nt lds
    s_add_u32 s51, s41, 11
    s_and_b32 s51, s51, 15
    s_lshl_b32 s51, s51, 14
    s_add_u32 s51, s51, s44
    s_add_u32 m0, s45, 16384
    s_waitcnt vmcnt(4)
    buffer_load_dwordx4 v5, s[16:19], s51 offen offset:2048 nt lds
    s_add_u32 s51, s41, 11
    s_and_b32 s51, s51, 15
    s_lshl_b32 s51, s51, 14
    s_add_u32 s51, s51, s44
    s_add_u32 m0, s45, 16384
    s_waitcnt vmcnt(4)
    buffer_load_dwordx4 v6, s[16:19], s51 offen offset:3072 nt lds
    s_barrier
    s_add_u32 s51, s41, 12
    s_and_b32 s51, s51, 15
    s_lshl_b32 s51, s51, 14
    s_add_u32 s51, s51, s44
    s_add_u32 m0, s45, 32768
    s_waitcnt vmcnt(4)
    buffer_load_dwordx4 v1, s[12:15], s51 offen offset:0 nt lds
    s_add_u32 s51, s41, 12
    s_and_b32 s51, s51, 15
    s_lshl_b32 s51, s51, 14
    s_add_u32 s51, s51, s44
    s_add_u32 m0, s45, 32768
    s_waitcnt vmcnt(4)
    buffer_load_dwordx4 v2, s[12:15], s51 offen offset:1024 nt lds
    s_add_u32 s51, s41, 12
    s_and_b32 s51, s51, 15
    s_lshl_b32 s51, s51, 14
    s_add_u32 s51, s51, s44
    s_add_u32 m0, s45, 32768
    s_waitcnt vmcnt(4)
    buffer_load_dwordx4 v3, s[12:15], s51 offen offset:2048 nt lds
    s_add_u32 s51, s41, 12
    s_and_b32 s51, s51, 15
    s_lshl_b32 s51, s51, 14
    s_add_u32 s51, s51, s44
    s_add_u32 m0, s45, 32768
    s_waitcnt vmcnt(4)
    buffer_load_dwordx4 v4, s[12:15], s51 offen offset:3072 nt lds
    s_add_u32 s51, s41, 12
    s_and_b32 s51, s51, 15
    s_lshl_b32 s51, s51, 14
    s_add_u32 s51, s51, s44
    s_add_u32 m0, s45, 49152
    s_waitcnt vmcnt(4)
    buffer_load_dwordx4 v5, s[16:19], s51 offen offset:0 nt lds
    s_add_u32 s51, s41, 12
    s_and_b32 s51, s51, 15
    s_lshl_b32 s51, s51, 14
    s_add_u32 s51, s51, s44
    s_add_u32 m0, s45, 49152
    s_waitcnt vmcnt(4)
    buffer_load_dwordx4 v6, s[16:19], s51 offen offset:1024 nt lds
    s_add_u32 s51, s41, 12
    s_and_b32 s51, s51, 15
    s_lshl_b32 s51, s51, 14
    s_add_u32 s51, s51, s44
    s_add_u32 m0, s45, 49152
    s_waitcnt vmcnt(4)
    buffer_load_dwordx4 v5, s[16:19], s51 offen offset:2048 nt lds
    s_add_u32 s51, s41, 12
    s_and_b32 s51, s51, 15
    s_lshl_b32 s51, s51, 14
    s_add_u32 s51, s51, s44
    s_add_u32 m0, s45, 49152
    s_waitcnt vmcnt(4)
    buffer_load_dwordx4 v6, s[16:19], s51 offen offset:3072 nt lds
    s_barrier
    s_add_u32 s51, s41, 13
    s_and_b32 s51, s51, 15
    s_lshl_b32 s51, s51, 14
    s_add_u32 s51, s51, s44
    s_add_u32 m0, s45, 65536
    s_waitcnt vmcnt(4)
    buffer_load_dwordx4 v1, s[12:15], s51 offen offset:0 nt lds
    s_add_u32 s51, s41, 13
    s_and_b32 s51, s51, 15
    s_lshl_b32 s51, s51, 14
    s_add_u32 s51, s51, s44
    s_add_u32 m0, s45, 65536
    s_waitcnt vmcnt(4)
    buffer_load_dwordx4 v2, s[12:15], s51 offen offset:1024 nt lds
    s_add_u32 s51, s41, 13
    s_and_b32 s51, s51, 15
    s_lshl_b32 s51, s51, 14
    s_add_u32 s51, s51, s44
    s_add_u32 m0, s45, 65536
    s_waitcnt vmcnt(4)
    buffer_load_dwordx4 v3, s[12:15], s51 offen offset:2048 nt lds
    s_add_u32 s51, s41, 13
    s_and_b32 s51, s51, 15
    s_lshl_b32 s51, s51, 14
    s_add_u32 s51, s51, s44
    s_add_u32 m0, s45, 65536
    s_waitcnt vmcnt(4)
    buffer_load_dwordx4 v4, s[12:15], s51 offen offset:3072 nt lds
    s_add_u32 s51, s41, 13
    s_and_b32 s51, s51, 15
    s_lshl_b32 s51, s51, 14
    s_add_u32 s51, s51, s44
    s_add_u32 m0, s45, 81920
    s_waitcnt vmcnt(4)
    buffer_load_dwordx4 v5, s[16:19], s51 offen offset:0 nt lds
    s_add_u32 s51, s41, 13
    s_and_b32 s51, s51, 15
    s_lshl_b32 s51, s51, 14
    s_add_u32 s51, s51, s44
    s_add_u32 m0, s45, 81920
    s_waitcnt vmcnt(4)
    buffer_load_dwordx4 v6, s[16:19], s51 offen offset:1024 nt lds
    s_add_u32 s51, s41, 13
    s_and_b32 s51, s51, 15
    s_lshl_b32 s51, s51, 14
    s_add_u32 s51, s51, s44
    s_add_u32 m0, s45, 81920
    s_waitcnt vmcnt(4)
    buffer_load_dwordx4 v5, s[16:19], s51 offen offset:2048 nt lds
    s_add_u32 s51, s41, 13
    s_and_b32 s51, s51, 15
    s_lshl_b32 s51, s51, 14
    s_add_u32 s51, s51, s44
    s_add_u32 m0, s45, 81920
    s_waitcnt vmcnt(4)
    buffer_load_dwordx4 v6, s[16:19], s51 offen offset:3072 nt lds
    s_barrier
    s_add_u32 s51, s41, 14
    s_and_b32 s51, s51, 15
    s_lshl_b32 s51, s51, 14
    s_add_u32 s51, s51, s44
    s_add_u32 m0, s45, 0
    s_waitcnt vmcnt(4)
    buffer_load_dwordx4 v1, s[12:15], s51 offen offset:0 nt lds
    s_add_u32 s51, s41, 14
    s_and_b32 s51, s51, 15
    s_lshl_b32 s51, s51, 14
    s_add_u32 s51, s51, s44
    s_add_u32 m0, s45, 0
    s_waitcnt vmcnt(4)
    buffer_load_dwordx4 v2, s[12:15], s51 offen offset:1024 nt lds
    s_add_u32 s51, s41, 14
    s_and_b32 s51, s51, 15
    s_lshl_b32 s51, s51, 14
    s_add_u32 s51, s51, s44
    s_add_u32 m0, s45, 0
    s_waitcnt vmcnt(4)
    buffer_load_dwordx4 v3, s[12:15], s51 offen offset:2048 nt lds
    s_add_u32 s51, s41, 14
    s_and_b32 s51, s51, 15
    s_lshl_b32 s51, s51, 14
    s_add_u32 s51, s51, s44
    s_add_u32 m0, s45, 0
    s_waitcnt vmcnt(4)
    buffer_load_dwordx4 v4, s[12:15], s51 offen offset:3072 nt lds
    s_add_u32 s51, s41, 14
    s_and_b32 s51, s51, 15
    s_lshl_b32 s51, s51, 14
    s_add_u32 s51, s51, s44
    s_add_u32 m0, s45, 16384
    s_waitcnt vmcnt(4)
    buffer_load_dwordx4 v5, s[16:19], s51 offen offset:0 nt lds
    s_add_u32 s51, s41, 14
    s_and_b32 s51, s51, 15
    s_lshl_b32 s51, s51, 14
    s_add_u32 s51, s51, s44
    s_add_u32 m0, s45, 16384
    s_waitcnt vmcnt(4)
    buffer_load_dwordx4 v6, s[16:19], s51 offen offset:1024 nt lds
    s_add_u32 s51, s41, 14
    s_and_b32 s51, s51, 15
    s_lshl_b32 s51, s51, 14
    s_add_u32 s51, s51, s44
    s_add_u32 m0, s45, 16384
    s_waitcnt vmcnt(4)
    buffer_load_dwordx4 v5, s[16:19], s51 offen offset:2048 nt lds
    s_add_u32 s51, s41, 14
    s_and_b32 s51, s51, 15
    s_lshl_b32 s51, s51, 14
    s_add_u32 s51, s51, s44
    s_add_u32 m0, s45, 16384
    s_waitcnt vmcnt(4)
    buffer_load_dwordx4 v6, s[16:19], s51 offen offset:3072 nt lds
    s_barrier
    s_add_u32 s51, s41, 15
    s_and_b32 s51, s51, 15
    s_lshl_b32 s51, s51, 14
    s_add_u32 s51, s51, s44
    s_add_u32 m0, s45, 32768
    s_waitcnt vmcnt(4)
    buffer_load_dwordx4 v1, s[12:15], s51 offen offset:0 nt lds
    s_add_u32 s51, s41, 15
    s_and_b32 s51, s51, 15
    s_lshl_b32 s51, s51, 14
    s_add_u32 s51, s51, s44
    s_add_u32 m0, s45, 32768
    s_waitcnt vmcnt(4)
    buffer_load_dwordx4 v2, s[12:15], s51 offen offset:1024 nt lds
    s_add_u32 s51, s41, 15
    s_and_b32 s51, s51, 15
    s_lshl_b32 s51, s51, 14
    s_add_u32 s51, s51, s44
    s_add_u32 m0, s45, 32768
    s_waitcnt vmcnt(4)
    buffer_load_dwordx4 v3, s[12:15], s51 offen offset:2048 nt lds
    s_add_u32 s51, s41, 15
    s_and_b32 s51, s51, 15
    s_lshl_b32 s51, s51, 14
    s_add_u32 s51, s51, s44
    s_add_u32 m0, s45, 32768
    s_waitcnt vmcnt(4)
    buffer_load_dwordx4 v4, s[12:15], s51 offen offset:3072 nt lds
    s_add_u32 s51, s41, 15
    s_and_b32 s51, s51, 15
    s_lshl_b32 s51, s51, 14
    s_add_u32 s51, s51, s44
    s_add_u32 m0, s45, 49152
    s_waitcnt vmcnt(4)
    buffer_load_dwordx4 v5, s[16:19], s51 offen offset:0 nt lds
    s_add_u32 s51, s41, 15
    s_and_b32 s51, s51, 15
    s_lshl_b32 s51, s51, 14
    s_add_u32 s51, s51, s44
    s_add_u32 m0, s45, 49152
    s_waitcnt vmcnt(4)
    buffer_load_dwordx4 v6, s[16:19], s51 offen offset:1024 nt lds
    s_add_u32 s51, s41, 15
    s_and_b32 s51, s51, 15
    s_lshl_b32 s51, s51, 14
    s_add_u32 s51, s51, s44
    s_add_u32 m0, s45, 49152
    s_waitcnt vmcnt(4)
    buffer_load_dwordx4 v5, s[16:19], s51 offen offset:2048 nt lds
    s_add_u32 s51, s41, 15
    s_and_b32 s51, s51, 15
    s_lshl_b32 s51, s51, 14
    s_add_u32 s51, s51, s44
    s_add_u32 m0, s45, 49152
    s_waitcnt vmcnt(4)
    buffer_load_dwordx4 v6, s[16:19], s51 offen offset:3072 nt lds
    s_barrier
    buffer_load_dword v231, v232, s[20:23], s96 offen sc1
    s_add_u32 s51, s53, 0
    buffer_store_dwordx4 v[112:115], v10, s[20:23], s51 offen offset:0 sc1
    s_add_u32 s51, s53, 0
    buffer_store_dwordx4 v[116:119], v10, s[20:23], s51 offen offset:1024 sc1
    s_add_u32 s51, s53, 8192
    buffer_store_dwordx4 v[120:123], v10, s[20:23], s51 offen offset:0 sc1
    s_add_u32 s51, s53, 8192
    buffer_store_dwordx4 v[124:127], v10, s[20:23], s51 offen offset:1024 sc1
    s_add_u32 s51, s53, 16384
    buffer_store_dwordx4 v[128:131], v10, s[20:23], s51 offen offset:0 sc1
    s_add_u32 s51, s53, 16384
    buffer_store_dwordx4 v[132:135], v10, s[20:23], s51 offen offset:1024 sc1
    s_add_u32 s51, s53, 24576
    buffer_store_dwordx4 v[136:139], v10, s[20:23], s51 offen offset:0 sc1
    s_add_u32 s51, s53, 24576
    buffer_store_dwordx4 v[140:143], v10, s[20:23], s51 offen offset:1024 sc1
    s_add_u32 s51, s63, 0
    s_and_b32 s51, s51, 7
    s_mul_i32 s51, s51, 81920
    s_add_u32 s51, s51, s84
    s_add_u32 m0, s88, 126976
    s_nop 0
    buffer_load_dwordx4 v216, s[24:27], s51 offen offset:0 lds
    buffer_load_dwordx4 v217, s[24:27], s51 offen offset:1024 lds
    buffer_load_dwordx4 v218, s[24:27], s51 offen offset:2048 lds
    buffer_load_dwordx4 v219, s[24:27], s51 offen offset:3072 lds
    s_add_u32 m0, s88, 131072
    s_nop 0
    buffer_load_dwordx4 v220, s[24:27], s51 offen lds
    s_add_u32 s51, s63, 1
    s_and_b32 s51, s51, 7
    s_mul_i32 s51, s51, 81920
    s_add_u32 s51, s51, s84
    s_add_u32 m0, s88, 106496
    s_nop 0
    buffer_load_dwordx4 v216, s[24:27], s51 offen offset:0 lds
    buffer_load_dwordx4 v217, s[24:27], s51 offen offset:1024 lds
    buffer_load_dwordx4 v218, s[24:27], s51 offen offset:2048 lds
    buffer_load_dwordx4 v219, s[24:27], s51 offen offset:3072 lds
    s_add_u32 m0, s88, 110592
    s_nop 0
    buffer_load_dwordx4 v220, s[24:27], s51 offen lds
    s_waitcnt vmcnt(19)
    s_barrier
    s_waitcnt vmcnt(10)
    v_mov_b32 v14, 1
    v_mov_b32 v15, 0
    s_mov_b64 s[90:91], exec
    s_mov_b64 exec, 1
    buffer_store_dword v14, v15, s[20:23], s85 offen sc1
    s_mov_b64 exec, s[90:91]
L_foa:
    s_add_u32 s51, s63, 2
    s_and_b32 s51, s51, 7
    s_mul_i32 s51, s51, 81920
    s_add_u32 s51, s51, s84
    s_add_u32 m0, s88, 86016
    s_nop 0
    buffer_load_dwordx4 v216, s[24:27], s51 offen offset:0 lds
    buffer_load_dwordx4 v217, s[24:27], s51 offen offset:1024 lds
    buffer_load_dwordx4 v218, s[24:27], s51 offen offset:2048 lds
    buffer_load_dwordx4 v219, s[24:27], s51 offen offset:3072 lds
    s_add_u32 m0, s88, 90112
    s_nop 0
    buffer_load_dwordx4 v220, s[24:27], s51 offen lds
    s_add_u32 s51, s63, 3
    s_and_b32 s51, s51, 7
    s_mul_i32 s51, s51, 81920
    s_add_u32 s51, s51, s84
    s_add_u32 m0, s88, 65536
    s_nop 0
    buffer_load_dwordx4 v216, s[24:27], s51 offen offset:0 lds
    buffer_load_dwordx4 v217, s[24:27], s51 offen offset:1024 lds
    buffer_load_dwordx4 v218, s[24:27], s51 offen offset:2048 lds
    buffer_load_dwordx4 v219, s[24:27], s51 offen offset:3072 lds
    s_add_u32 m0, s88, 69632
    s_nop 0
    buffer_load_dwordx4 v220, s[24:27], s51 offen lds
    s_mov_b32 s89, 0
L_p0_c:
    v_cmp_ne_u32 vcc, 1, v231
    s_nop 0
    s_cbranch_vccz L_p0_ok
    s_add_u32 s89, s89, 1
    s_cmp_gt_u32 s89, 0x40000
    s_cbranch_scc1 L_p0_ok
    s_sleep 4
    buffer_load_dword v231, v232, s[20:23], s96 offen sc1
        s_waitcnt vmcnt(0)
    s_branch L_p0_c
L_p0_ok:
    s_add_u32 s52, s63, 0
    s_and_b32 s52, s52, 7
    s_lshl_b32 s52, s52, 14
    s_add_u32 s52, s52, s83
    s_add_u32 m0, s45, 147456
    s_nop 0
    buffer_load_dwordx4 v221, s[20:23], s52 offen offset:0 sc1 lds
    buffer_load_dwordx4 v221, s[20:23], s52 offen offset:1024 sc1 lds
    buffer_load_dwordx4 v221, s[20:23], s52 offen offset:2048 sc1 lds
    buffer_load_dwordx4 v221, s[20:23], s52 offen offset:3072 sc1 lds
    s_add_u32 s52, s63, 1
    s_and_b32 s52, s52, 7
    s_lshl_b32 s52, s52, 14
    s_add_u32 s52, s52, s83
    s_add_u32 m0, s45, 0
    s_nop 0
    buffer_load_dwordx4 v221, s[20:23], s52 offen offset:0 sc1 lds
    buffer_load_dwordx4 v221, s[20:23], s52 offen offset:1024 sc1 lds
    buffer_load_dwordx4 v221, s[20:23], s52 offen offset:2048 sc1 lds
    buffer_load_dwordx4 v221, s[20:23], s52 offen offset:3072 sc1 lds
    s_add_u32 s52, s63, 2
    s_and_b32 s52, s52, 7
    s_lshl_b32 s52, s52, 14
    s_add_u32 s52, s52, s83
    s_add_u32 m0, s45, 16384
    s_nop 0
    buffer_load_dwordx4 v221, s[20:23], s52 offen offset:0 sc1 lds
    buffer_load_dwordx4 v221, s[20:23], s52 offen offset:1024 sc1 lds
    buffer_load_dwordx4 v221, s[20:23], s52 offen offset:2048 sc1 lds
    buffer_load_dwordx4 v221, s[20:23], s52 offen offset:3072 sc1 lds
    buffer_load_dword v228, v229, s[20:23], s96 offen sc1
    s_waitcnt vmcnt(5)
    s_barrier
    ds_read_b64_tr_b16 v[144:145], v226 offset:0
    ds_read_b64_tr_b16 v[146:147], v226 offset:5120
    ds_read_b128 v[164:167], v222 offset:0
    ds_read_b128 v[168:171], v223 offset:0
    ds_read_b128 v[172:175], v224 offset:0
    ds_read_b128 v[176:179], v225 offset:0
    ds_read_b64_tr_b16 v[148:149], v227 offset:32
    ds_read_b64_tr_b16 v[150:151], v227 offset:5152
    ds_read_b64_tr_b16 v[152:153], v226 offset:64
    ds_read_b64_tr_b16 v[154:155], v226 offset:5184
    ds_read_b64_tr_b16 v[156:157], v227 offset:96
    ds_read_b64_tr_b16 v[158:159], v227 offset:5216
    ds_read_b64_tr_b16 v[160:161], v226 offset:128
    ds_read_b64_tr_b16 v[162:163], v226 offset:5248
    s_waitcnt lgkmcnt(8)
    v_mfma_f32_16x16x32_bf16 v[16:19], v[144:147], v[164:167], 0
    ds_read_b64_tr_b16 v[180:181], v226 offset:10240
    v_mfma_f32_16x16x32_bf16 v[36:39], v[144:147], v[168:171], 0
    ds_read_b64_tr_b16 v[182:183], v226 offset:15360
    v_mfma_f32_16x16x32_bf16 v[56:59], v[144:147], v[172:175], 0
    ds_read_b128 v[200:203], v222 offset:8192
    v_mfma_f32_16x16x32_bf16 v[76:79], v[144:147], v[176:179], 0
    ds_read_b128 v[204:207], v223 offset:8192
    s_waitcnt lgkmcnt(4)
    v_mfma_f32_16x16x32_bf16 v[20:23], v[148:151], v[164:167], 0
    ds_read_b128 v[208:211], v224 offset:8192
    v_mfma_f32_16x16x32_bf16 v[40:43], v[148:151], v[168:171], 0
    ds_read_b128 v[212:215], v225 offset:8192
    v_mfma_f32_16x16x32_bf16 v[60:63], v[148:151], v[172:175], 0
    ds_read_b64_tr_b16 v[184:185], v227 offset:10272
    v_mfma_f32_16x16x32_bf16 v[80:83], v[148:151], v[176:179], 0
    ds_read_b64_tr_b16 v[186:187], v227 offset:15392
    v_mfma_f32_16x16x32_bf16 v[24:27], v[152:155], v[164:167], 0
    ds_read_b64_tr_b16 v[188:189], v226 offset:10304
    v_mfma_f32_16x16x32_bf16 v[44:47], v[152:155], v[168:171], 0
    ds_read_b64_tr_b16 v[190:191], v226 offset:15424
    v_mfma_f32_16x16x32_bf16 v[64:67], v[152:155], v[172:175], 0
    ds_read_b64_tr_b16 v[192:193], v227 offset:10336
    v_mfma_f32_16x16x32_bf16 v[84:87], v[152:155], v[176:179], 0
    ds_read_b64_tr_b16 v[194:195], v227 offset:15456
    v_mfma_f32_16x16x32_bf16 v[28:31], v[156:159], v[164:167], 0
    ds_read_b64_tr_b16 v[196:197], v226 offset:10368
    v_mfma_f32_16x16x32_bf16 v[48:51], v[156:159], v[168:171], 0
    ds_read_b64_tr_b16 v[198:199], v226 offset:15488
    v_mfma_f32_16x16x32_bf16 v[68:71], v[156:159], v[172:175], 0
    v_mfma_f32_16x16x32_bf16 v[88:91], v[156:159], v[176:179], 0
    v_mfma_f32_16x16x32_bf16 v[32:35], v[160:163], v[164:167], 0
    v_mfma_f32_16x16x32_bf16 v[52:55], v[160:163], v[168:171], 0
    v_mfma_f32_16x16x32_bf16 v[72:75], v[160:163], v[172:175], 0
    v_mfma_f32_16x16x32_bf16 v[92:95], v[160:163], v[176:179], 0
    s_waitcnt vmcnt(0)
    s_mov_b32 s89, 0
L_pa_c:
    v_cmp_ne_u32 vcc, 1, v228
    s_nop 0
    s_cbranch_vccz L_pa_ok
    s_add_u32 s89, s89, 1
    s_cmp_gt_u32 s89, 0x40000
    s_cbranch_scc1 L_pa_ok
    s_sleep 4
    buffer_load_dword v228, v229, s[20:23], s96 offen sc1
        s_waitcnt vmcnt(0)
    s_branch L_pa_c
L_pa_ok:
    s_waitcnt lgkmcnt(8)
    v_mfma_f32_16x16x32_bf16 v[16:19], v[180:183], v[200:203], v[16:19]
    v_add_u32 v226, 0xffffb000, v226
    v_add_u32 v227, 0xffffb000, v227
    v_mfma_f32_16x16x32_bf16 v[36:39], v[180:183], v[204:207], v[36:39]
    v_add_u32 v222, 0xfffdc000, v222
    v_add_u32 v223, 0xfffdc000, v223
    s_add_u32 s52, s63, 3
    s_and_b32 s52, s52, 7
    s_lshl_b32 s52, s52, 14
    s_add_u32 s52, s52, s83
    s_add_u32 m0, s45, 32768
    s_nop 0
    buffer_load_dwordx4 v221, s[20:23], s52 offen offset:0 sc1 lds
    buffer_load_dwordx4 v221, s[20:23], s52 offen offset:1024 sc1 lds
    v_mfma_f32_16x16x32_bf16 v[56:59], v[180:183], v[208:211], v[56:59]
    v_add_u32 v224, 0xfffdc000, v224
    v_add_u32 v225, 0xfffdc000, v225
    v_mfma_f32_16x16x32_bf16 v[76:79], v[180:183], v[212:215], v[76:79]
    ds_read_b64_tr_b16 v[144:145], v226 offset:0
    s_waitcnt lgkmcnt(1)
    v_mfma_f32_16x16x32_bf16 v[20:23], v[184:187], v[200:203], v[20:23]
    ds_read_b64_tr_b16 v[146:147], v226 offset:5120
    v_mfma_f32_16x16x32_bf16 v[40:43], v[184:187], v[204:207], v[40:43]
    ds_read_b128 v[164:167], v222 offset:0
    buffer_load_dwordx4 v221, s[20:23], s52 offen offset:2048 sc1 lds
    buffer_load_dwordx4 v221, s[20:23], s52 offen offset:3072 sc1 lds
    v_mfma_f32_16x16x32_bf16 v[60:63], v[184:187], v[208:211], v[60:63]
    ds_read_b128 v[168:171], v223 offset:0
    v_mfma_f32_16x16x32_bf16 v[80:83], v[184:187], v[212:215], v[80:83]
    ds_read_b128 v[172:175], v224 offset:0
    v_mfma_f32_16x16x32_bf16 v[24:27], v[188:191], v[200:203], v[24:27]
    ds_read_b128 v[176:179], v225 offset:0
    v_mfma_f32_16x16x32_bf16 v[44:47], v[188:191], v[204:207], v[44:47]
    ds_read_b64_tr_b16 v[148:149], v227 offset:32
    v_mfma_f32_16x16x32_bf16 v[64:67], v[188:191], v[208:211], v[64:67]
    ds_read_b64_tr_b16 v[150:151], v227 offset:5152
    v_mfma_f32_16x16x32_bf16 v[84:87], v[188:191], v[212:215], v[84:87]
    ds_read_b64_tr_b16 v[152:153], v226 offset:64
    v_mfma_f32_16x16x32_bf16 v[28:31], v[192:195], v[200:203], v[28:31]
    ds_read_b64_tr_b16 v[154:155], v226 offset:5184
    v_mfma_f32_16x16x32_bf16 v[48:51], v[192:195], v[204:207], v[48:51]
    ds_read_b64_tr_b16 v[156:157], v227 offset:96
    v_mfma_f32_16x16x32_bf16 v[68:71], v[192:195], v[208:211], v[68:71]
    ds_read_b64_tr_b16 v[158:159], v227 offset:5216
    v_mfma_f32_16x16x32_bf16 v[88:91], v[192:195], v[212:215], v[88:91]
    ds_read_b64_tr_b16 v[160:161], v226 offset:128
    v_mfma_f32_16x16x32_bf16 v[32:35], v[196:199], v[200:203], v[32:35]
    ds_read_b64_tr_b16 v[162:163], v226 offset:5248
    v_mfma_f32_16x16x32_bf16 v[52:55], v[196:199], v[204:207], v[52:55]
    v_mfma_f32_16x16x32_bf16 v[72:75], v[196:199], v[208:211], v[72:75]
    v_mfma_f32_16x16x32_bf16 v[92:95], v[196:199], v[212:215], v[92:95]
    s_barrier
    s_waitcnt lgkmcnt(8)
    v_mfma_f32_16x16x32_bf16 v[16:19], v[144:147], v[164:167], v[16:19]
    ds_read_b64_tr_b16 v[180:181], v226 offset:10240
    v_mfma_f32_16x16x32_bf16 v[36:39], v[144:147], v[168:171], v[36:39]
    ds_read_b64_tr_b16 v[182:183], v226 offset:15360
    s_add_u32 s51, s63, 4
    s_and_b32 s51, s51, 7
    s_mul_i32 s51, s51, 81920
    s_add_u32 s51, s51, s84
    s_add_u32 m0, s88, 126976
    s_nop 0
    buffer_load_dwordx4 v216, s[24:27], s51 offen offset:0 lds
    buffer_load_dwordx4 v217, s[24:27], s51 offen offset:1024 lds
    v_mfma_f32_16x16x32_bf16 v[56:59], v[144:147], v[172:175], v[56:59]
    ds_read_b128 v[200:203], v222 offset:8192
    v_mfma_f32_16x16x32_bf16 v[76:79], v[144:147], v[176:179], v[76:79]
    ds_read_b128 v[204:207], v223 offset:8192
    s_waitcnt lgkmcnt(4)
    v_mfma_f32_16x16x32_bf16 v[20:23], v[148:151], v[164:167], v[20:23]
    ds_read_b128 v[208:211], v224 offset:8192
    v_mfma_f32_16x16x32_bf16 v[40:43], v[148:151], v[168:171], v[40:43]
    ds_read_b128 v[212:215], v225 offset:8192
    buffer_load_dwordx4 v218, s[24:27], s51 offen offset:2048 lds
    buffer_load_dwordx4 v219, s[24:27], s51 offen offset:3072 lds
    v_mfma_f32_16x16x32_bf16 v[60:63], v[148:151], v[172:175], v[60:63]
    ds_read_b64_tr_b16 v[184:185], v227 offset:10272
    v_mfma_f32_16x16x32_bf16 v[80:83], v[148:151], v[176:179], v[80:83]
    ds_read_b64_tr_b16 v[186:187], v227 offset:15392
    v_mfma_f32_16x16x32_bf16 v[24:27], v[152:155], v[164:167], v[24:27]
    ds_read_b64_tr_b16 v[188:189], v226 offset:10304
    v_mfma_f32_16x16x32_bf16 v[44:47], v[152:155], v[168:171], v[44:47]
    ds_read_b64_tr_b16 v[190:191], v226 offset:15424
    s_add_u32 m0, s88, 131072
    s_nop 0
    buffer_load_dwordx4 v220, s[24:27], s51 offen lds
    v_mfma_f32_16x16x32_bf16 v[64:67], v[152:155], v[172:175], v[64:67]
    ds_read_b64_tr_b16 v[192:193], v227 offset:10336
    v_mfma_f32_16x16x32_bf16 v[84:87], v[152:155], v[176:179], v[84:87]
    ds_read_b64_tr_b16 v[194:195], v227 offset:15456
    v_mfma_f32_16x16x32_bf16 v[28:31], v[156:159], v[164:167], v[28:31]
    ds_read_b64_tr_b16 v[196:197], v226 offset:10368
    v_mfma_f32_16x16x32_bf16 v[48:51], v[156:159], v[168:171], v[48:51]
    ds_read_b64_tr_b16 v[198:199], v226 offset:15488
    v_mfma_f32_16x16x32_bf16 v[68:71], v[156:159], v[172:175], v[68:71]
    v_mfma_f32_16x16x32_bf16 v[88:91], v[156:159], v[176:179], v[88:91]
    v_mfma_f32_16x16x32_bf16 v[32:35], v[160:163], v[164:167], v[32:35]
    v_mfma_f32_16x16x32_bf16 v[52:55], v[160:163], v[168:171], v[52:55]
    v_mfma_f32_16x16x32_bf16 v[72:75], v[160:163], v[172:175], v[72:75]
    v_mfma_f32_16x16x32_bf16 v[92:95], v[160:163], v[176:179], v[92:95]
    s_waitcnt lgkmcnt(8)
    v_mfma_f32_16x16x32_bf16 v[16:19], v[180:183], v[200:203], v[16:19]
    v_add_u32 v226, 0xffffb000, v226
    v_add_u32 v227, 0xffffb000, v227
    v_mfma_f32_16x16x32_bf16 v[36:39], v[180:183], v[204:207], v[36:39]
    v_add_u32 v222, 0x4000, v222
    v_add_u32 v223, 0x4000, v223
    s_add_u32 s52, s63, 4
    s_and_b32 s52, s52, 7
    s_lshl_b32 s52, s52, 14
    s_add_u32 s52, s52, s83
    s_add_u32 m0, s45, 147456
    s_nop 0
    buffer_load_dwordx4 v221, s[20:23], s52 offen offset:0 sc1 lds
    buffer_load_dwordx4 v221, s[20:23], s52 offen offset:1024 sc1 lds
    v_mfma_f32_16x16x32_bf16 v[56:59], v[180:183], v[208:211], v[56:59]
    v_add_u32 v224, 0x4000, v224
    v_add_u32 v225, 0x4000, v225
    v_mfma_f32_16x16x32_bf16 v[76:79], v[180:183], v[212:215], v[76:79]
    ds_read_b64_tr_b16 v[144:145], v226 offset:0
    s_waitcnt lgkmcnt(1)
    v_mfma_f32_16x16x32_bf16 v[20:23], v[184:187], v[200:203], v[20:23]
    ds_read_b64_tr_b16 v[146:147], v226 offset:5120
    v_mfma_f32_16x16x32_bf16 v[40:43], v[184:187], v[204:207], v[40:43]
    ds_read_b128 v[164:167], v222 offset:0
    buffer_load_dwordx4 v221, s[20:23], s52 offen offset:2048 sc1 lds
    buffer_load_dwordx4 v221, s[20:23], s52 offen offset:3072 sc1 lds
    v_mfma_f32_16x16x32_bf16 v[60:63], v[184:187], v[208:211], v[60:63]
    ds_read_b128 v[168:171], v223 offset:0
    v_mfma_f32_16x16x32_bf16 v[80:83], v[184:187], v[212:215], v[80:83]
    ds_read_b128 v[172:175], v224 offset:0
    v_mfma_f32_16x16x32_bf16 v[24:27], v[188:191], v[200:203], v[24:27]
    ds_read_b128 v[176:179], v225 offset:0
    v_mfma_f32_16x16x32_bf16 v[44:47], v[188:191], v[204:207], v[44:47]
    ds_read_b64_tr_b16 v[148:149], v227 offset:32
    v_mfma_f32_16x16x32_bf16 v[64:67], v[188:191], v[208:211], v[64:67]
    ds_read_b64_tr_b16 v[150:151], v227 offset:5152
    v_mfma_f32_16x16x32_bf16 v[84:87], v[188:191], v[212:215], v[84:87]
    ds_read_b64_tr_b16 v[152:153], v226 offset:64
    v_mfma_f32_16x16x32_bf16 v[28:31], v[192:195], v[200:203], v[28:31]
    ds_read_b64_tr_b16 v[154:155], v226 offset:5184
    v_mfma_f32_16x16x32_bf16 v[48:51], v[192:195], v[204:207], v[48:51]
    ds_read_b64_tr_b16 v[156:157], v227 offset:96
    v_mfma_f32_16x16x32_bf16 v[68:71], v[192:195], v[208:211], v[68:71]
    ds_read_b64_tr_b16 v[158:159], v227 offset:5216
    v_mfma_f32_16x16x32_bf16 v[88:91], v[192:195], v[212:215], v[88:91]
    ds_read_b64_tr_b16 v[160:161], v226 offset:128
    v_mfma_f32_16x16x32_bf16 v[32:35], v[196:199], v[200:203], v[32:35]
    ds_read_b64_tr_b16 v[162:163], v226 offset:5248
    v_mfma_f32_16x16x32_bf16 v[52:55], v[196:199], v[204:207], v[52:55]
    v_mfma_f32_16x16x32_bf16 v[72:75], v[196:199], v[208:211], v[72:75]
    v_mfma_f32_16x16x32_bf16 v[92:95], v[196:199], v[212:215], v[92:95]
    s_waitcnt vmcnt(9)
    s_barrier
    s_waitcnt lgkmcnt(8)
    v_mfma_f32_16x16x32_bf16 v[16:19], v[144:147], v[164:167], v[16:19]
    ds_read_b64_tr_b16 v[180:181], v226 offset:10240
    v_mfma_f32_16x16x32_bf16 v[36:39], v[144:147], v[168:171], v[36:39]
    ds_read_b64_tr_b16 v[182:183], v226 offset:15360
    v_mfma_f32_16x16x32_bf16 v[56:59], v[144:147], v[172:175], v[56:59]
    ds_read_b128 v[200:203], v222 offset:8192
    v_mfma_f32_16x16x32_bf16 v[76:79], v[144:147], v[176:179], v[76:79]
    ds_read_b128 v[204:207], v223 offset:8192
    s_waitcnt lgkmcnt(4)
    v_mfma_f32_16x16x32_bf16 v[20:23], v[148:151], v[164:167], v[20:23]
    ds_read_b128 v[208:211], v224 offset:8192
    v_mfma_f32_16x16x32_bf16 v[40:43], v[148:151], v[168:171], v[40:43]
    ds_read_b128 v[212:215], v225 offset:8192
    v_mfma_f32_16x16x32_bf16 v[60:63], v[148:151], v[172:175], v[60:63]
    ds_read_b64_tr_b16 v[184:185], v227 offset:10272
    v_mfma_f32_16x16x32_bf16 v[80:83], v[148:151], v[176:179], v[80:83]
    ds_read_b64_tr_b16 v[186:187], v227 offset:15392
    v_mfma_f32_16x16x32_bf16 v[24:27], v[152:155], v[164:167], v[24:27]
    ds_read_b64_tr_b16 v[188:189], v226 offset:10304
    v_mfma_f32_16x16x32_bf16 v[44:47], v[152:155], v[168:171], v[44:47]
    ds_read_b64_tr_b16 v[190:191], v226 offset:15424
    v_mfma_f32_16x16x32_bf16 v[64:67], v[152:155], v[172:175], v[64:67]
    ds_read_b64_tr_b16 v[192:193], v227 offset:10336
    v_mfma_f32_16x16x32_bf16 v[84:87], v[152:155], v[176:179], v[84:87]
    ds_read_b64_tr_b16 v[194:195], v227 offset:15456
    v_mfma_f32_16x16x32_bf16 v[28:31], v[156:159], v[164:167], v[28:31]
    ds_read_b64_tr_b16 v[196:197], v226 offset:10368
    v_mfma_f32_16x16x32_bf16 v[48:51], v[156:159], v[168:171], v[48:51]
    ds_read_b64_tr_b16 v[198:199], v226 offset:15488
    v_mfma_f32_16x16x32_bf16 v[68:71], v[156:159], v[172:175], v[68:71]
    v_mfma_f32_16x16x32_bf16 v[88:91], v[156:159], v[176:179], v[88:91]
    v_mfma_f32_16x16x32_bf16 v[32:35], v[160:163], v[164:167], v[32:35]
    v_mfma_f32_16x16x32_bf16 v[52:55], v[160:163], v[168:171], v[52:55]
    v_mfma_f32_16x16x32_bf16 v[72:75], v[160:163], v[172:175], v[72:75]
    v_mfma_f32_16x16x32_bf16 v[92:95], v[160:163], v[176:179], v[92:95]
    s_waitcnt lgkmcnt(8)
    v_mfma_f32_16x16x32_bf16 v[16:19], v[180:183], v[200:203], v[16:19]
    v_add_u32 v226, 0xffffb000, v226
    v_add_u32 v227, 0xffffb000, v227
    v_mfma_f32_16x16x32_bf16 v[36:39], v[180:183], v[204:207], v[36:39]
    v_add_u32 v222, 0x4000, v222
    v_add_u32 v223, 0x4000, v223
    v_mfma_f32_16x16x32_bf16 v[56:59], v[180:183], v[208:211], v[56:59]
    v_add_u32 v224, 0x4000, v224
    v_add_u32 v225, 0x4000, v225
    v_mfma_f32_16x16x32_bf16 v[76:79], v[180:183], v[212:215], v[76:79]
    ds_read_b64_tr_b16 v[144:145], v226 offset:0
    s_waitcnt lgkmcnt(1)
    v_mfma_f32_16x16x32_bf16 v[20:23], v[184:187], v[200:203], v[20:23]
    ds_read_b64_tr_b16 v[146:147], v226 offset:5120
    v_mfma_f32_16x16x32_bf16 v[40:43], v[184:187], v[204:207], v[40:43]
    ds_read_b128 v[164:167], v222 offset:0
    v_mfma_f32_16x16x32_bf16 v[60:63], v[184:187], v[208:211], v[60:63]
    ds_read_b128 v[168:171], v223 offset:0
    v_mfma_f32_16x16x32_bf16 v[80:83], v[184:187], v[212:215], v[80:83]
    ds_read_b128 v[172:175], v224 offset:0
    v_mfma_f32_16x16x32_bf16 v[24:27], v[188:191], v[200:203], v[24:27]
    ds_read_b128 v[176:179], v225 offset:0
    v_mfma_f32_16x16x32_bf16 v[44:47], v[188:191], v[204:207], v[44:47]
    ds_read_b64_tr_b16 v[148:149], v227 offset:32
    v_mfma_f32_16x16x32_bf16 v[64:67], v[188:191], v[208:211], v[64:67]
    ds_read_b64_tr_b16 v[150:151], v227 offset:5152
    v_mfma_f32_16x16x32_bf16 v[84:87], v[188:191], v[212:215], v[84:87]
    ds_read_b64_tr_b16 v[152:153], v226 offset:64
    v_mfma_f32_16x16x32_bf16 v[28:31], v[192:195], v[200:203], v[28:31]
    ds_read_b64_tr_b16 v[154:155], v226 offset:5184
    v_mfma_f32_16x16x32_bf16 v[48:51], v[192:195], v[204:207], v[48:51]
    ds_read_b64_tr_b16 v[156:157], v227 offset:96
    v_mfma_f32_16x16x32_bf16 v[68:71], v[192:195], v[208:211], v[68:71]
    ds_read_b64_tr_b16 v[158:159], v227 offset:5216
    v_mfma_f32_16x16x32_bf16 v[88:91], v[192:195], v[212:215], v[88:91]
    ds_read_b64_tr_b16 v[160:161], v226 offset:128
    v_mfma_f32_16x16x32_bf16 v[32:35], v[196:199], v[200:203], v[32:35]
    ds_read_b64_tr_b16 v[162:163], v226 offset:5248
    v_mfma_f32_16x16x32_bf16 v[52:55], v[196:199], v[204:207], v[52:55]
    v_mfma_f32_16x16x32_bf16 v[72:75], v[196:199], v[208:211], v[72:75]
    v_mfma_f32_16x16x32_bf16 v[92:95], v[196:199], v[212:215], v[92:95]
    s_waitcnt vmcnt(0)
    s_barrier
    s_waitcnt lgkmcnt(8)
    v_mfma_f32_16x16x32_bf16 v[16:19], v[144:147], v[164:167], v[16:19]
    ds_read_b64_tr_b16 v[180:181], v226 offset:10240
    v_mfma_f32_16x16x32_bf16 v[36:39], v[144:147], v[168:171], v[36:39]
    ds_read_b64_tr_b16 v[182:183], v226 offset:15360
    v_mfma_f32_16x16x32_bf16 v[56:59], v[144:147], v[172:175], v[56:59]
    ds_read_b128 v[200:203], v222 offset:8192
    v_mfma_f32_16x16x32_bf16 v[76:79], v[144:147], v[176:179], v[76:79]
    ds_read_b128 v[204:207], v223 offset:8192
    s_waitcnt lgkmcnt(4)
    v_mfma_f32_16x16x32_bf16 v[20:23], v[148:151], v[164:167], v[20:23]
    ds_read_b128 v[208:211], v224 offset:8192
    v_mfma_f32_16x16x32_bf16 v[40:43], v[148:151], v[168:171], v[40:43]
    ds_read_b128 v[212:215], v225 offset:8192
    v_mfma_f32_16x16x32_bf16 v[60:63], v[148:151], v[172:175], v[60:63]
    ds_read_b64_tr_b16 v[184:185], v227 offset:10272
    v_mfma_f32_16x16x32_bf16 v[80:83], v[148:151], v[176:179], v[80:83]
    ds_read_b64_tr_b16 v[186:187], v227 offset:15392
    v_mfma_f32_16x16x32_bf16 v[24:27], v[152:155], v[164:167], v[24:27]
    ds_read_b64_tr_b16 v[188:189], v226 offset:10304
    v_mfma_f32_16x16x32_bf16 v[44:47], v[152:155], v[168:171], v[44:47]
    ds_read_b64_tr_b16 v[190:191], v226 offset:15424
    v_mfma_f32_16x16x32_bf16 v[64:67], v[152:155], v[172:175], v[64:67]
    ds_read_b64_tr_b16 v[192:193], v227 offset:10336
    v_mfma_f32_16x16x32_bf16 v[84:87], v[152:155], v[176:179], v[84:87]
    ds_read_b64_tr_b16 v[194:195], v227 offset:15456
    v_mfma_f32_16x16x32_bf16 v[28:31], v[156:159], v[164:167], v[28:31]
    ds_read_b64_tr_b16 v[196:197], v226 offset:10368
    v_mfma_f32_16x16x32_bf16 v[48:51], v[156:159], v[168:171], v[48:51]
    ds_read_b64_tr_b16 v[198:199], v226 offset:15488
    v_mfma_f32_16x16x32_bf16 v[68:71], v[156:159], v[172:175], v[68:71]
    v_mfma_f32_16x16x32_bf16 v[88:91], v[156:159], v[176:179], v[88:91]
    v_mfma_f32_16x16x32_bf16 v[32:35], v[160:163], v[164:167], v[32:35]
    v_mfma_f32_16x16x32_bf16 v[52:55], v[160:163], v[168:171], v[52:55]
    v_mfma_f32_16x16x32_bf16 v[72:75], v[160:163], v[172:175], v[72:75]
    v_mfma_f32_16x16x32_bf16 v[92:95], v[160:163], v[176:179], v[92:95]
    s_waitcnt lgkmcnt(8)
    v_mfma_f32_16x16x32_bf16 v[16:19], v[180:183], v[200:203], v[16:19]
    v_add_u32 v226, 0xf000, v226
    v_add_u32 v227, 0xf000, v227
    v_mfma_f32_16x16x32_bf16 v[36:39], v[180:183], v[204:207], v[36:39]
    v_add_u32 v222, 0x1c000, v222
    v_add_u32 v223, 0x1c000, v223
    v_mfma_f32_16x16x32_bf16 v[56:59], v[180:183], v[208:211], v[56:59]
    v_add_u32 v224, 0x1c000, v224
    v_add_u32 v225, 0x1c000, v225
    v_mfma_f32_16x16x32_bf16 v[76:79], v[180:183], v[212:215], v[76:79]
    ds_read_b64_tr_b16 v[144:145], v226 offset:0
    s_waitcnt lgkmcnt(1)
    v_mfma_f32_16x16x32_bf16 v[20:23], v[184:187], v[200:203], v[20:23]
    ds_read_b64_tr_b16 v[146:147], v226 offset:5120
    v_mfma_f32_16x16x32_bf16 v[40:43], v[184:187], v[204:207], v[40:43]
    ds_read_b128 v[164:167], v222 offset:0
    v_mfma_f32_16x16x32_bf16 v[60:63], v[184:187], v[208:211], v[60:63]
    ds_read_b128 v[168:171], v223 offset:0
    v_mfma_f32_16x16x32_bf16 v[80:83], v[184:187], v[212:215], v[80:83]
    ds_read_b128 v[172:175], v224 offset:0
    v_mfma_f32_16x16x32_bf16 v[24:27], v[188:191], v[200:203], v[24:27]
    ds_read_b128 v[176:179], v225 offset:0
    v_mfma_f32_16x16x32_bf16 v[44:47], v[188:191], v[204:207], v[44:47]
    ds_read_b64_tr_b16 v[148:149], v227 offset:32
    v_mfma_f32_16x16x32_bf16 v[64:67], v[188:191], v[208:211], v[64:67]
    ds_read_b64_tr_b16 v[150:151], v227 offset:5152
    v_mfma_f32_16x16x32_bf16 v[84:87], v[188:191], v[212:215], v[84:87]
    ds_read_b64_tr_b16 v[152:153], v226 offset:64
    v_mfma_f32_16x16x32_bf16 v[28:31], v[192:195], v[200:203], v[28:31]
    ds_read_b64_tr_b16 v[154:155], v226 offset:5184
    v_mfma_f32_16x16x32_bf16 v[48:51], v[192:195], v[204:207], v[48:51]
    ds_read_b64_tr_b16 v[156:157], v227 offset:96
    v_mfma_f32_16x16x32_bf16 v[68:71], v[192:195], v[208:211], v[68:71]
    ds_read_b64_tr_b16 v[158:159], v227 offset:5216
    v_mfma_f32_16x16x32_bf16 v[88:91], v[192:195], v[212:215], v[88:91]
    ds_read_b64_tr_b16 v[160:161], v226 offset:128
    v_mfma_f32_16x16x32_bf16 v[32:35], v[196:199], v[200:203], v[32:35]
    ds_read_b64_tr_b16 v[162:163], v226 offset:5248
    v_mfma_f32_16x16x32_bf16 v[52:55], v[196:199], v[204:207], v[52:55]
    v_mfma_f32_16x16x32_bf16 v[72:75], v[196:199], v[208:211], v[72:75]
    v_mfma_f32_16x16x32_bf16 v[92:95], v[196:199], v[212:215], v[92:95]
    s_barrier
    s_waitcnt lgkmcnt(8)
    v_mfma_f32_16x16x32_bf16 v[16:19], v[144:147], v[164:167], v[16:19]
    ds_read_b64_tr_b16 v[180:181], v226 offset:10240
    v_mfma_f32_16x16x32_bf16 v[36:39], v[144:147], v[168:171], v[36:39]
    ds_read_b64_tr_b16 v[182:183], v226 offset:15360
    v_mfma_f32_16x16x32_bf16 v[56:59], v[144:147], v[172:175], v[56:59]
    ds_read_b128 v[200:203], v222 offset:8192
    v_mfma_f32_16x16x32_bf16 v[76:79], v[144:147], v[176:179], v[76:79]
    ds_read_b128 v[204:207], v223 offset:8192
    s_waitcnt lgkmcnt(4)
    v_mfma_f32_16x16x32_bf16 v[20:23], v[148:151], v[164:167], v[20:23]
    ds_read_b128 v[208:211], v224 offset:8192
    v_mfma_f32_16x16x32_bf16 v[40:43], v[148:151], v[168:171], v[40:43]
    ds_read_b128 v[212:215], v225 offset:8192
    v_mfma_f32_16x16x32_bf16 v[60:63], v[148:151], v[172:175], v[60:63]
    ds_read_b64_tr_b16 v[184:185], v227 offset:10272
    v_mfma_f32_16x16x32_bf16 v[80:83], v[148:151], v[176:179], v[80:83]
    ds_read_b64_tr_b16 v[186:187], v227 offset:15392
    v_mfma_f32_16x16x32_bf16 v[24:27], v[152:155], v[164:167], v[24:27]
    ds_read_b64_tr_b16 v[188:189], v226 offset:10304
    v_mfma_f32_16x16x32_bf16 v[44:47], v[152:155], v[168:171], v[44:47]
    ds_read_b64_tr_b16 v[190:191], v226 offset:15424
    v_mfma_f32_16x16x32_bf16 v[64:67], v[152:155], v[172:175], v[64:67]
    ds_read_b64_tr_b16 v[192:193], v227 offset:10336
    v_mfma_f32_16x16x32_bf16 v[84:87], v[152:155], v[176:179], v[84:87]
    ds_read_b64_tr_b16 v[194:195], v227 offset:15456
    v_mfma_f32_16x16x32_bf16 v[28:31], v[156:159], v[164:167], v[28:31]
    ds_read_b64_tr_b16 v[196:197], v226 offset:10368
    v_mfma_f32_16x16x32_bf16 v[48:51], v[156:159], v[168:171], v[48:51]
    ds_read_b64_tr_b16 v[198:199], v226 offset:15488
    v_mfma_f32_16x16x32_bf16 v[68:71], v[156:159], v[172:175], v[68:71]
    v_mfma_f32_16x16x32_bf16 v[88:91], v[156:159], v[176:179], v[88:91]
    v_mfma_f32_16x16x32_bf16 v[32:35], v[160:163], v[164:167], v[32:35]
    v_mfma_f32_16x16x32_bf16 v[52:55], v[160:163], v[168:171], v[52:55]
    v_mfma_f32_16x16x32_bf16 v[72:75], v[160:163], v[172:175], v[72:75]
    v_mfma_f32_16x16x32_bf16 v[92:95], v[160:163], v[176:179], v[92:95]
    s_waitcnt lgkmcnt(8)
    v_mfma_f32_16x16x32_bf16 v[16:19], v[180:183], v[200:203], v[16:19]
    v_add_u32 v226, 0xffffb000, v226
    v_add_u32 v227, 0xffffb000, v227
    v_mfma_f32_16x16x32_bf16 v[36:39], v[180:183], v[204:207], v[36:39]
    v_add_u32 v222, 0xfffdc000, v222
    v_add_u32 v223, 0xfffdc000, v223
    v_mfma_f32_16x16x32_bf16 v[56:59], v[180:183], v[208:211], v[56:59]
    v_add_u32 v224, 0xfffdc000, v224
    v_add_u32 v225, 0xfffdc000, v225
    v_mfma_f32_16x16x32_bf16 v[76:79], v[180:183], v[212:215], v[76:79]
    ds_read_b64_tr_b16 v[144:145], v226 offset:0
    s_waitcnt lgkmcnt(1)
    v_mfma_f32_16x16x32_bf16 v[20:23], v[184:187], v[200:203], v[20:23]
    ds_read_b64_tr_b16 v[146:147], v226 offset:5120
    v_mfma_f32_16x16x32_bf16 v[40:43], v[184:187], v[204:207], v[40:43]
    ds_read_b128 v[164:167], v222 offset:0
    v_mfma_f32_16x16x32_bf16 v[60:63], v[184:187], v[208:211], v[60:63]
    ds_read_b128 v[168:171], v223 offset:0
    v_mfma_f32_16x16x32_bf16 v[80:83], v[184:187], v[212:215], v[80:83]
    ds_read_b128 v[172:175], v224 offset:0
    v_mfma_f32_16x16x32_bf16 v[24:27], v[188:191], v[200:203], v[24:27]
    ds_read_b128 v[176:179], v225 offset:0
    v_mfma_f32_16x16x32_bf16 v[44:47], v[188:191], v[204:207], v[44:47]
    ds_read_b64_tr_b16 v[148:149], v227 offset:32
    v_mfma_f32_16x16x32_bf16 v[64:67], v[188:191], v[208:211], v[64:67]
    ds_read_b64_tr_b16 v[150:151], v227 offset:5152
    v_mfma_f32_16x16x32_bf16 v[84:87], v[188:191], v[212:215], v[84:87]
    ds_read_b64_tr_b16 v[152:153], v226 offset:64
    v_mfma_f32_16x16x32_bf16 v[28:31], v[192:195], v[200:203], v[28:31]
    ds_read_b64_tr_b16 v[154:155], v226 offset:5184
    v_mfma_f32_16x16x32_bf16 v[48:51], v[192:195], v[204:207], v[48:51]
    ds_read_b64_tr_b16 v[156:157], v227 offset:96
    v_mfma_f32_16x16x32_bf16 v[68:71], v[192:195], v[208:211], v[68:71]
    ds_read_b64_tr_b16 v[158:159], v227 offset:5216
    v_mfma_f32_16x16x32_bf16 v[88:91], v[192:195], v[212:215], v[88:91]
    ds_read_b64_tr_b16 v[160:161], v226 offset:128
    v_mfma_f32_16x16x32_bf16 v[32:35], v[196:199], v[200:203], v[32:35]
    ds_read_b64_tr_b16 v[162:163], v226 offset:5248
    v_mfma_f32_16x16x32_bf16 v[52:55], v[196:199], v[204:207], v[52:55]
    v_mfma_f32_16x16x32_bf16 v[72:75], v[196:199], v[208:211], v[72:75]
    v_mfma_f32_16x16x32_bf16 v[92:95], v[196:199], v[212:215], v[92:95]
    s_barrier
    s_waitcnt lgkmcnt(8)
    v_mfma_f32_16x16x32_bf16 v[16:19], v[144:147], v[164:167], v[16:19]
    ds_read_b64_tr_b16 v[180:181], v226 offset:10240
    v_mfma_f32_16x16x32_bf16 v[36:39], v[144:147], v[168:171], v[36:39]
    ds_read_b64_tr_b16 v[182:183], v226 offset:15360
    v_mfma_f32_16x16x32_bf16 v[56:59], v[144:147], v[172:175], v[56:59]
    ds_read_b128 v[200:203], v222 offset:8192
    v_mfma_f32_16x16x32_bf16 v[76:79], v[144:147], v[176:179], v[76:79]
    ds_read_b128 v[204:207], v223 offset:8192
    s_waitcnt lgkmcnt(4)
    v_mfma_f32_16x16x32_bf16 v[20:23], v[148:151], v[164:167], v[20:23]
    ds_read_b128 v[208:211], v224 offset:8192
    v_mfma_f32_16x16x32_bf16 v[40:43], v[148:151], v[168:171], v[40:43]
    ds_read_b128 v[212:215], v225 offset:8192
    v_mfma_f32_16x16x32_bf16 v[60:63], v[148:151], v[172:175], v[60:63]
    ds_read_b64_tr_b16 v[184:185], v227 offset:10272
    v_mfma_f32_16x16x32_bf16 v[80:83], v[148:151], v[176:179], v[80:83]
    ds_read_b64_tr_b16 v[186:187], v227 offset:15392
    v_mfma_f32_16x16x32_bf16 v[24:27], v[152:155], v[164:167], v[24:27]
    ds_read_b64_tr_b16 v[188:189], v226 offset:10304
    v_mfma_f32_16x16x32_bf16 v[44:47], v[152:155], v[168:171], v[44:47]
    ds_read_b64_tr_b16 v[190:191], v226 offset:15424
    v_mfma_f32_16x16x32_bf16 v[64:67], v[152:155], v[172:175], v[64:67]
    ds_read_b64_tr_b16 v[192:193], v227 offset:10336
    v_mfma_f32_16x16x32_bf16 v[84:87], v[152:155], v[176:179], v[84:87]
    ds_read_b64_tr_b16 v[194:195], v227 offset:15456
    v_mfma_f32_16x16x32_bf16 v[28:31], v[156:159], v[164:167], v[28:31]
    ds_read_b64_tr_b16 v[196:197], v226 offset:10368
    v_mfma_f32_16x16x32_bf16 v[48:51], v[156:159], v[168:171], v[48:51]
    ds_read_b64_tr_b16 v[198:199], v226 offset:15488
    v_mfma_f32_16x16x32_bf16 v[68:71], v[156:159], v[172:175], v[68:71]
    v_mfma_f32_16x16x32_bf16 v[88:91], v[156:159], v[176:179], v[88:91]
    v_mfma_f32_16x16x32_bf16 v[32:35], v[160:163], v[164:167], v[32:35]
    v_mfma_f32_16x16x32_bf16 v[52:55], v[160:163], v[168:171], v[52:55]
    v_mfma_f32_16x16x32_bf16 v[72:75], v[160:163], v[172:175], v[72:75]
    v_mfma_f32_16x16x32_bf16 v[92:95], v[160:163], v[176:179], v[92:95]
    s_waitcnt lgkmcnt(8)
    v_mfma_f32_16x16x32_bf16 v[16:19], v[180:183], v[200:203], v[16:19]
    v_add_u32 v226, 0xffffb000, v226
    v_add_u32 v227, 0xffffb000, v227
    v_mfma_f32_16x16x32_bf16 v[36:39], v[180:183], v[204:207], v[36:39]
    v_add_u32 v222, 0x4000, v222
    v_add_u32 v223, 0x4000, v223
    v_mfma_f32_16x16x32_bf16 v[56:59], v[180:183], v[208:211], v[56:59]
    v_add_u32 v224, 0x4000, v224
    v_add_u32 v225, 0x4000, v225
    v_mfma_f32_16x16x32_bf16 v[76:79], v[180:183], v[212:215], v[76:79]
    ds_read_b64_tr_b16 v[144:145], v226 offset:0
    s_waitcnt lgkmcnt(1)
    v_mfma_f32_16x16x32_bf16 v[20:23], v[184:187], v[200:203], v[20:23]
    ds_read_b64_tr_b16 v[146:147], v226 offset:5120
    v_mfma_f32_16x16x32_bf16 v[40:43], v[184:187], v[204:207], v[40:43]
    ds_read_b128 v[164:167], v222 offset:0
    v_mfma_f32_16x16x32_bf16 v[60:63], v[184:187], v[208:211], v[60:63]
    ds_read_b128 v[168:171], v223 offset:0
    v_mfma_f32_16x16x32_bf16 v[80:83], v[184:187], v[212:215], v[80:83]
    ds_read_b128 v[172:175], v224 offset:0
    v_mfma_f32_16x16x32_bf16 v[24:27], v[188:191], v[200:203], v[24:27]
    ds_read_b128 v[176:179], v225 offset:0
    v_mfma_f32_16x16x32_bf16 v[44:47], v[188:191], v[204:207], v[44:47]
    ds_read_b64_tr_b16 v[148:149], v227 offset:32
    v_mfma_f32_16x16x32_bf16 v[64:67], v[188:191], v[208:211], v[64:67]
    ds_read_b64_tr_b16 v[150:151], v227 offset:5152
    v_mfma_f32_16x16x32_bf16 v[84:87], v[188:191], v[212:215], v[84:87]
    ds_read_b64_tr_b16 v[152:153], v226 offset:64
    v_mfma_f32_16x16x32_bf16 v[28:31], v[192:195], v[200:203], v[28:31]
    ds_read_b64_tr_b16 v[154:155], v226 offset:5184
    v_mfma_f32_16x16x32_bf16 v[48:51], v[192:195], v[204:207], v[48:51]
    ds_read_b64_tr_b16 v[156:157], v227 offset:96
    v_mfma_f32_16x16x32_bf16 v[68:71], v[192:195], v[208:211], v[68:71]
    ds_read_b64_tr_b16 v[158:159], v227 offset:5216
    v_mfma_f32_16x16x32_bf16 v[88:91], v[192:195], v[212:215], v[88:91]
    ds_read_b64_tr_b16 v[160:161], v226 offset:128
    v_mfma_f32_16x16x32_bf16 v[32:35], v[196:199], v[200:203], v[32:35]
    ds_read_b64_tr_b16 v[162:163], v226 offset:5248
    v_mfma_f32_16x16x32_bf16 v[52:55], v[196:199], v[204:207], v[52:55]
    v_mfma_f32_16x16x32_bf16 v[72:75], v[196:199], v[208:211], v[72:75]
    v_mfma_f32_16x16x32_bf16 v[92:95], v[196:199], v[212:215], v[92:95]
    s_barrier
    s_waitcnt lgkmcnt(8)
    v_mfma_f32_16x16x32_bf16 v[16:19], v[144:147], v[164:167], v[16:19]
    ds_read_b64_tr_b16 v[180:181], v226 offset:10240
    v_mfma_f32_16x16x32_bf16 v[36:39], v[144:147], v[168:171], v[36:39]
    ds_read_b64_tr_b16 v[182:183], v226 offset:15360
    v_mfma_f32_16x16x32_bf16 v[56:59], v[144:147], v[172:175], v[56:59]
    ds_read_b128 v[200:203], v222 offset:8192
    v_mfma_f32_16x16x32_bf16 v[76:79], v[144:147], v[176:179], v[76:79]
    ds_read_b128 v[204:207], v223 offset:8192
    s_waitcnt lgkmcnt(4)
    v_mfma_f32_16x16x32_bf16 v[20:23], v[148:151], v[164:167], v[20:23]
    ds_read_b128 v[208:211], v224 offset:8192
    v_mfma_f32_16x16x32_bf16 v[40:43], v[148:151], v[168:171], v[40:43]
    ds_read_b128 v[212:215], v225 offset:8192
    v_mfma_f32_16x16x32_bf16 v[60:63], v[148:151], v[172:175], v[60:63]
    ds_read_b64_tr_b16 v[184:185], v227 offset:10272
    v_mfma_f32_16x16x32_bf16 v[80:83], v[148:151], v[176:179], v[80:83]
    ds_read_b64_tr_b16 v[186:187], v227 offset:15392
    v_mfma_f32_16x16x32_bf16 v[24:27], v[152:155], v[164:167], v[24:27]
    ds_read_b64_tr_b16 v[188:189], v226 offset:10304
    v_mfma_f32_16x16x32_bf16 v[44:47], v[152:155], v[168:171], v[44:47]
    ds_read_b64_tr_b16 v[190:191], v226 offset:15424
    v_mfma_f32_16x16x32_bf16 v[64:67], v[152:155], v[172:175], v[64:67]
    ds_read_b64_tr_b16 v[192:193], v227 offset:10336
    v_mfma_f32_16x16x32_bf16 v[84:87], v[152:155], v[176:179], v[84:87]
    ds_read_b64_tr_b16 v[194:195], v227 offset:15456
    v_mfma_f32_16x16x32_bf16 v[28:31], v[156:159], v[164:167], v[28:31]
    ds_read_b64_tr_b16 v[196:197], v226 offset:10368
    v_mfma_f32_16x16x32_bf16 v[48:51], v[156:159], v[168:171], v[48:51]
    ds_read_b64_tr_b16 v[198:199], v226 offset:15488
    v_mfma_f32_16x16x32_bf16 v[68:71], v[156:159], v[172:175], v[68:71]
    v_mfma_f32_16x16x32_bf16 v[88:91], v[156:159], v[176:179], v[88:91]
    v_mfma_f32_16x16x32_bf16 v[32:35], v[160:163], v[164:167], v[32:35]
    v_mfma_f32_16x16x32_bf16 v[52:55], v[160:163], v[168:171], v[52:55]
    v_mfma_f32_16x16x32_bf16 v[72:75], v[160:163], v[172:175], v[72:75]
    v_mfma_f32_16x16x32_bf16 v[92:95], v[160:163], v[176:179], v[92:95]
    s_waitcnt lgkmcnt(8)
    v_mfma_f32_16x16x32_bf16 v[16:19], v[180:183], v[200:203], v[16:19]
    v_add_u32 v226, 0xffffb000, v226
    v_add_u32 v227, 0xffffb000, v227
    v_mfma_f32_16x16x32_bf16 v[36:39], v[180:183], v[204:207], v[36:39]
    v_add_u32 v222, 0x4000, v222
    v_add_u32 v223, 0x4000, v223
    v_mfma_f32_16x16x32_bf16 v[56:59], v[180:183], v[208:211], v[56:59]
    v_add_u32 v224, 0x4000, v224
    v_add_u32 v225, 0x4000, v225
    v_mfma_f32_16x16x32_bf16 v[76:79], v[180:183], v[212:215], v[76:79]
    ds_read_b64_tr_b16 v[144:145], v226 offset:0
    s_waitcnt lgkmcnt(1)
    v_mfma_f32_16x16x32_bf16 v[20:23], v[184:187], v[200:203], v[20:23]
    ds_read_b64_tr_b16 v[146:147], v226 offset:5120
    v_mfma_f32_16x16x32_bf16 v[40:43], v[184:187], v[204:207], v[40:43]
    ds_read_b128 v[164:167], v222 offset:0
    v_mfma_f32_16x16x32_bf16 v[60:63], v[184:187], v[208:211], v[60:63]
    ds_read_b128 v[168:171], v223 offset:0
    v_mfma_f32_16x16x32_bf16 v[80:83], v[184:187], v[212:215], v[80:83]
    ds_read_b128 v[172:175], v224 offset:0
    v_mfma_f32_16x16x32_bf16 v[24:27], v[188:191], v[200:203], v[24:27]
    ds_read_b128 v[176:179], v225 offset:0
    v_mfma_f32_16x16x32_bf16 v[44:47], v[188:191], v[204:207], v[44:47]
    ds_read_b64_tr_b16 v[148:149], v227 offset:32
    v_mfma_f32_16x16x32_bf16 v[64:67], v[188:191], v[208:211], v[64:67]
    ds_read_b64_tr_b16 v[150:151], v227 offset:5152
    v_mfma_f32_16x16x32_bf16 v[84:87], v[188:191], v[212:215], v[84:87]
    ds_read_b64_tr_b16 v[152:153], v226 offset:64
    v_mfma_f32_16x16x32_bf16 v[28:31], v[192:195], v[200:203], v[28:31]
    ds_read_b64_tr_b16 v[154:155], v226 offset:5184
    v_mfma_f32_16x16x32_bf16 v[48:51], v[192:195], v[204:207], v[48:51]
    ds_read_b64_tr_b16 v[156:157], v227 offset:96
    v_mfma_f32_16x16x32_bf16 v[68:71], v[192:195], v[208:211], v[68:71]
    ds_read_b64_tr_b16 v[158:159], v227 offset:5216
    v_mfma_f32_16x16x32_bf16 v[88:91], v[192:195], v[212:215], v[88:91]
    ds_read_b64_tr_b16 v[160:161], v226 offset:128
    v_mfma_f32_16x16x32_bf16 v[32:35], v[196:199], v[200:203], v[32:35]
    ds_read_b64_tr_b16 v[162:163], v226 offset:5248
    v_mfma_f32_16x16x32_bf16 v[52:55], v[196:199], v[204:207], v[52:55]
    v_mfma_f32_16x16x32_bf16 v[72:75], v[196:199], v[208:211], v[72:75]
    v_mfma_f32_16x16x32_bf16 v[92:95], v[196:199], v[212:215], v[92:95]
    s_barrier
    s_waitcnt lgkmcnt(8)
    v_mfma_f32_16x16x32_bf16 v[16:19], v[144:147], v[164:167], v[16:19]
    ds_read_b64_tr_b16 v[180:181], v226 offset:10240
    v_mfma_f32_16x16x32_bf16 v[36:39], v[144:147], v[168:171], v[36:39]
    ds_read_b64_tr_b16 v[182:183], v226 offset:15360
    v_mfma_f32_16x16x32_bf16 v[56:59], v[144:147], v[172:175], v[56:59]
    ds_read_b128 v[200:203], v222 offset:8192
    v_mfma_f32_16x16x32_bf16 v[76:79], v[144:147], v[176:179], v[76:79]
    ds_read_b128 v[204:207], v223 offset:8192
    s_waitcnt lgkmcnt(4)
    v_mfma_f32_16x16x32_bf16 v[20:23], v[148:151], v[164:167], v[20:23]
    ds_read_b128 v[208:211], v224 offset:8192
    v_mfma_f32_16x16x32_bf16 v[40:43], v[148:151], v[168:171], v[40:43]
    ds_read_b128 v[212:215], v225 offset:8192
    v_mfma_f32_16x16x32_bf16 v[60:63], v[148:151], v[172:175], v[60:63]
    ds_read_b64_tr_b16 v[184:185], v227 offset:10272
    v_mfma_f32_16x16x32_bf16 v[80:83], v[148:151], v[176:179], v[80:83]
    ds_read_b64_tr_b16 v[186:187], v227 offset:15392
    v_mfma_f32_16x16x32_bf16 v[24:27], v[152:155], v[164:167], v[24:27]
    ds_read_b64_tr_b16 v[188:189], v226 offset:10304
    v_mfma_f32_16x16x32_bf16 v[44:47], v[152:155], v[168:171], v[44:47]
    ds_read_b64_tr_b16 v[190:191], v226 offset:15424
    v_mfma_f32_16x16x32_bf16 v[64:67], v[152:155], v[172:175], v[64:67]
    ds_read_b64_tr_b16 v[192:193], v227 offset:10336
    v_mfma_f32_16x16x32_bf16 v[84:87], v[152:155], v[176:179], v[84:87]
    ds_read_b64_tr_b16 v[194:195], v227 offset:15456
    v_mfma_f32_16x16x32_bf16 v[28:31], v[156:159], v[164:167], v[28:31]
    ds_read_b64_tr_b16 v[196:197], v226 offset:10368
    v_mfma_f32_16x16x32_bf16 v[48:51], v[156:159], v[168:171], v[48:51]
    ds_read_b64_tr_b16 v[198:199], v226 offset:15488
    v_mfma_f32_16x16x32_bf16 v[68:71], v[156:159], v[172:175], v[68:71]
    v_mfma_f32_16x16x32_bf16 v[88:91], v[156:159], v[176:179], v[88:91]
    v_mfma_f32_16x16x32_bf16 v[32:35], v[160:163], v[164:167], v[32:35]
    v_mfma_f32_16x16x32_bf16 v[52:55], v[160:163], v[168:171], v[52:55]
    v_mfma_f32_16x16x32_bf16 v[72:75], v[160:163], v[172:175], v[72:75]
    v_mfma_f32_16x16x32_bf16 v[92:95], v[160:163], v[176:179], v[92:95]
    s_waitcnt lgkmcnt(8)
    v_mfma_f32_16x16x32_bf16 v[16:19], v[180:183], v[200:203], v[16:19]
    v_add_u32 v226, 0xf000, v226
    v_add_u32 v227, 0xf000, v227
    v_mfma_f32_16x16x32_bf16 v[36:39], v[180:183], v[204:207], v[36:39]
    v_add_u32 v222, 0x1c000, v222
    v_add_u32 v223, 0x1c000, v223
    v_mfma_f32_16x16x32_bf16 v[56:59], v[180:183], v[208:211], v[56:59]
    v_add_u32 v224, 0x1c000, v224
    v_add_u32 v225, 0x1c000, v225
    v_mfma_f32_16x16x32_bf16 v[76:79], v[180:183], v[212:215], v[76:79]
    ds_read_b64_tr_b16 v[144:145], v226 offset:0
    s_waitcnt lgkmcnt(1)
    v_mfma_f32_16x16x32_bf16 v[20:23], v[184:187], v[200:203], v[20:23]
    ds_read_b64_tr_b16 v[146:147], v226 offset:5120
    v_mfma_f32_16x16x32_bf16 v[40:43], v[184:187], v[204:207], v[40:43]
    ds_read_b128 v[164:167], v222 offset:0
    v_mfma_f32_16x16x32_bf16 v[60:63], v[184:187], v[208:211], v[60:63]
    ds_read_b128 v[168:171], v223 offset:0
    v_mfma_f32_16x16x32_bf16 v[80:83], v[184:187], v[212:215], v[80:83]
    ds_read_b128 v[172:175], v224 offset:0
    v_mfma_f32_16x16x32_bf16 v[24:27], v[188:191], v[200:203], v[24:27]
    ds_read_b128 v[176:179], v225 offset:0
    v_mfma_f32_16x16x32_bf16 v[44:47], v[188:191], v[204:207], v[44:47]
    ds_read_b64_tr_b16 v[148:149], v227 offset:32
    v_mfma_f32_16x16x32_bf16 v[64:67], v[188:191], v[208:211], v[64:67]
    ds_read_b64_tr_b16 v[150:151], v227 offset:5152
    v_mfma_f32_16x16x32_bf16 v[84:87], v[188:191], v[212:215], v[84:87]
    ds_read_b64_tr_b16 v[152:153], v226 offset:64
    v_mfma_f32_16x16x32_bf16 v[28:31], v[192:195], v[200:203], v[28:31]
    ds_read_b64_tr_b16 v[154:155], v226 offset:5184
    v_mfma_f32_16x16x32_bf16 v[48:51], v[192:195], v[204:207], v[48:51]
    ds_read_b64_tr_b16 v[156:157], v227 offset:96
    v_mfma_f32_16x16x32_bf16 v[68:71], v[192:195], v[208:211], v[68:71]
    ds_read_b64_tr_b16 v[158:159], v227 offset:5216
    v_mfma_f32_16x16x32_bf16 v[88:91], v[192:195], v[212:215], v[88:91]
    ds_read_b64_tr_b16 v[160:161], v226 offset:128
    v_mfma_f32_16x16x32_bf16 v[32:35], v[196:199], v[200:203], v[32:35]
    ds_read_b64_tr_b16 v[162:163], v226 offset:5248
    v_mfma_f32_16x16x32_bf16 v[52:55], v[196:199], v[204:207], v[52:55]
    v_mfma_f32_16x16x32_bf16 v[72:75], v[196:199], v[208:211], v[72:75]
    v_mfma_f32_16x16x32_bf16 v[92:95], v[196:199], v[212:215], v[92:95]
    s_barrier
    s_waitcnt lgkmcnt(8)
    v_mfma_f32_16x16x32_bf16 v[16:19], v[144:147], v[164:167], v[16:19]
    ds_read_b64_tr_b16 v[180:181], v226 offset:10240
    v_mfma_f32_16x16x32_bf16 v[36:39], v[144:147], v[168:171], v[36:39]
    ds_read_b64_tr_b16 v[182:183], v226 offset:15360
    v_mfma_f32_16x16x32_bf16 v[56:59], v[144:147], v[172:175], v[56:59]
    ds_read_b128 v[200:203], v222 offset:8192
    v_mfma_f32_16x16x32_bf16 v[76:79], v[144:147], v[176:179], v[76:79]
    ds_read_b128 v[204:207], v223 offset:8192
    s_waitcnt lgkmcnt(4)
    v_mfma_f32_16x16x32_bf16 v[20:23], v[148:151], v[164:167], v[20:23]
    ds_read_b128 v[208:211], v224 offset:8192
    v_mfma_f32_16x16x32_bf16 v[40:43], v[148:151], v[168:171], v[40:43]
    ds_read_b128 v[212:215], v225 offset:8192
    v_mfma_f32_16x16x32_bf16 v[60:63], v[148:151], v[172:175], v[60:63]
    ds_read_b64_tr_b16 v[184:185], v227 offset:10272
    v_mfma_f32_16x16x32_bf16 v[80:83], v[148:151], v[176:179], v[80:83]
    ds_read_b64_tr_b16 v[186:187], v227 offset:15392
    v_mfma_f32_16x16x32_bf16 v[24:27], v[152:155], v[164:167], v[24:27]
    ds_read_b64_tr_b16 v[188:189], v226 offset:10304
    v_mfma_f32_16x16x32_bf16 v[44:47], v[152:155], v[168:171], v[44:47]
    ds_read_b64_tr_b16 v[190:191], v226 offset:15424
    v_mfma_f32_16x16x32_bf16 v[64:67], v[152:155], v[172:175], v[64:67]
    ds_read_b64_tr_b16 v[192:193], v227 offset:10336
    v_mfma_f32_16x16x32_bf16 v[84:87], v[152:155], v[176:179], v[84:87]
    ds_read_b64_tr_b16 v[194:195], v227 offset:15456
    v_mfma_f32_16x16x32_bf16 v[28:31], v[156:159], v[164:167], v[28:31]
    ds_read_b64_tr_b16 v[196:197], v226 offset:10368
    v_mfma_f32_16x16x32_bf16 v[48:51], v[156:159], v[168:171], v[48:51]
    ds_read_b64_tr_b16 v[198:199], v226 offset:15488
    v_mfma_f32_16x16x32_bf16 v[68:71], v[156:159], v[172:175], v[68:71]
    v_mfma_f32_16x16x32_bf16 v[88:91], v[156:159], v[176:179], v[88:91]
    v_mfma_f32_16x16x32_bf16 v[32:35], v[160:163], v[164:167], v[32:35]
    v_mfma_f32_16x16x32_bf16 v[52:55], v[160:163], v[168:171], v[52:55]
    v_mfma_f32_16x16x32_bf16 v[72:75], v[160:163], v[172:175], v[72:75]
    v_mfma_f32_16x16x32_bf16 v[92:95], v[160:163], v[176:179], v[92:95]
    s_waitcnt lgkmcnt(8)
    v_mfma_f32_16x16x32_bf16 v[16:19], v[180:183], v[200:203], v[16:19]
    v_add_u32 v226, 0xffffb000, v226
    v_add_u32 v227, 0xffffb000, v227
    v_mfma_f32_16x16x32_bf16 v[36:39], v[180:183], v[204:207], v[36:39]
    v_add_u32 v222, 0xfffdc000, v222
    v_add_u32 v223, 0xfffdc000, v223
    v_mfma_f32_16x16x32_bf16 v[56:59], v[180:183], v[208:211], v[56:59]
    v_add_u32 v224, 0xfffdc000, v224
    v_add_u32 v225, 0xfffdc000, v225
    v_mfma_f32_16x16x32_bf16 v[76:79], v[180:183], v[212:215], v[76:79]
    ds_read_b64_tr_b16 v[144:145], v226 offset:0
    s_waitcnt lgkmcnt(1)
    v_mfma_f32_16x16x32_bf16 v[20:23], v[184:187], v[200:203], v[20:23]
    ds_read_b64_tr_b16 v[146:147], v226 offset:5120
    v_mfma_f32_16x16x32_bf16 v[40:43], v[184:187], v[204:207], v[40:43]
    ds_read_b128 v[164:167], v222 offset:0
    v_mfma_f32_16x16x32_bf16 v[60:63], v[184:187], v[208:211], v[60:63]
    ds_read_b128 v[168:171], v223 offset:0
    v_mfma_f32_16x16x32_bf16 v[80:83], v[184:187], v[212:215], v[80:83]
    ds_read_b128 v[172:175], v224 offset:0
    v_mfma_f32_16x16x32_bf16 v[24:27], v[188:191], v[200:203], v[24:27]
    ds_read_b128 v[176:179], v225 offset:0
    v_mfma_f32_16x16x32_bf16 v[44:47], v[188:191], v[204:207], v[44:47]
    ds_read_b64_tr_b16 v[148:149], v227 offset:32
    v_mfma_f32_16x16x32_bf16 v[64:67], v[188:191], v[208:211], v[64:67]
    ds_read_b64_tr_b16 v[150:151], v227 offset:5152
    v_mfma_f32_16x16x32_bf16 v[84:87], v[188:191], v[212:215], v[84:87]
    ds_read_b64_tr_b16 v[152:153], v226 offset:64
    v_mfma_f32_16x16x32_bf16 v[28:31], v[192:195], v[200:203], v[28:31]
    ds_read_b64_tr_b16 v[154:155], v226 offset:5184
    v_mfma_f32_16x16x32_bf16 v[48:51], v[192:195], v[204:207], v[48:51]
    ds_read_b64_tr_b16 v[156:157], v227 offset:96
    v_mfma_f32_16x16x32_bf16 v[68:71], v[192:195], v[208:211], v[68:71]
    ds_read_b64_tr_b16 v[158:159], v227 offset:5216
    v_mfma_f32_16x16x32_bf16 v[88:91], v[192:195], v[212:215], v[88:91]
    ds_read_b64_tr_b16 v[160:161], v226 offset:128
    v_mfma_f32_16x16x32_bf16 v[32:35], v[196:199], v[200:203], v[32:35]
    ds_read_b64_tr_b16 v[162:163], v226 offset:5248
    v_mfma_f32_16x16x32_bf16 v[52:55], v[196:199], v[204:207], v[52:55]
    v_mfma_f32_16x16x32_bf16 v[72:75], v[196:199], v[208:211], v[72:75]
    v_mfma_f32_16x16x32_bf16 v[92:95], v[196:199], v[212:215], v[92:95]
    s_barrier
    s_waitcnt lgkmcnt(8)
    v_mfma_f32_16x16x32_bf16 v[16:19], v[144:147], v[164:167], v[16:19]
    ds_read_b64_tr_b16 v[180:181], v226 offset:10240
    v_mfma_f32_16x16x32_bf16 v[36:39], v[144:147], v[168:171], v[36:39]
    ds_read_b64_tr_b16 v[182:183], v226 offset:15360
    v_mfma_f32_16x16x32_bf16 v[56:59], v[144:147], v[172:175], v[56:59]
    ds_read_b128 v[200:203], v222 offset:8192
    v_mfma_f32_16x16x32_bf16 v[76:79], v[144:147], v[176:179], v[76:79]
    ds_read_b128 v[204:207], v223 offset:8192
    s_waitcnt lgkmcnt(4)
    v_mfma_f32_16x16x32_bf16 v[20:23], v[148:151], v[164:167], v[20:23]
    ds_read_b128 v[208:211], v224 offset:8192
    v_mfma_f32_16x16x32_bf16 v[40:43], v[148:151], v[168:171], v[40:43]
    ds_read_b128 v[212:215], v225 offset:8192
    v_mfma_f32_16x16x32_bf16 v[60:63], v[148:151], v[172:175], v[60:63]
    ds_read_b64_tr_b16 v[184:185], v227 offset:10272
    v_mfma_f32_16x16x32_bf16 v[80:83], v[148:151], v[176:179], v[80:83]
    ds_read_b64_tr_b16 v[186:187], v227 offset:15392
    v_mfma_f32_16x16x32_bf16 v[24:27], v[152:155], v[164:167], v[24:27]
    ds_read_b64_tr_b16 v[188:189], v226 offset:10304
    v_mfma_f32_16x16x32_bf16 v[44:47], v[152:155], v[168:171], v[44:47]
    ds_read_b64_tr_b16 v[190:191], v226 offset:15424
    v_mfma_f32_16x16x32_bf16 v[64:67], v[152:155], v[172:175], v[64:67]
    ds_read_b64_tr_b16 v[192:193], v227 offset:10336
    v_mfma_f32_16x16x32_bf16 v[84:87], v[152:155], v[176:179], v[84:87]
    ds_read_b64_tr_b16 v[194:195], v227 offset:15456
    v_mfma_f32_16x16x32_bf16 v[28:31], v[156:159], v[164:167], v[28:31]
    ds_read_b64_tr_b16 v[196:197], v226 offset:10368
    v_mfma_f32_16x16x32_bf16 v[48:51], v[156:159], v[168:171], v[48:51]
    ds_read_b64_tr_b16 v[198:199], v226 offset:15488
    v_mfma_f32_16x16x32_bf16 v[68:71], v[156:159], v[172:175], v[68:71]
    v_mfma_f32_16x16x32_bf16 v[88:91], v[156:159], v[176:179], v[88:91]
    v_mfma_f32_16x16x32_bf16 v[32:35], v[160:163], v[164:167], v[32:35]
    v_mfma_f32_16x16x32_bf16 v[52:55], v[160:163], v[168:171], v[52:55]
    v_mfma_f32_16x16x32_bf16 v[72:75], v[160:163], v[172:175], v[72:75]
    v_mfma_f32_16x16x32_bf16 v[92:95], v[160:163], v[176:179], v[92:95]
    s_waitcnt lgkmcnt(8)
    v_mfma_f32_16x16x32_bf16 v[16:19], v[180:183], v[200:203], v[16:19]
    v_add_u32 v226, 0xffffb000, v226
    v_add_u32 v227, 0xffffb000, v227
    v_mfma_f32_16x16x32_bf16 v[36:39], v[180:183], v[204:207], v[36:39]
    v_add_u32 v222, 0x4000, v222
    v_add_u32 v223, 0x4000, v223
    v_mfma_f32_16x16x32_bf16 v[56:59], v[180:183], v[208:211], v[56:59]
    v_add_u32 v224, 0x4000, v224
    v_add_u32 v225, 0x4000, v225
    v_mfma_f32_16x16x32_bf16 v[76:79], v[180:183], v[212:215], v[76:79]
    ds_read_b64_tr_b16 v[144:145], v226 offset:0
    s_waitcnt lgkmcnt(1)
    v_mfma_f32_16x16x32_bf16 v[20:23], v[184:187], v[200:203], v[20:23]
    ds_read_b64_tr_b16 v[146:147], v226 offset:5120
    v_mfma_f32_16x16x32_bf16 v[40:43], v[184:187], v[204:207], v[40:43]
    ds_read_b128 v[164:167], v222 offset:0
    v_mfma_f32_16x16x32_bf16 v[60:63], v[184:187], v[208:211], v[60:63]
    ds_read_b128 v[168:171], v223 offset:0
    v_mfma_f32_16x16x32_bf16 v[80:83], v[184:187], v[212:215], v[80:83]
    ds_read_b128 v[172:175], v224 offset:0
    v_mfma_f32_16x16x32_bf16 v[24:27], v[188:191], v[200:203], v[24:27]
    ds_read_b128 v[176:179], v225 offset:0
    v_mfma_f32_16x16x32_bf16 v[44:47], v[188:191], v[204:207], v[44:47]
    ds_read_b64_tr_b16 v[148:149], v227 offset:32
    v_mfma_f32_16x16x32_bf16 v[64:67], v[188:191], v[208:211], v[64:67]
    ds_read_b64_tr_b16 v[150:151], v227 offset:5152
    v_mfma_f32_16x16x32_bf16 v[84:87], v[188:191], v[212:215], v[84:87]
    ds_read_b64_tr_b16 v[152:153], v226 offset:64
    v_mfma_f32_16x16x32_bf16 v[28:31], v[192:195], v[200:203], v[28:31]
    ds_read_b64_tr_b16 v[154:155], v226 offset:5184
    v_mfma_f32_16x16x32_bf16 v[48:51], v[192:195], v[204:207], v[48:51]
    ds_read_b64_tr_b16 v[156:157], v227 offset:96
    v_mfma_f32_16x16x32_bf16 v[68:71], v[192:195], v[208:211], v[68:71]
    ds_read_b64_tr_b16 v[158:159], v227 offset:5216
    v_mfma_f32_16x16x32_bf16 v[88:91], v[192:195], v[212:215], v[88:91]
    ds_read_b64_tr_b16 v[160:161], v226 offset:128
    v_mfma_f32_16x16x32_bf16 v[32:35], v[196:199], v[200:203], v[32:35]
    ds_read_b64_tr_b16 v[162:163], v226 offset:5248
    v_mfma_f32_16x16x32_bf16 v[52:55], v[196:199], v[204:207], v[52:55]
    v_mfma_f32_16x16x32_bf16 v[72:75], v[196:199], v[208:211], v[72:75]
    v_mfma_f32_16x16x32_bf16 v[92:95], v[196:199], v[212:215], v[92:95]
    s_barrier
    s_waitcnt lgkmcnt(8)
    v_mfma_f32_16x16x32_bf16 v[16:19], v[144:147], v[164:167], v[16:19]
    ds_read_b64_tr_b16 v[180:181], v226 offset:10240
    v_mfma_f32_16x16x32_bf16 v[36:39], v[144:147], v[168:171], v[36:39]
    ds_read_b64_tr_b16 v[182:183], v226 offset:15360
    v_mfma_f32_16x16x32_bf16 v[56:59], v[144:147], v[172:175], v[56:59]
    ds_read_b128 v[200:203], v222 offset:8192
    v_mfma_f32_16x16x32_bf16 v[76:79], v[144:147], v[176:179], v[76:79]
    ds_read_b128 v[204:207], v223 offset:8192
    s_waitcnt lgkmcnt(4)
    v_mfma_f32_16x16x32_bf16 v[20:23], v[148:151], v[164:167], v[20:23]
    ds_read_b128 v[208:211], v224 offset:8192
    v_mfma_f32_16x16x32_bf16 v[40:43], v[148:151], v[168:171], v[40:43]
    ds_read_b128 v[212:215], v225 offset:8192
    v_mfma_f32_16x16x32_bf16 v[60:63], v[148:151], v[172:175], v[60:63]
    ds_read_b64_tr_b16 v[184:185], v227 offset:10272
    v_mfma_f32_16x16x32_bf16 v[80:83], v[148:151], v[176:179], v[80:83]
    ds_read_b64_tr_b16 v[186:187], v227 offset:15392
    v_mfma_f32_16x16x32_bf16 v[24:27], v[152:155], v[164:167], v[24:27]
    ds_read_b64_tr_b16 v[188:189], v226 offset:10304
    v_mfma_f32_16x16x32_bf16 v[44:47], v[152:155], v[168:171], v[44:47]
    ds_read_b64_tr_b16 v[190:191], v226 offset:15424
    v_mfma_f32_16x16x32_bf16 v[64:67], v[152:155], v[172:175], v[64:67]
    ds_read_b64_tr_b16 v[192:193], v227 offset:10336
    v_mfma_f32_16x16x32_bf16 v[84:87], v[152:155], v[176:179], v[84:87]
    ds_read_b64_tr_b16 v[194:195], v227 offset:15456
    v_mfma_f32_16x16x32_bf16 v[28:31], v[156:159], v[164:167], v[28:31]
    ds_read_b64_tr_b16 v[196:197], v226 offset:10368
    v_mfma_f32_16x16x32_bf16 v[48:51], v[156:159], v[168:171], v[48:51]
    ds_read_b64_tr_b16 v[198:199], v226 offset:15488
    v_mfma_f32_16x16x32_bf16 v[68:71], v[156:159], v[172:175], v[68:71]
    v_mfma_f32_16x16x32_bf16 v[88:91], v[156:159], v[176:179], v[88:91]
    v_mfma_f32_16x16x32_bf16 v[32:35], v[160:163], v[164:167], v[32:35]
    v_mfma_f32_16x16x32_bf16 v[52:55], v[160:163], v[168:171], v[52:55]
    v_mfma_f32_16x16x32_bf16 v[72:75], v[160:163], v[172:175], v[72:75]
    v_mfma_f32_16x16x32_bf16 v[92:95], v[160:163], v[176:179], v[92:95]
    s_waitcnt lgkmcnt(8)
    v_mfma_f32_16x16x32_bf16 v[16:19], v[180:183], v[200:203], v[16:19]
    v_add_u32 v226, 0xffffb000, v226
    v_add_u32 v227, 0xffffb000, v227
    v_mfma_f32_16x16x32_bf16 v[36:39], v[180:183], v[204:207], v[36:39]
    v_add_u32 v222, 0x4000, v222
    v_add_u32 v223, 0x4000, v223
    v_mfma_f32_16x16x32_bf16 v[56:59], v[180:183], v[208:211], v[56:59]
    v_add_u32 v224, 0x4000, v224
    v_add_u32 v225, 0x4000, v225
    v_mfma_f32_16x16x32_bf16 v[76:79], v[180:183], v[212:215], v[76:79]
    ds_read_b64_tr_b16 v[144:145], v226 offset:0
    s_waitcnt lgkmcnt(1)
    v_mfma_f32_16x16x32_bf16 v[20:23], v[184:187], v[200:203], v[20:23]
    ds_read_b64_tr_b16 v[146:147], v226 offset:5120
    v_mfma_f32_16x16x32_bf16 v[40:43], v[184:187], v[204:207], v[40:43]
    ds_read_b128 v[164:167], v222 offset:0
    v_mfma_f32_16x16x32_bf16 v[60:63], v[184:187], v[208:211], v[60:63]
    ds_read_b128 v[168:171], v223 offset:0
    v_mfma_f32_16x16x32_bf16 v[80:83], v[184:187], v[212:215], v[80:83]
    ds_read_b128 v[172:175], v224 offset:0
    v_mfma_f32_16x16x32_bf16 v[24:27], v[188:191], v[200:203], v[24:27]
    ds_read_b128 v[176:179], v225 offset:0
    v_mfma_f32_16x16x32_bf16 v[44:47], v[188:191], v[204:207], v[44:47]
    ds_read_b64_tr_b16 v[148:149], v227 offset:32
    v_mfma_f32_16x16x32_bf16 v[64:67], v[188:191], v[208:211], v[64:67]
    ds_read_b64_tr_b16 v[150:151], v227 offset:5152
    v_mfma_f32_16x16x32_bf16 v[84:87], v[188:191], v[212:215], v[84:87]
    ds_read_b64_tr_b16 v[152:153], v226 offset:64
    v_mfma_f32_16x16x32_bf16 v[28:31], v[192:195], v[200:203], v[28:31]
    ds_read_b64_tr_b16 v[154:155], v226 offset:5184
    v_mfma_f32_16x16x32_bf16 v[48:51], v[192:195], v[204:207], v[48:51]
    ds_read_b64_tr_b16 v[156:157], v227 offset:96
    v_mfma_f32_16x16x32_bf16 v[68:71], v[192:195], v[208:211], v[68:71]
    ds_read_b64_tr_b16 v[158:159], v227 offset:5216
    v_mfma_f32_16x16x32_bf16 v[88:91], v[192:195], v[212:215], v[88:91]
    ds_read_b64_tr_b16 v[160:161], v226 offset:128
    v_mfma_f32_16x16x32_bf16 v[32:35], v[196:199], v[200:203], v[32:35]
    ds_read_b64_tr_b16 v[162:163], v226 offset:5248
    v_mfma_f32_16x16x32_bf16 v[52:55], v[196:199], v[204:207], v[52:55]
    v_mfma_f32_16x16x32_bf16 v[72:75], v[196:199], v[208:211], v[72:75]
    v_mfma_f32_16x16x32_bf16 v[92:95], v[196:199], v[212:215], v[92:95]
    s_barrier
    s_waitcnt lgkmcnt(8)
    v_mfma_f32_16x16x32_bf16 v[16:19], v[144:147], v[164:167], v[16:19]
    ds_read_b64_tr_b16 v[180:181], v226 offset:10240
    v_mfma_f32_16x16x32_bf16 v[36:39], v[144:147], v[168:171], v[36:39]
    ds_read_b64_tr_b16 v[182:183], v226 offset:15360
    v_mfma_f32_16x16x32_bf16 v[56:59], v[144:147], v[172:175], v[56:59]
    ds_read_b128 v[200:203], v222 offset:8192
    v_mfma_f32_16x16x32_bf16 v[76:79], v[144:147], v[176:179], v[76:79]
    ds_read_b128 v[204:207], v223 offset:8192
    s_waitcnt lgkmcnt(4)
    v_mfma_f32_16x16x32_bf16 v[20:23], v[148:151], v[164:167], v[20:23]
    ds_read_b128 v[208:211], v224 offset:8192
    v_mfma_f32_16x16x32_bf16 v[40:43], v[148:151], v[168:171], v[40:43]
    ds_read_b128 v[212:215], v225 offset:8192
    v_mfma_f32_16x16x32_bf16 v[60:63], v[148:151], v[172:175], v[60:63]
    ds_read_b64_tr_b16 v[184:185], v227 offset:10272
    v_mfma_f32_16x16x32_bf16 v[80:83], v[148:151], v[176:179], v[80:83]
    ds_read_b64_tr_b16 v[186:187], v227 offset:15392
    v_mfma_f32_16x16x32_bf16 v[24:27], v[152:155], v[164:167], v[24:27]
    ds_read_b64_tr_b16 v[188:189], v226 offset:10304
    v_mfma_f32_16x16x32_bf16 v[44:47], v[152:155], v[168:171], v[44:47]
    ds_read_b64_tr_b16 v[190:191], v226 offset:15424
    v_mfma_f32_16x16x32_bf16 v[64:67], v[152:155], v[172:175], v[64:67]
    ds_read_b64_tr_b16 v[192:193], v227 offset:10336
    v_mfma_f32_16x16x32_bf16 v[84:87], v[152:155], v[176:179], v[84:87]
    ds_read_b64_tr_b16 v[194:195], v227 offset:15456
    v_mfma_f32_16x16x32_bf16 v[28:31], v[156:159], v[164:167], v[28:31]
    ds_read_b64_tr_b16 v[196:197], v226 offset:10368
    v_mfma_f32_16x16x32_bf16 v[48:51], v[156:159], v[168:171], v[48:51]
    ds_read_b64_tr_b16 v[198:199], v226 offset:15488
    v_mfma_f32_16x16x32_bf16 v[68:71], v[156:159], v[172:175], v[68:71]
    v_mfma_f32_16x16x32_bf16 v[88:91], v[156:159], v[176:179], v[88:91]
    v_mfma_f32_16x16x32_bf16 v[32:35], v[160:163], v[164:167], v[32:35]
    v_mfma_f32_16x16x32_bf16 v[52:55], v[160:163], v[168:171], v[52:55]
    v_mfma_f32_16x16x32_bf16 v[72:75], v[160:163], v[172:175], v[72:75]
    v_mfma_f32_16x16x32_bf16 v[92:95], v[160:163], v[176:179], v[92:95]
    s_waitcnt lgkmcnt(8)
    v_mfma_f32_16x16x32_bf16 v[16:19], v[180:183], v[200:203], v[16:19]
    v_add_u32 v226, 0xf000, v226
    v_add_u32 v227, 0xf000, v227
    v_mfma_f32_16x16x32_bf16 v[36:39], v[180:183], v[204:207], v[36:39]
    v_add_u32 v222, 0x1c000, v222
    v_add_u32 v223, 0x1c000, v223
    v_mfma_f32_16x16x32_bf16 v[56:59], v[180:183], v[208:211], v[56:59]
    v_add_u32 v224, 0x1c000, v224
    v_add_u32 v225, 0x1c000, v225
    v_mfma_f32_16x16x32_bf16 v[76:79], v[180:183], v[212:215], v[76:79]
    ds_read_b64_tr_b16 v[144:145], v226 offset:0
    s_waitcnt lgkmcnt(1)
    v_mfma_f32_16x16x32_bf16 v[20:23], v[184:187], v[200:203], v[20:23]
    ds_read_b64_tr_b16 v[146:147], v226 offset:5120
    v_mfma_f32_16x16x32_bf16 v[40:43], v[184:187], v[204:207], v[40:43]
    ds_read_b128 v[164:167], v222 offset:0
    v_mfma_f32_16x16x32_bf16 v[60:63], v[184:187], v[208:211], v[60:63]
    ds_read_b128 v[168:171], v223 offset:0
    v_mfma_f32_16x16x32_bf16 v[80:83], v[184:187], v[212:215], v[80:83]
    ds_read_b128 v[172:175], v224 offset:0
    v_mfma_f32_16x16x32_bf16 v[24:27], v[188:191], v[200:203], v[24:27]
    ds_read_b128 v[176:179], v225 offset:0
    v_mfma_f32_16x16x32_bf16 v[44:47], v[188:191], v[204:207], v[44:47]
    ds_read_b64_tr_b16 v[148:149], v227 offset:32
    v_mfma_f32_16x16x32_bf16 v[64:67], v[188:191], v[208:211], v[64:67]
    ds_read_b64_tr_b16 v[150:151], v227 offset:5152
    v_mfma_f32_16x16x32_bf16 v[84:87], v[188:191], v[212:215], v[84:87]
    ds_read_b64_tr_b16 v[152:153], v226 offset:64
    v_mfma_f32_16x16x32_bf16 v[28:31], v[192:195], v[200:203], v[28:31]
    ds_read_b64_tr_b16 v[154:155], v226 offset:5184
    v_mfma_f32_16x16x32_bf16 v[48:51], v[192:195], v[204:207], v[48:51]
    ds_read_b64_tr_b16 v[156:157], v227 offset:96
    v_mfma_f32_16x16x32_bf16 v[68:71], v[192:195], v[208:211], v[68:71]
    ds_read_b64_tr_b16 v[158:159], v227 offset:5216
    v_mfma_f32_16x16x32_bf16 v[88:91], v[192:195], v[212:215], v[88:91]
    ds_read_b64_tr_b16 v[160:161], v226 offset:128
    v_mfma_f32_16x16x32_bf16 v[32:35], v[196:199], v[200:203], v[32:35]
    ds_read_b64_tr_b16 v[162:163], v226 offset:5248
    v_mfma_f32_16x16x32_bf16 v[52:55], v[196:199], v[204:207], v[52:55]
    v_mfma_f32_16x16x32_bf16 v[72:75], v[196:199], v[208:211], v[72:75]
    v_mfma_f32_16x16x32_bf16 v[92:95], v[196:199], v[212:215], v[92:95]
    s_barrier
    s_waitcnt lgkmcnt(8)
    v_mfma_f32_16x16x32_bf16 v[16:19], v[144:147], v[164:167], v[16:19]
    ds_read_b64_tr_b16 v[180:181], v226 offset:10240
    v_mfma_f32_16x16x32_bf16 v[36:39], v[144:147], v[168:171], v[36:39]
    ds_read_b64_tr_b16 v[182:183], v226 offset:15360
    v_mfma_f32_16x16x32_bf16 v[56:59], v[144:147], v[172:175], v[56:59]
    ds_read_b128 v[200:203], v222 offset:8192
    v_mfma_f32_16x16x32_bf16 v[76:79], v[144:147], v[176:179], v[76:79]
    ds_read_b128 v[204:207], v223 offset:8192
    s_waitcnt lgkmcnt(4)
    v_mfma_f32_16x16x32_bf16 v[20:23], v[148:151], v[164:167], v[20:23]
    ds_read_b128 v[208:211], v224 offset:8192
    v_mfma_f32_16x16x32_bf16 v[40:43], v[148:151], v[168:171], v[40:43]
    ds_read_b128 v[212:215], v225 offset:8192
    v_mfma_f32_16x16x32_bf16 v[60:63], v[148:151], v[172:175], v[60:63]
    ds_read_b64_tr_b16 v[184:185], v227 offset:10272
    v_mfma_f32_16x16x32_bf16 v[80:83], v[148:151], v[176:179], v[80:83]
    ds_read_b64_tr_b16 v[186:187], v227 offset:15392
    v_mfma_f32_16x16x32_bf16 v[24:27], v[152:155], v[164:167], v[24:27]
    ds_read_b64_tr_b16 v[188:189], v226 offset:10304
    v_mfma_f32_16x16x32_bf16 v[44:47], v[152:155], v[168:171], v[44:47]
    ds_read_b64_tr_b16 v[190:191], v226 offset:15424
    v_mfma_f32_16x16x32_bf16 v[64:67], v[152:155], v[172:175], v[64:67]
    ds_read_b64_tr_b16 v[192:193], v227 offset:10336
    v_mfma_f32_16x16x32_bf16 v[84:87], v[152:155], v[176:179], v[84:87]
    ds_read_b64_tr_b16 v[194:195], v227 offset:15456
    v_mfma_f32_16x16x32_bf16 v[28:31], v[156:159], v[164:167], v[28:31]
    ds_read_b64_tr_b16 v[196:197], v226 offset:10368
    v_mfma_f32_16x16x32_bf16 v[48:51], v[156:159], v[168:171], v[48:51]
    ds_read_b64_tr_b16 v[198:199], v226 offset:15488
    v_mfma_f32_16x16x32_bf16 v[68:71], v[156:159], v[172:175], v[68:71]
    v_mfma_f32_16x16x32_bf16 v[88:91], v[156:159], v[176:179], v[88:91]
    v_mfma_f32_16x16x32_bf16 v[32:35], v[160:163], v[164:167], v[32:35]
    v_mfma_f32_16x16x32_bf16 v[52:55], v[160:163], v[168:171], v[52:55]
    v_mfma_f32_16x16x32_bf16 v[72:75], v[160:163], v[172:175], v[72:75]
    v_mfma_f32_16x16x32_bf16 v[92:95], v[160:163], v[176:179], v[92:95]
    s_waitcnt lgkmcnt(8)
    v_mfma_f32_16x16x32_bf16 v[16:19], v[180:183], v[200:203], v[16:19]
    v_add_u32 v226, 0xffffb000, v226
    v_add_u32 v227, 0xffffb000, v227
    v_mfma_f32_16x16x32_bf16 v[36:39], v[180:183], v[204:207], v[36:39]
    v_add_u32 v222, 0xfffdc000, v222
    v_add_u32 v223, 0xfffdc000, v223
    v_mfma_f32_16x16x32_bf16 v[56:59], v[180:183], v[208:211], v[56:59]
    v_add_u32 v224, 0xfffdc000, v224
    v_add_u32 v225, 0xfffdc000, v225
    v_mfma_f32_16x16x32_bf16 v[76:79], v[180:183], v[212:215], v[76:79]
    ds_read_b64_tr_b16 v[144:145], v226 offset:0
    s_waitcnt lgkmcnt(1)
    v_mfma_f32_16x16x32_bf16 v[20:23], v[184:187], v[200:203], v[20:23]
    ds_read_b64_tr_b16 v[146:147], v226 offset:5120
    v_mfma_f32_16x16x32_bf16 v[40:43], v[184:187], v[204:207], v[40:43]
    ds_read_b128 v[168:171], v223 offset:0
    v_mfma_f32_16x16x32_bf16 v[60:63], v[184:187], v[208:211], v[60:63]
    ds_read_b128 v[172:175], v224 offset:0
    v_mfma_f32_16x16x32_bf16 v[80:83], v[184:187], v[212:215], v[80:83]
    ds_read_b128 v[176:179], v225 offset:0
    v_mfma_f32_16x16x32_bf16 v[24:27], v[188:191], v[200:203], v[24:27]
    ds_read_b64_tr_b16 v[148:149], v227 offset:32
    v_mfma_f32_16x16x32_bf16 v[44:47], v[188:191], v[204:207], v[44:47]
    ds_read_b64_tr_b16 v[150:151], v227 offset:5152
    v_mfma_f32_16x16x32_bf16 v[64:67], v[188:191], v[208:211], v[64:67]
    ds_read_b64_tr_b16 v[152:153], v226 offset:64
    v_mfma_f32_16x16x32_bf16 v[84:87], v[188:191], v[212:215], v[84:87]
    ds_read_b64_tr_b16 v[154:155], v226 offset:5184
    v_mfma_f32_16x16x32_bf16 v[28:31], v[192:195], v[200:203], v[28:31]
    ds_read_b64_tr_b16 v[156:157], v227 offset:96
    v_mfma_f32_16x16x32_bf16 v[48:51], v[192:195], v[204:207], v[48:51]
    ds_read_b64_tr_b16 v[158:159], v227 offset:5216
    v_mfma_f32_16x16x32_bf16 v[68:71], v[192:195], v[208:211], v[68:71]
    ds_read_b64_tr_b16 v[160:161], v226 offset:128
    v_mfma_f32_16x16x32_bf16 v[88:91], v[192:195], v[212:215], v[88:91]
    ds_read_b64_tr_b16 v[162:163], v226 offset:5248
    v_mfma_f32_16x16x32_bf16 v[32:35], v[196:199], v[200:203], v[32:35]
    v_mfma_f32_16x16x32_bf16 v[52:55], v[196:199], v[204:207], v[52:55]
    v_mfma_f32_16x16x32_bf16 v[72:75], v[196:199], v[208:211], v[72:75]
    v_mfma_f32_16x16x32_bf16 v[92:95], v[196:199], v[212:215], v[92:95]
    s_barrier
    s_waitcnt lgkmcnt(8)
    v_mfma_f32_16x16x32_bf16 v[36:39], v[144:147], v[168:171], v[36:39]
    ds_read_b64_tr_b16 v[180:181], v226 offset:10240
    ds_read_b64_tr_b16 v[182:183], v226 offset:15360
    v_mfma_f32_16x16x32_bf16 v[56:59], v[144:147], v[172:175], v[56:59]
    ds_read_b128 v[204:207], v223 offset:8192
    v_mfma_f32_16x16x32_bf16 v[76:79], v[144:147], v[176:179], v[76:79]
    ds_read_b128 v[208:211], v224 offset:8192
    s_waitcnt lgkmcnt(4)
    v_mfma_f32_16x16x32_bf16 v[40:43], v[148:151], v[168:171], v[40:43]
    ds_read_b128 v[212:215], v225 offset:8192
    v_mfma_f32_16x16x32_bf16 v[60:63], v[148:151], v[172:175], v[60:63]
    ds_read_b64_tr_b16 v[184:185], v227 offset:10272
    v_mfma_f32_16x16x32_bf16 v[80:83], v[148:151], v[176:179], v[80:83]
    ds_read_b64_tr_b16 v[186:187], v227 offset:15392
    v_mfma_f32_16x16x32_bf16 v[44:47], v[152:155], v[168:171], v[44:47]
    ds_read_b64_tr_b16 v[188:189], v226 offset:10304
    v_mfma_f32_16x16x32_bf16 v[64:67], v[152:155], v[172:175], v[64:67]
    ds_read_b64_tr_b16 v[190:191], v226 offset:15424
    v_mfma_f32_16x16x32_bf16 v[84:87], v[152:155], v[176:179], v[84:87]
    ds_read_b64_tr_b16 v[192:193], v227 offset:10336
    v_mfma_f32_16x16x32_bf16 v[48:51], v[156:159], v[168:171], v[48:51]
    ds_read_b64_tr_b16 v[194:195], v227 offset:15456
    v_mfma_f32_16x16x32_bf16 v[68:71], v[156:159], v[172:175], v[68:71]
    ds_read_b64_tr_b16 v[196:197], v226 offset:10368
    v_mfma_f32_16x16x32_bf16 v[88:91], v[156:159], v[176:179], v[88:91]
    ds_read_b64_tr_b16 v[198:199], v226 offset:15488
    v_mfma_f32_16x16x32_bf16 v[52:55], v[160:163], v[168:171], v[52:55]
    v_mfma_f32_16x16x32_bf16 v[72:75], v[160:163], v[172:175], v[72:75]
    v_mfma_f32_16x16x32_bf16 v[92:95], v[160:163], v[176:179], v[92:95]
    s_waitcnt lgkmcnt(8)
    v_mfma_f32_16x16x32_bf16 v[36:39], v[180:183], v[204:207], v[36:39]
    v_add_u32 v226, 0xffffb000, v226
    v_add_u32 v227, 0xffffb000, v227
    v_mfma_f32_16x16x32_bf16 v[56:59], v[180:183], v[208:211], v[56:59]
    v_add_u32 v222, 0x4000, v222
    v_add_u32 v223, 0x4000, v223
    v_mfma_f32_16x16x32_bf16 v[76:79], v[180:183], v[212:215], v[76:79]
    v_add_u32 v224, 0x4000, v224
    v_add_u32 v225, 0x4000, v225
    s_waitcnt lgkmcnt(0)
    v_mfma_f32_16x16x32_bf16 v[40:43], v[184:187], v[204:207], v[40:43]
    ds_read_b64_tr_b16 v[144:145], v226 offset:0
    ds_read_b64_tr_b16 v[146:147], v226 offset:5120
    v_mfma_f32_16x16x32_bf16 v[60:63], v[184:187], v[208:211], v[60:63]
    ds_read_b128 v[168:171], v223 offset:0
    ds_read_b128 v[172:175], v224 offset:0
    v_mfma_f32_16x16x32_bf16 v[80:83], v[184:187], v[212:215], v[80:83]
    ds_read_b128 v[176:179], v225 offset:0
    ds_read_b64_tr_b16 v[148:149], v227 offset:32
    v_mfma_f32_16x16x32_bf16 v[44:47], v[188:191], v[204:207], v[44:47]
    ds_read_b64_tr_b16 v[150:151], v227 offset:5152
    ds_read_b64_tr_b16 v[152:153], v226 offset:64
    v_mfma_f32_16x16x32_bf16 v[64:67], v[188:191], v[208:211], v[64:67]
    ds_read_b64_tr_b16 v[154:155], v226 offset:5184
    v_mfma_f32_16x16x32_bf16 v[84:87], v[188:191], v[212:215], v[84:87]
    ds_read_b64_tr_b16 v[156:157], v227 offset:96
    v_mfma_f32_16x16x32_bf16 v[48:51], v[192:195], v[204:207], v[48:51]
    ds_read_b64_tr_b16 v[158:159], v227 offset:5216
    v_mfma_f32_16x16x32_bf16 v[68:71], v[192:195], v[208:211], v[68:71]
    ds_read_b64_tr_b16 v[160:161], v226 offset:128
    v_mfma_f32_16x16x32_bf16 v[88:91], v[192:195], v[212:215], v[88:91]
    ds_read_b64_tr_b16 v[162:163], v226 offset:5248
    v_mfma_f32_16x16x32_bf16 v[52:55], v[196:199], v[204:207], v[52:55]
    v_mfma_f32_16x16x32_bf16 v[72:75], v[196:199], v[208:211], v[72:75]
    v_mfma_f32_16x16x32_bf16 v[92:95], v[196:199], v[212:215], v[92:95]
    s_barrier
    s_waitcnt lgkmcnt(8)
    v_mfma_f32_16x16x32_bf16 v[36:39], v[144:147], v[168:171], v[36:39]
    ds_read_b64_tr_b16 v[180:181], v226 offset:10240
    ds_read_b64_tr_b16 v[182:183], v226 offset:15360
    v_mfma_f32_16x16x32_bf16 v[56:59], v[144:147], v[172:175], v[56:59]
    ds_read_b128 v[204:207], v223 offset:8192
    v_mfma_f32_16x16x32_bf16 v[76:79], v[144:147], v[176:179], v[76:79]
    ds_read_b128 v[208:211], v224 offset:8192
    s_waitcnt lgkmcnt(4)
    v_mfma_f32_16x16x32_bf16 v[40:43], v[148:151], v[168:171], v[40:43]
    ds_read_b128 v[212:215], v225 offset:8192
    v_mfma_f32_16x16x32_bf16 v[60:63], v[148:151], v[172:175], v[60:63]
    ds_read_b64_tr_b16 v[184:185], v227 offset:10272
    v_mfma_f32_16x16x32_bf16 v[80:83], v[148:151], v[176:179], v[80:83]
    ds_read_b64_tr_b16 v[186:187], v227 offset:15392
    v_mfma_f32_16x16x32_bf16 v[44:47], v[152:155], v[168:171], v[44:47]
    ds_read_b64_tr_b16 v[188:189], v226 offset:10304
    v_mfma_f32_16x16x32_bf16 v[64:67], v[152:155], v[172:175], v[64:67]
    ds_read_b64_tr_b16 v[190:191], v226 offset:15424
    v_mfma_f32_16x16x32_bf16 v[84:87], v[152:155], v[176:179], v[84:87]
    ds_read_b64_tr_b16 v[192:193], v227 offset:10336
    v_mfma_f32_16x16x32_bf16 v[48:51], v[156:159], v[168:171], v[48:51]
    ds_read_b64_tr_b16 v[194:195], v227 offset:15456
    v_mfma_f32_16x16x32_bf16 v[68:71], v[156:159], v[172:175], v[68:71]
    ds_read_b64_tr_b16 v[196:197], v226 offset:10368
    v_mfma_f32_16x16x32_bf16 v[88:91], v[156:159], v[176:179], v[88:91]
    ds_read_b64_tr_b16 v[198:199], v226 offset:15488
    v_mfma_f32_16x16x32_bf16 v[52:55], v[160:163], v[168:171], v[52:55]
    v_mfma_f32_16x16x32_bf16 v[72:75], v[160:163], v[172:175], v[72:75]
    v_mfma_f32_16x16x32_bf16 v[92:95], v[160:163], v[176:179], v[92:95]
    s_waitcnt lgkmcnt(8)
    v_mfma_f32_16x16x32_bf16 v[36:39], v[180:183], v[204:207], v[36:39]
    v_add_u32 v226, 0xffffb000, v226
    v_add_u32 v227, 0xffffb000, v227
    v_mfma_f32_16x16x32_bf16 v[56:59], v[180:183], v[208:211], v[56:59]
    v_add_u32 v222, 0x4000, v222
    v_add_u32 v223, 0x4000, v223
    v_mfma_f32_16x16x32_bf16 v[76:79], v[180:183], v[212:215], v[76:79]
    v_add_u32 v224, 0x4000, v224
    v_add_u32 v225, 0x4000, v225
    s_waitcnt lgkmcnt(0)
    v_mfma_f32_16x16x32_bf16 v[40:43], v[184:187], v[204:207], v[40:43]
    ds_read_b64_tr_b16 v[144:145], v226 offset:0
    ds_read_b64_tr_b16 v[146:147], v226 offset:5120
    v_mfma_f32_16x16x32_bf16 v[60:63], v[184:187], v[208:211], v[60:63]
    ds_read_b128 v[168:171], v223 offset:0
    ds_read_b128 v[172:175], v224 offset:0
    v_mfma_f32_16x16x32_bf16 v[80:83], v[184:187], v[212:215], v[80:83]
    ds_read_b128 v[176:179], v225 offset:0
    ds_read_b64_tr_b16 v[148:149], v227 offset:32
    v_mfma_f32_16x16x32_bf16 v[44:47], v[188:191], v[204:207], v[44:47]
    ds_read_b64_tr_b16 v[150:151], v227 offset:5152
    ds_read_b64_tr_b16 v[152:153], v226 offset:64
    v_mfma_f32_16x16x32_bf16 v[64:67], v[188:191], v[208:211], v[64:67]
    ds_read_b64_tr_b16 v[154:155], v226 offset:5184
    v_mfma_f32_16x16x32_bf16 v[84:87], v[188:191], v[212:215], v[84:87]
    ds_read_b64_tr_b16 v[156:157], v227 offset:96
    v_mfma_f32_16x16x32_bf16 v[48:51], v[192:195], v[204:207], v[48:51]
    ds_read_b64_tr_b16 v[158:159], v227 offset:5216
    v_mfma_f32_16x16x32_bf16 v[68:71], v[192:195], v[208:211], v[68:71]
    ds_read_b64_tr_b16 v[160:161], v226 offset:128
    v_mfma_f32_16x16x32_bf16 v[88:91], v[192:195], v[212:215], v[88:91]
    ds_read_b64_tr_b16 v[162:163], v226 offset:5248
    v_mfma_f32_16x16x32_bf16 v[52:55], v[196:199], v[204:207], v[52:55]
    v_mfma_f32_16x16x32_bf16 v[72:75], v[196:199], v[208:211], v[72:75]
    v_mfma_f32_16x16x32_bf16 v[92:95], v[196:199], v[212:215], v[92:95]
    s_barrier
    s_waitcnt lgkmcnt(8)
    v_mfma_f32_16x16x32_bf16 v[36:39], v[144:147], v[168:171], v[36:39]
    ds_read_b64_tr_b16 v[180:181], v226 offset:10240
    ds_read_b64_tr_b16 v[182:183], v226 offset:15360
    v_mfma_f32_16x16x32_bf16 v[56:59], v[144:147], v[172:175], v[56:59]
    ds_read_b128 v[204:207], v223 offset:8192
    v_mfma_f32_16x16x32_bf16 v[76:79], v[144:147], v[176:179], v[76:79]
    ds_read_b128 v[208:211], v224 offset:8192
    s_waitcnt lgkmcnt(4)
    v_mfma_f32_16x16x32_bf16 v[40:43], v[148:151], v[168:171], v[40:43]
    ds_read_b128 v[212:215], v225 offset:8192
    v_mfma_f32_16x16x32_bf16 v[60:63], v[148:151], v[172:175], v[60:63]
    ds_read_b64_tr_b16 v[184:185], v227 offset:10272
    v_mfma_f32_16x16x32_bf16 v[80:83], v[148:151], v[176:179], v[80:83]
    ds_read_b64_tr_b16 v[186:187], v227 offset:15392
    v_mfma_f32_16x16x32_bf16 v[44:47], v[152:155], v[168:171], v[44:47]
    ds_read_b64_tr_b16 v[188:189], v226 offset:10304
    v_mfma_f32_16x16x32_bf16 v[64:67], v[152:155], v[172:175], v[64:67]
    ds_read_b64_tr_b16 v[190:191], v226 offset:15424
    v_mfma_f32_16x16x32_bf16 v[84:87], v[152:155], v[176:179], v[84:87]
    ds_read_b64_tr_b16 v[192:193], v227 offset:10336
    v_mfma_f32_16x16x32_bf16 v[48:51], v[156:159], v[168:171], v[48:51]
    ds_read_b64_tr_b16 v[194:195], v227 offset:15456
    v_mfma_f32_16x16x32_bf16 v[68:71], v[156:159], v[172:175], v[68:71]
    ds_read_b64_tr_b16 v[196:197], v226 offset:10368
    v_mfma_f32_16x16x32_bf16 v[88:91], v[156:159], v[176:179], v[88:91]
    ds_read_b64_tr_b16 v[198:199], v226 offset:15488
    v_mfma_f32_16x16x32_bf16 v[52:55], v[160:163], v[168:171], v[52:55]
    v_mfma_f32_16x16x32_bf16 v[72:75], v[160:163], v[172:175], v[72:75]
    v_mfma_f32_16x16x32_bf16 v[92:95], v[160:163], v[176:179], v[92:95]
    s_waitcnt lgkmcnt(8)
    v_mfma_f32_16x16x32_bf16 v[36:39], v[180:183], v[204:207], v[36:39]
    v_add_u32 v226, 0xa000, v226
    v_add_u32 v227, 0xa000, v227
    v_mfma_f32_16x16x32_bf16 v[56:59], v[180:183], v[208:211], v[56:59]
    v_add_u32 v222, 0xffff8000, v222
    v_add_u32 v223, 0xffff8000, v223
    v_mfma_f32_16x16x32_bf16 v[76:79], v[180:183], v[212:215], v[76:79]
    v_add_u32 v224, 0xffff8000, v224
    v_add_u32 v225, 0xffff8000, v225
    s_waitcnt lgkmcnt(0)
    v_mfma_f32_16x16x32_bf16 v[40:43], v[184:187], v[204:207], v[40:43]
    ds_read_b64_tr_b16 v[144:145], v226 offset:0
    ds_read_b64_tr_b16 v[146:147], v226 offset:5120
    v_mfma_f32_16x16x32_bf16 v[60:63], v[184:187], v[208:211], v[60:63]
    ds_read_b128 v[164:167], v222 offset:0
    ds_read_b64_tr_b16 v[148:149], v227 offset:32
    v_mfma_f32_16x16x32_bf16 v[80:83], v[184:187], v[212:215], v[80:83]
    ds_read_b64_tr_b16 v[150:151], v227 offset:5152
    v_mfma_f32_16x16x32_bf16 v[44:47], v[188:191], v[204:207], v[44:47]
    ds_read_b64_tr_b16 v[152:153], v226 offset:64
    v_mfma_f32_16x16x32_bf16 v[64:67], v[188:191], v[208:211], v[64:67]
    ds_read_b64_tr_b16 v[154:155], v226 offset:5184
    v_mfma_f32_16x16x32_bf16 v[84:87], v[188:191], v[212:215], v[84:87]
    ds_read_b64_tr_b16 v[156:157], v227 offset:96
    v_mfma_f32_16x16x32_bf16 v[48:51], v[192:195], v[204:207], v[48:51]
    ds_read_b64_tr_b16 v[158:159], v227 offset:5216
    v_mfma_f32_16x16x32_bf16 v[68:71], v[192:195], v[208:211], v[68:71]
    ds_read_b64_tr_b16 v[160:161], v226 offset:128
    v_mfma_f32_16x16x32_bf16 v[88:91], v[192:195], v[212:215], v[88:91]
    ds_read_b64_tr_b16 v[162:163], v226 offset:5248
    v_mfma_f32_16x16x32_bf16 v[52:55], v[196:199], v[204:207], v[52:55]
    v_mfma_f32_16x16x32_bf16 v[72:75], v[196:199], v[208:211], v[72:75]
    v_mfma_f32_16x16x32_bf16 v[92:95], v[196:199], v[212:215], v[92:95]
    v_cvt_pk_bf16_f32 v96, v36, v37
    v_cvt_pk_bf16_f32 v97, v38, v39
    v_cvt_pk_bf16_f32 v98, v40, v41
    v_cvt_pk_bf16_f32 v99, v42, v43
    buffer_store_dwordx4 v[96:99], v221, s[20:23], s60 offen offset:0 sc1
    v_cvt_pk_bf16_f32 v100, v44, v45
    v_cvt_pk_bf16_f32 v101, v46, v47
    v_cvt_pk_bf16_f32 v102, v48, v49
    v_cvt_pk_bf16_f32 v103, v50, v51
    buffer_store_dwordx4 v[100:103], v221, s[20:23], s60 offen offset:1024 sc1
    v_cvt_pk_bf16_f32 v104, v52, v53
    v_cvt_pk_bf16_f32 v105, v54, v55
    buffer_store_dwordx2 v[104:105], v241, s[20:23], s60 offen offset:2048 sc1
    v_cvt_pk_bf16_f32 v108, v56, v57
    v_cvt_pk_bf16_f32 v109, v58, v59
    v_cvt_pk_bf16_f32 v110, v60, v61
    v_cvt_pk_bf16_f32 v111, v62, v63
    buffer_store_dwordx4 v[108:111], v221, s[20:23], s61 offen offset:0 sc1
    v_cvt_pk_bf16_f32 v112, v64, v65
    v_cvt_pk_bf16_f32 v113, v66, v67
    v_cvt_pk_bf16_f32 v114, v68, v69
    v_cvt_pk_bf16_f32 v115, v70, v71
    buffer_store_dwordx4 v[112:115], v221, s[20:23], s61 offen offset:1024 sc1
    v_cvt_pk_bf16_f32 v116, v72, v73
    v_cvt_pk_bf16_f32 v117, v74, v75
    buffer_store_dwordx2 v[116:117], v241, s[20:23], s61 offen offset:2048 sc1
    v_cvt_pk_bf16_f32 v120, v76, v77
    v_cvt_pk_bf16_f32 v121, v78, v79
    v_cvt_pk_bf16_f32 v122, v80, v81
    v_cvt_pk_bf16_f32 v123, v82, v83
    buffer_store_dwordx4 v[120:123], v221, s[20:23], s56 offen offset:0 sc1
    v_cvt_pk_bf16_f32 v124, v84, v85
    v_cvt_pk_bf16_f32 v125, v86, v87
    v_cvt_pk_bf16_f32 v126, v88, v89
    v_cvt_pk_bf16_f32 v127, v90, v91
    buffer_store_dwordx4 v[124:127], v221, s[20:23], s56 offen offset:1024 sc1
    v_cvt_pk_bf16_f32 v128, v92, v93
    v_cvt_pk_bf16_f32 v129, v94, v95
    buffer_store_dwordx2 v[128:129], v241, s[20:23], s56 offen offset:2048 sc1
    s_waitcnt lgkmcnt(8)
    v_mfma_f32_16x16x32_bf16 v[16:19], v[144:147], v[164:167], v[16:19]
    ds_read_b64_tr_b16 v[180:181], v226 offset:10240
    ds_read_b64_tr_b16 v[182:183], v226 offset:15360
    ds_read_b128 v[200:203], v222 offset:8192
    ds_read_b64_tr_b16 v[184:185], v227 offset:10272
    s_waitcnt lgkmcnt(10)
    v_mfma_f32_16x16x32_bf16 v[20:23], v[148:151], v[164:167], v[20:23]
    ds_read_b64_tr_b16 v[186:187], v227 offset:15392
    ds_read_b64_tr_b16 v[188:189], v226 offset:10304
    ds_read_b64_tr_b16 v[190:191], v226 offset:15424
    ds_read_b64_tr_b16 v[192:193], v227 offset:10336
    s_waitcnt lgkmcnt(12)
    v_mfma_f32_16x16x32_bf16 v[24:27], v[152:155], v[164:167], v[24:27]
    ds_read_b64_tr_b16 v[194:195], v227 offset:15456
    ds_read_b64_tr_b16 v[196:197], v226 offset:10368
    ds_read_b64_tr_b16 v[198:199], v226 offset:15488
    s_waitcnt lgkmcnt(13)
    v_mfma_f32_16x16x32_bf16 v[28:31], v[156:159], v[164:167], v[28:31]
    s_waitcnt lgkmcnt(11)
    v_mfma_f32_16x16x32_bf16 v[32:35], v[160:163], v[164:167], v[32:35]
    s_waitcnt lgkmcnt(8)
    v_mfma_f32_16x16x32_bf16 v[16:19], v[180:183], v[200:203], v[16:19]
    v_add_u32 v226, 0xffffb000, v226
    v_add_u32 v227, 0xffffb000, v227
    v_add_u32 v222, 0x4000, v222
    v_add_u32 v223, 0x4000, v223
    v_add_u32 v224, 0x4000, v224
    v_add_u32 v225, 0x4000, v225
    s_waitcnt lgkmcnt(6)
    v_mfma_f32_16x16x32_bf16 v[20:23], v[184:187], v[200:203], v[20:23]
    ds_read_b64_tr_b16 v[144:145], v226 offset:0
    ds_read_b64_tr_b16 v[146:147], v226 offset:5120
    ds_read_b128 v[164:167], v222 offset:0
    ds_read_b64_tr_b16 v[148:149], v227 offset:32
    s_waitcnt lgkmcnt(8)
    v_mfma_f32_16x16x32_bf16 v[24:27], v[188:191], v[200:203], v[24:27]
    ds_read_b64_tr_b16 v[150:151], v227 offset:5152
    ds_read_b64_tr_b16 v[152:153], v226 offset:64
    ds_read_b64_tr_b16 v[154:155], v226 offset:5184
    ds_read_b64_tr_b16 v[156:157], v227 offset:96
    s_waitcnt lgkmcnt(10)
    v_mfma_f32_16x16x32_bf16 v[28:31], v[192:195], v[200:203], v[28:31]
    ds_read_b64_tr_b16 v[158:159], v227 offset:5216
    ds_read_b64_tr_b16 v[160:161], v226 offset:128
    ds_read_b64_tr_b16 v[162:163], v226 offset:5248
    s_waitcnt lgkmcnt(11)
    v_mfma_f32_16x16x32_bf16 v[32:35], v[196:199], v[200:203], v[32:35]
    s_waitcnt lgkmcnt(8)
    v_mfma_f32_16x16x32_bf16 v[16:19], v[144:147], v[164:167], v[16:19]
    ds_read_b64_tr_b16 v[180:181], v226 offset:10240
    ds_read_b64_tr_b16 v[182:183], v226 offset:15360
    ds_read_b128 v[200:203], v222 offset:8192
    ds_read_b64_tr_b16 v[184:185], v227 offset:10272
    s_waitcnt lgkmcnt(10)
    v_mfma_f32_16x16x32_bf16 v[20:23], v[148:151], v[164:167], v[20:23]
    ds_read_b64_tr_b16 v[186:187], v227 offset:15392
    ds_read_b64_tr_b16 v[188:189], v226 offset:10304
    ds_read_b64_tr_b16 v[190:191], v226 offset:15424
    ds_read_b64_tr_b16 v[192:193], v227 offset:10336
    s_waitcnt lgkmcnt(12)
    v_mfma_f32_16x16x32_bf16 v[24:27], v[152:155], v[164:167], v[24:27]
    ds_read_b64_tr_b16 v[194:195], v227 offset:15456
    ds_read_b64_tr_b16 v[196:197], v226 offset:10368
    ds_read_b64_tr_b16 v[198:199], v226 offset:15488
    s_waitcnt lgkmcnt(13)
    v_mfma_f32_16x16x32_bf16 v[28:31], v[156:159], v[164:167], v[28:31]
    s_waitcnt lgkmcnt(11)
    v_mfma_f32_16x16x32_bf16 v[32:35], v[160:163], v[164:167], v[32:35]
    s_waitcnt vmcnt(0)
    v_mov_b32 v14, 1
    v_mov_b32 v15, 0
    s_mov_b64 s[90:91], exec
    s_mov_b64 exec, 1
    buffer_store_dword v14, v15, s[20:23], s98 offen sc1
    buffer_store_dword v14, v15, s[20:23], s99 offen sc1
    buffer_store_dword v14, v15, s[20:23], s100 offen sc1
    s_mov_b64 exec, s[90:91]
L_fx:
    buffer_load_dword v228, v240, s[20:23], s86 offen sc1
    s_waitcnt lgkmcnt(8)
    v_mfma_f32_16x16x32_bf16 v[16:19], v[180:183], v[200:203], v[16:19]
    v_add_u32 v226, 0xffffb000, v226
    v_add_u32 v227, 0xffffb000, v227
    v_add_u32 v222, 0x4000, v222
    v_add_u32 v223, 0x4000, v223
    v_add_u32 v224, 0x4000, v224
    v_add_u32 v225, 0x4000, v225
    s_waitcnt lgkmcnt(6)
    v_mfma_f32_16x16x32_bf16 v[20:23], v[184:187], v[200:203], v[20:23]
    ds_read_b64_tr_b16 v[144:145], v226 offset:0
    ds_read_b64_tr_b16 v[146:147], v226 offset:5120
    ds_read_b128 v[164:167], v222 offset:0
    ds_read_b64_tr_b16 v[148:149], v227 offset:32
    s_waitcnt lgkmcnt(8)
    v_mfma_f32_16x16x32_bf16 v[24:27], v[188:191], v[200:203], v[24:27]
    ds_read_b64_tr_b16 v[150:151], v227 offset:5152
    ds_read_b64_tr_b16 v[152:153], v226 offset:64
    ds_read_b64_tr_b16 v[154:155], v226 offset:5184
    ds_read_b64_tr_b16 v[156:157], v227 offset:96
    s_waitcnt lgkmcnt(10)
    v_mfma_f32_16x16x32_bf16 v[28:31], v[192:195], v[200:203], v[28:31]
    ds_read_b64_tr_b16 v[158:159], v227 offset:5216
    ds_read_b64_tr_b16 v[160:161], v226 offset:128
    ds_read_b64_tr_b16 v[162:163], v226 offset:5248
    s_waitcnt lgkmcnt(11)
    v_mfma_f32_16x16x32_bf16 v[32:35], v[196:199], v[200:203], v[32:35]
    s_waitcnt lgkmcnt(8)
    v_mfma_f32_16x16x32_bf16 v[16:19], v[144:147], v[164:167], v[16:19]
    ds_read_b64_tr_b16 v[180:181], v226 offset:10240
    ds_read_b64_tr_b16 v[182:183], v226 offset:15360
    ds_read_b128 v[200:203], v222 offset:8192
    ds_read_b64_tr_b16 v[184:185], v227 offset:10272
    s_waitcnt lgkmcnt(10)
    v_mfma_f32_16x16x32_bf16 v[20:23], v[148:151], v[164:167], v[20:23]
    ds_read_b64_tr_b16 v[186:187], v227 offset:15392
    ds_read_b64_tr_b16 v[188:189], v226 offset:10304
    ds_read_b64_tr_b16 v[190:191], v226 offset:15424
    ds_read_b64_tr_b16 v[192:193], v227 offset:10336
    s_waitcnt lgkmcnt(12)
    v_mfma_f32_16x16x32_bf16 v[24:27], v[152:155], v[164:167], v[24:27]
    ds_read_b64_tr_b16 v[194:195], v227 offset:15456
    ds_read_b64_tr_b16 v[196:197], v226 offset:10368
    ds_read_b64_tr_b16 v[198:199], v226 offset:15488
    s_waitcnt lgkmcnt(13)
    v_mfma_f32_16x16x32_bf16 v[28:31], v[156:159], v[164:167], v[28:31]
    s_waitcnt lgkmcnt(11)
    v_mfma_f32_16x16x32_bf16 v[32:35], v[160:163], v[164:167], v[32:35]
    s_waitcnt lgkmcnt(8)
    v_mfma_f32_16x16x32_bf16 v[16:19], v[180:183], v[200:203], v[16:19]
    s_waitcnt lgkmcnt(6)
    v_mfma_f32_16x16x32_bf16 v[20:23], v[184:187], v[200:203], v[20:23]
    s_waitcnt lgkmcnt(4)
    v_mfma_f32_16x16x32_bf16 v[24:27], v[188:191], v[200:203], v[24:27]
    s_waitcnt lgkmcnt(2)
    v_mfma_f32_16x16x32_bf16 v[28:31], v[192:195], v[200:203], v[28:31]
    s_waitcnt lgkmcnt(0)
    v_mfma_f32_16x16x32_bf16 v[32:35], v[196:199], v[200:203], v[32:35]
    s_waitcnt vmcnt(0)
    s_mov_b32 s89, 0
L_px_c:
    v_cmp_ne_u32 vcc, 1, v228
    s_nop 0
    s_cbranch_vccz L_px_ok
    s_add_u32 s89, s89, 1
    s_cmp_gt_u32 s89, 0x40000
    s_cbranch_scc1 L_px_ok
    s_sleep 1
    buffer_load_dword v228, v240, s[20:23], s86 offen sc1
        s_waitcnt vmcnt(0)
    s_branch L_px_c
L_px_ok:
    buffer_load_dwordx4 v[96:99], v221, s[20:23], s92 offen offset:0 sc1
    buffer_load_dwordx4 v[100:103], v221, s[20:23], s92 offen offset:1024 sc1
    buffer_load_dwordx2 v[104:105], v241, s[20:23], s92 offen offset:2048 sc1
    buffer_load_dwordx4 v[108:111], v221, s[20:23], s93 offen offset:0 sc1
    buffer_load_dwordx4 v[112:115], v221, s[20:23], s93 offen offset:1024 sc1
    buffer_load_dwordx2 v[116:117], v241, s[20:23], s93 offen offset:2048 sc1
    buffer_load_dwordx4 v[120:123], v221, s[20:23], s94 offen offset:0 sc1
    buffer_load_dwordx4 v[124:127], v221, s[20:23], s94 offen offset:1024 sc1
    buffer_load_dwordx2 v[128:129], v241, s[20:23], s94 offen offset:2048 sc1
    s_waitcnt vmcnt(6)
    v_lshlrev_b32 v144, 16, v96
    v_and_b32 v145, 0xffff0000, v96
    v_pk_add_f32 v[16:17], v[16:17], v[144:145]
    v_lshlrev_b32 v146, 16, v97
    v_and_b32 v147, 0xffff0000, v97
    v_pk_add_f32 v[18:19], v[18:19], v[146:147]
    v_lshlrev_b32 v148, 16, v98
    v_and_b32 v149, 0xffff0000, v98
    v_pk_add_f32 v[20:21], v[20:21], v[148:149]
    v_lshlrev_b32 v150, 16, v99
    v_and_b32 v151, 0xffff0000, v99
    v_pk_add_f32 v[22:23], v[22:23], v[150:151]
    v_lshlrev_b32 v144, 16, v100
    v_and_b32 v145, 0xffff0000, v100
    v_pk_add_f32 v[24:25], v[24:25], v[144:145]
    v_lshlrev_b32 v146, 16, v101
    v_and_b32 v147, 0xffff0000, v101
    v_pk_add_f32 v[26:27], v[26:27], v[146:147]
    v_lshlrev_b32 v148, 16, v102
    v_and_b32 v149, 0xffff0000, v102
    v_pk_add_f32 v[28:29], v[28:29], v[148:149]
    v_lshlrev_b32 v150, 16, v103
    v_and_b32 v151, 0xffff0000, v103
    v_pk_add_f32 v[30:31], v[30:31], v[150:151]
    v_lshlrev_b32 v144, 16, v104
    v_and_b32 v145, 0xffff0000, v104
    v_pk_add_f32 v[32:33], v[32:33], v[144:145]
    v_lshlrev_b32 v146, 16, v105
    v_and_b32 v147, 0xffff0000, v105
    v_pk_add_f32 v[34:35], v[34:35], v[146:147]
    s_waitcnt vmcnt(3)
    v_lshlrev_b32 v144, 16, v108
    v_and_b32 v145, 0xffff0000, v108
    v_pk_add_f32 v[16:17], v[16:17], v[144:145]
    v_lshlrev_b32 v146, 16, v109
    v_and_b32 v147, 0xffff0000, v109
    v_pk_add_f32 v[18:19], v[18:19], v[146:147]
    v_lshlrev_b32 v148, 16, v110
    v_and_b32 v149, 0xffff0000, v110
    v_pk_add_f32 v[20:21], v[20:21], v[148:149]
    v_lshlrev_b32 v150, 16, v111
    v_and_b32 v151, 0xffff0000, v111
    v_pk_add_f32 v[22:23], v[22:23], v[150:151]
    v_lshlrev_b32 v144, 16, v112
    v_and_b32 v145, 0xffff0000, v112
    v_pk_add_f32 v[24:25], v[24:25], v[144:145]
    v_lshlrev_b32 v146, 16, v113
    v_and_b32 v147, 0xffff0000, v113
    v_pk_add_f32 v[26:27], v[26:27], v[146:147]
    v_lshlrev_b32 v148, 16, v114
    v_and_b32 v149, 0xffff0000, v114
    v_pk_add_f32 v[28:29], v[28:29], v[148:149]
    v_lshlrev_b32 v150, 16, v115
    v_and_b32 v151, 0xffff0000, v115
    v_pk_add_f32 v[30:31], v[30:31], v[150:151]
    v_lshlrev_b32 v144, 16, v116
    v_and_b32 v145, 0xffff0000, v116
    v_pk_add_f32 v[32:33], v[32:33], v[144:145]
    v_lshlrev_b32 v146, 16, v117
    v_and_b32 v147, 0xffff0000, v117
    v_pk_add_f32 v[34:35], v[34:35], v[146:147]
    s_waitcnt vmcnt(0)
    v_lshlrev_b32 v144, 16, v120
    v_and_b32 v145, 0xffff0000, v120
    v_pk_add_f32 v[16:17], v[16:17], v[144:145]
    v_lshlrev_b32 v146, 16, v121
    v_and_b32 v147, 0xffff0000, v121
    v_pk_add_f32 v[18:19], v[18:19], v[146:147]
    v_cvt_pk_bf16_f32 v132, v16, v17
    v_cvt_pk_bf16_f32 v133, v18, v19
    ds_write_b64 v233, v[132:133] offset:0
    v_lshlrev_b32 v148, 16, v122
    v_and_b32 v149, 0xffff0000, v122
    v_pk_add_f32 v[20:21], v[20:21], v[148:149]
    v_lshlrev_b32 v150, 16, v123
    v_and_b32 v151, 0xffff0000, v123
    v_pk_add_f32 v[22:23], v[22:23], v[150:151]
    v_cvt_pk_bf16_f32 v134, v20, v21
    v_cvt_pk_bf16_f32 v135, v22, v23
    ds_write_b64 v233, v[134:135] offset:32
    v_lshlrev_b32 v144, 16, v124
    v_and_b32 v145, 0xffff0000, v124
    v_pk_add_f32 v[24:25], v[24:25], v[144:145]
    v_lshlrev_b32 v146, 16, v125
    v_and_b32 v147, 0xffff0000, v125
    v_pk_add_f32 v[26:27], v[26:27], v[146:147]
    v_cvt_pk_bf16_f32 v136, v24, v25
    v_cvt_pk_bf16_f32 v137, v26, v27
    ds_write_b64 v233, v[136:137] offset:64
    v_lshlrev_b32 v148, 16, v126
    v_and_b32 v149, 0xffff0000, v126
    v_pk_add_f32 v[28:29], v[28:29], v[148:149]
    v_lshlrev_b32 v150, 16, v127
    v_and_b32 v151, 0xffff0000, v127
    v_pk_add_f32 v[30:31], v[30:31], v[150:151]
    v_cvt_pk_bf16_f32 v138, v28, v29
    v_cvt_pk_bf16_f32 v139, v30, v31
    ds_write_b64 v233, v[138:139] offset:96
    v_lshlrev_b32 v144, 16, v128
    v_and_b32 v145, 0xffff0000, v128
    v_pk_add_f32 v[32:33], v[32:33], v[144:145]
    v_lshlrev_b32 v146, 16, v129
    v_and_b32 v147, 0xffff0000, v129
    v_pk_add_f32 v[34:35], v[34:35], v[146:147]
    v_cvt_pk_bf16_f32 v140, v32, v33
    v_cvt_pk_bf16_f32 v141, v34, v35
    ds_write_b64 v233, v[140:141] offset:128
    s_waitcnt lgkmcnt(0)
    ds_read_b128 v[36:39], v234
    ds_read_b128 v[40:43], v235
    ds_read_b128 v[44:47], v236
    s_waitcnt lgkmcnt(2)
    buffer_store_dwordx4 v[36:39], v237, s[28:31], s3 offen
    s_waitcnt lgkmcnt(1)
    buffer_store_dwordx4 v[40:43], v238, s[28:31], s3 offen
    s_waitcnt lgkmcnt(0)
    s_mov_b32 exec_hi, 0
    buffer_store_dwordx4 v[44:47], v239, s[28:31], s3 offen
    s_mov_b64 exec, -1
    s_endpgm
L_tailB:
    v_exp_f32 v128, v128
    v_exp_f32 v129, v129
    v_exp_f32 v130, v130
    v_exp_f32 v131, v131
    v_cvt_pk_bf16_f32 v168, v128, v129
    v_exp_f32 v136, v136
    v_exp_f32 v137, v137
    v_cvt_pk_bf16_f32 v169, v130, v131
    v_exp_f32 v138, v138
    v_exp_f32 v139, v139
    v_cvt_pk_bf16_f32 v170, v136, v137
    v_exp_f32 v132, v132
    v_exp_f32 v133, v133
    v_cvt_pk_bf16_f32 v171, v138, v139
    v_exp_f32 v134, v134
    v_exp_f32 v135, v135
    v_cvt_pk_bf16_f32 v172, v132, v133
    v_exp_f32 v140, v140
    v_exp_f32 v141, v141
    v_cvt_pk_bf16_f32 v173, v134, v135
    v_exp_f32 v142, v142
    v_exp_f32 v143, v143
    v_cvt_pk_bf16_f32 v174, v140, v141
    v_cvt_pk_bf16_f32 v175, v142, v143
    v_mfma_f32_16x16x32_bf16 v[48:51], v[208:211], v[168:171], v[48:51]
    s_nop 0
    v_mfma_f32_16x16x32_bf16 v[52:55], v[208:211], v[172:175], v[52:55]
    v_mfma_f32_16x16x32_bf16 v[56:59], v[212:215], v[168:171], v[56:59]
    v_mfma_f32_16x16x32_bf16 v[60:63], v[212:215], v[172:175], v[60:63]
    v_mfma_f32_16x16x32_bf16 v[64:67], v[216:219], v[168:171], v[64:67]
    v_mfma_f32_16x16x32_bf16 v[68:71], v[216:219], v[172:175], v[68:71]
    v_mfma_f32_16x16x32_bf16 v[72:75], v[220:223], v[168:171], v[72:75]
    v_mfma_f32_16x16x32_bf16 v[76:79], v[220:223], v[172:175], v[76:79]
    v_mfma_f32_16x16x32_bf16 v[80:83], v[224:227], v[168:171], v[80:83]
    v_mfma_f32_16x16x32_bf16 v[84:87], v[224:227], v[172:175], v[84:87]
    v_mfma_f32_16x16x32_bf16 v[88:91], v[228:231], v[168:171], v[88:91]
    v_mfma_f32_16x16x32_bf16 v[92:95], v[228:231], v[172:175], v[92:95]
    v_mfma_f32_16x16x32_bf16 v[96:99], v[232:235], v[168:171], v[96:99]
    v_mfma_f32_16x16x32_bf16 v[100:103], v[232:235], v[172:175], v[100:103]
    v_mfma_f32_16x16x32_bf16 v[104:107], v[236:239], v[168:171], v[104:107]
    v_mfma_f32_16x16x32_bf16 v[108:111], v[236:239], v[172:175], v[108:111]
    v_mfma_f32_16x16x32_bf16 v[152:155], v[252:255], v[168:171], v[152:155]
    v_mfma_f32_16x16x32_bf16 v[156:159], v[252:255], v[172:175], v[156:159]
    s_nop 6
    v_rcp_f32 v176, v152
    v_rcp_f32 v178, v156
    v_lshlrev_b32 v10, 4, v11
    s_lshl_b32 s53, s38, 5
    s_add_u32 s53, s53, s54
    s_lshl_b32 s53, s53, 15
    s_lshl_b32 s87, s37, 11
    s_add_u32 s53, s53, s87
    v_mov_b32 v177, v176
    v_mov_b32 v179, v178
    v_pk_mul_f32 v[48:49], v[48:49], v[176:177]
    v_pk_mul_f32 v[50:51], v[50:51], v[176:177]
    v_pk_mul_f32 v[56:57], v[56:57], v[176:177]
    v_pk_mul_f32 v[58:59], v[58:59], v[176:177]
    v_cvt_pk_bf16_f32 v112, v48, v49
    v_cvt_pk_bf16_f32 v113, v50, v51
    v_cvt_pk_bf16_f32 v114, v56, v57
    v_cvt_pk_bf16_f32 v115, v58, v59
    s_add_u32 s51, s53, 0
    buffer_store_dwordx4 v[112:115], v10, s[20:23], s51 offen offset:0 sc1
    v_pk_mul_f32 v[52:53], v[52:53], v[178:179]
    v_pk_mul_f32 v[54:55], v[54:55], v[178:179]
    v_pk_mul_f32 v[60:61], v[60:61], v[178:179]
    v_pk_mul_f32 v[62:63], v[62:63], v[178:179]
    v_cvt_pk_bf16_f32 v116, v52, v53
    v_cvt_pk_bf16_f32 v117, v54, v55
    v_cvt_pk_bf16_f32 v118, v60, v61
    v_cvt_pk_bf16_f32 v119, v62, v63
    s_add_u32 s51, s53, 0
    buffer_store_dwordx4 v[116:119], v10, s[20:23], s51 offen offset:1024 sc1
    v_pk_mul_f32 v[64:65], v[64:65], v[176:177]
    v_pk_mul_f32 v[66:67], v[66:67], v[176:177]
    v_pk_mul_f32 v[72:73], v[72:73], v[176:177]
    v_pk_mul_f32 v[74:75], v[74:75], v[176:177]
    v_cvt_pk_bf16_f32 v120, v64, v65
    v_cvt_pk_bf16_f32 v121, v66, v67
    v_cvt_pk_bf16_f32 v122, v72, v73
    v_cvt_pk_bf16_f32 v123, v74, v75
    s_add_u32 s51, s53, 8192
    buffer_store_dwordx4 v[120:123], v10, s[20:23], s51 offen offset:0 sc1
    v_pk_mul_f32 v[68:69], v[68:69], v[178:179]
    v_pk_mul_f32 v[70:71], v[70:71], v[178:179]
    v_pk_mul_f32 v[76:77], v[76:77], v[178:179]
    v_pk_mul_f32 v[78:79], v[78:79], v[178:179]
    v_cvt_pk_bf16_f32 v124, v68, v69
    v_cvt_pk_bf16_f32 v125, v70, v71
    v_cvt_pk_bf16_f32 v126, v76, v77
    v_cvt_pk_bf16_f32 v127, v78, v79
    s_add_u32 s51, s53, 8192
    buffer_store_dwordx4 v[124:127], v10, s[20:23], s51 offen offset:1024 sc1
    v_pk_mul_f32 v[80:81], v[80:81], v[176:177]
    v_pk_mul_f32 v[82:83], v[82:83], v[176:177]
    v_pk_mul_f32 v[88:89], v[88:89], v[176:177]
    v_pk_mul_f32 v[90:91], v[90:91], v[176:177]
    v_cvt_pk_bf16_f32 v128, v80, v81
    v_cvt_pk_bf16_f32 v129, v82, v83
    v_cvt_pk_bf16_f32 v130, v88, v89
    v_cvt_pk_bf16_f32 v131, v90, v91
    v_pk_mul_f32 v[84:85], v[84:85], v[178:179]
    v_pk_mul_f32 v[86:87], v[86:87], v[178:179]
    v_pk_mul_f32 v[92:93], v[92:93], v[178:179]
    v_pk_mul_f32 v[94:95], v[94:95], v[178:179]
    v_cvt_pk_bf16_f32 v132, v84, v85
    v_cvt_pk_bf16_f32 v133, v86, v87
    v_cvt_pk_bf16_f32 v134, v92, v93
    v_cvt_pk_bf16_f32 v135, v94, v95
    v_pk_mul_f32 v[96:97], v[96:97], v[176:177]
    v_pk_mul_f32 v[98:99], v[98:99], v[176:177]
    v_pk_mul_f32 v[104:105], v[104:105], v[176:177]
    v_pk_mul_f32 v[106:107], v[106:107], v[176:177]
    v_cvt_pk_bf16_f32 v136, v96, v97
    v_cvt_pk_bf16_f32 v137, v98, v99
    v_cvt_pk_bf16_f32 v138, v104, v105
    v_cvt_pk_bf16_f32 v139, v106, v107
    v_pk_mul_f32 v[100:101], v[100:101], v[178:179]
    v_pk_mul_f32 v[102:103], v[102:103], v[178:179]
    v_pk_mul_f32 v[108:109], v[108:109], v[178:179]
    v_pk_mul_f32 v[110:111], v[110:111], v[178:179]
    v_cvt_pk_bf16_f32 v140, v100, v101
    v_cvt_pk_bf16_f32 v141, v102, v103
    v_cvt_pk_bf16_f32 v142, v108, v109
    v_cvt_pk_bf16_f32 v143, v110, v111
    s_barrier
    s_add_u32 s51, s53, 16384
    buffer_store_dwordx4 v[128:131], v10, s[20:23], s51 offen offset:0 sc1
    s_add_u32 s51, s53, 16384
    buffer_store_dwordx4 v[132:135], v10, s[20:23], s51 offen offset:1024 sc1
    s_add_u32 s51, s53, 24576
    buffer_store_dwordx4 v[136:139], v10, s[20:23], s51 offen offset:0 sc1
    s_add_u32 s51, s53, 24576
    buffer_store_dwordx4 v[140:143], v10, s[20:23], s51 offen offset:1024 sc1
    v_add_u32 v14, 0, v11
    v_mul_u32_u24 v15, 3277, v14
    v_lshrrev_b32 v15, 16, v15
    v_mul_u32_u24 v230, 20, v15
    v_sub_u32 v14, v14, v230
    v_bfe_u32 v230, v15, 2, 1
    v_lshlrev_b32 v230, 1, v230
    v_xor_b32 v14, v14, v230
    v_mul_u32_u24 v15, 1280, v15
    v_lshl_add_u32 v216, v14, 4, v15
    v_add_u32 v14, 64, v11
    v_mul_u32_u24 v15, 3277, v14
    v_lshrrev_b32 v15, 16, v15
    v_mul_u32_u24 v230, 20, v15
    v_sub_u32 v14, v14, v230
    v_bfe_u32 v230, v15, 2, 1
    v_lshlrev_b32 v230, 1, v230
    v_xor_b32 v14, v14, v230
    v_mul_u32_u24 v15, 1280, v15
    v_lshl_add_u32 v217, v14, 4, v15
    v_subrev_u32 v217, 1024, v217
    v_add_u32 v14, 128, v11
    v_mul_u32_u24 v15, 3277, v14
    v_lshrrev_b32 v15, 16, v15
    v_mul_u32_u24 v230, 20, v15
    v_sub_u32 v14, v14, v230
    v_bfe_u32 v230, v15, 2, 1
    v_lshlrev_b32 v230, 1, v230
    v_xor_b32 v14, v14, v230
    v_mul_u32_u24 v15, 1280, v15
    v_lshl_add_u32 v218, v14, 4, v15
    v_subrev_u32 v218, 2048, v218
    v_add_u32 v14, 192, v11
    v_mul_u32_u24 v15, 3277, v14
    v_lshrrev_b32 v15, 16, v15
    v_mul_u32_u24 v230, 20, v15
    v_sub_u32 v14, v14, v230
    v_bfe_u32 v230, v15, 2, 1
    v_lshlrev_b32 v230, 1, v230
    v_xor_b32 v14, v14, v230
    v_mul_u32_u24 v15, 1280, v15
    v_lshl_add_u32 v219, v14, 4, v15
    v_subrev_u32 v219, 3072, v219
    v_add_u32 v14, 256, v11
    v_mul_u32_u24 v15, 3277, v14
    v_lshrrev_b32 v15, 16, v15
    v_mul_u32_u24 v230, 20, v15
    v_sub_u32 v14, v14, v230
    v_bfe_u32 v230, v15, 2, 1
    v_lshlrev_b32 v230, 1, v230
    v_xor_b32 v14, v14, v230
    v_mul_u32_u24 v15, 1280, v15
    v_lshl_add_u32 v220, v14, 4, v15
    v_lshlrev_b32 v221, 4, v11
    s_lshl_b32 s83, s38, 2
    s_add_u32 s83, s83, s59
    s_mul_i32 s96, s83, 1280
    s_add_u32 s96, s96, 41943040
    s_lshl_b32 s83, s83, 18
    s_add_u32 s83, s83, s45
    s_lshl_b32 s84, s59, 6
    s_add_u32 s84, s84, s37
    s_mul_i32 s84, s84, 20480
    s_mul_i32 s51, s62, 320
    s_add_u32 s84, s84, s51
    s_mul_i32 s88, s37, 5120
    s_and_b32 s63, s38, 3
    s_lshl_b32 s51, s62, 1
    s_add_u32 s63, s63, s51
    s_add_u32 s63, s63, 2
    v_lshlrev_b32 v229, 2, v13
    s_add_u32 s96, s96, 81920
    s_barrier
    s_waitcnt vmcnt(0)
    v_mov_b32 v14, 1
    v_mov_b32 v15, 0
    s_mov_b64 s[90:91], exec
    s_mov_b64 exec, 1
    s_add_u32 s51, s85, 81920
    buffer_store_dword v14, v15, s[20:23], s51 offen sc1
    s_mov_b64 exec, s[90:91]
L_fob:
    s_barrier
    s_add_u32 s51, s63, 5
    s_and_b32 s51, s51, 7
    s_mul_i32 s51, s51, 81920
    s_add_u32 s51, s51, s84
    s_add_u32 m0, s88, 106496
    s_nop 0
    buffer_load_dwordx4 v216, s[24:27], s51 offen offset:0 lds
    buffer_load_dwordx4 v217, s[24:27], s51 offen offset:1024 lds
    buffer_load_dwordx4 v218, s[24:27], s51 offen offset:2048 lds
    buffer_load_dwordx4 v219, s[24:27], s51 offen offset:3072 lds
    s_add_u32 m0, s88, 110592
    s_nop 0
    buffer_load_dwordx4 v220, s[24:27], s51 offen lds
    s_add_u32 s52, s63, 5
    s_and_b32 s52, s52, 7
    s_lshl_b32 s52, s52, 14
    s_add_u32 s52, s52, s83
    s_add_u32 m0, s45, 0
    s_nop 0
    buffer_load_dwordx4 v221, s[20:23], s52 offen offset:0 sc1 lds
    buffer_load_dwordx4 v221, s[20:23], s52 offen offset:1024 sc1 lds
    buffer_load_dwordx4 v221, s[20:23], s52 offen offset:2048 sc1 lds
    buffer_load_dwordx4 v221, s[20:23], s52 offen offset:3072 sc1 lds
    s_barrier
    s_add_u32 s51, s63, 6
    s_and_b32 s51, s51, 7
    s_mul_i32 s51, s51, 81920
    s_add_u32 s51, s51, s84
    s_add_u32 m0, s88, 86016
    s_nop 0
    buffer_load_dwordx4 v216, s[24:27], s51 offen offset:0 lds
    buffer_load_dwordx4 v217, s[24:27], s51 offen offset:1024 lds
    buffer_load_dwordx4 v218, s[24:27], s51 offen offset:2048 lds
    buffer_load_dwordx4 v219, s[24:27], s51 offen offset:3072 lds
    s_add_u32 m0, s88, 90112
    s_nop 0
    buffer_load_dwordx4 v220, s[24:27], s51 offen lds
    s_add_u32 s52, s63, 6
    s_and_b32 s52, s52, 7
    s_lshl_b32 s52, s52, 14
    s_add_u32 s52, s52, s83
    s_add_u32 m0, s45, 16384
    s_nop 0
    buffer_load_dwordx4 v221, s[20:23], s52 offen offset:0 sc1 lds
    buffer_load_dwordx4 v221, s[20:23], s52 offen offset:1024 sc1 lds
    buffer_load_dwordx4 v221, s[20:23], s52 offen offset:2048 sc1 lds
    buffer_load_dwordx4 v221, s[20:23], s52 offen offset:3072 sc1 lds
    s_waitcnt vmcnt(9)
    s_barrier
    buffer_load_dword v228, v229, s[20:23], s96 offen sc1
    s_add_u32 s51, s63, 7
    s_and_b32 s51, s51, 7
    s_mul_i32 s51, s51, 81920
    s_add_u32 s51, s51, s84
    s_add_u32 m0, s88, 65536
    s_nop 0
    buffer_load_dwordx4 v216, s[24:27], s51 offen offset:0 lds
    buffer_load_dwordx4 v217, s[24:27], s51 offen offset:1024 lds
    buffer_load_dwordx4 v218, s[24:27], s51 offen offset:2048 lds
    buffer_load_dwordx4 v219, s[24:27], s51 offen offset:3072 lds
    s_add_u32 m0, s88, 69632
    s_nop 0
    buffer_load_dwordx4 v220, s[24:27], s51 offen lds
    s_add_u32 s52, s63, 7
    s_and_b32 s52, s52, 7
    s_lshl_b32 s52, s52, 14
    s_add_u32 s52, s52, s83
    s_add_u32 m0, s45, 32768
    s_nop 0
    buffer_load_dwordx4 v221, s[20:23], s52 offen offset:0 sc1 lds
    buffer_load_dwordx4 v221, s[20:23], s52 offen offset:1024 sc1 lds
    buffer_load_dwordx4 v221, s[20:23], s52 offen offset:2048 sc1 lds
    buffer_load_dwordx4 v221, s[20:23], s52 offen offset:3072 sc1 lds
    s_waitcnt vmcnt(10)
    s_barrier
    s_add_u32 s51, s63, 0
    s_and_b32 s51, s51, 7
    s_add_u32 s51, s51, 8
    s_mul_i32 s51, s51, 81920
    s_add_u32 s51, s51, s84
    s_add_u32 m0, s88, 126976
    s_nop 0
    buffer_load_dwordx4 v216, s[24:27], s51 offen offset:0 lds
    buffer_load_dwordx4 v217, s[24:27], s51 offen offset:1024 lds
    buffer_load_dwordx4 v218, s[24:27], s51 offen offset:2048 lds
    buffer_load_dwordx4 v219, s[24:27], s51 offen offset:3072 lds
    s_add_u32 m0, s88, 131072
    s_nop 0
    buffer_load_dwordx4 v220, s[24:27], s51 offen lds
    s_waitcnt vmcnt(14)
    s_mov_b32 s89, 0
L_pb_c:
    v_cmp_ne_u32 vcc, 1, v228
    s_nop 0
    s_cbranch_vccz L_pb_ok
    s_add_u32 s89, s89, 1
    s_cmp_gt_u32 s89, 0x40000
    s_cbranch_scc1 L_pb_ok
    s_sleep 4
    buffer_load_dword v228, v229, s[20:23], s96 offen sc1
        s_waitcnt vmcnt(0)
    s_branch L_pb_c
L_pb_ok:
    s_add_u32 s52, s63, 0
    s_and_b32 s52, s52, 7
    s_add_u32 s52, s52, 8
    s_lshl_b32 s52, s52, 14
    s_add_u32 s52, s52, s83
    s_add_u32 m0, s45, 147456
    s_nop 0
    buffer_load_dwordx4 v221, s[20:23], s52 offen offset:0 sc1 lds
    buffer_load_dwordx4 v221, s[20:23], s52 offen offset:1024 sc1 lds
    buffer_load_dwordx4 v221, s[20:23], s52 offen offset:2048 sc1 lds
    buffer_load_dwordx4 v221, s[20:23], s52 offen offset:3072 sc1 lds
    s_waitcnt vmcnt(9)
    s_barrier
    s_add_u32 s51, s63, 1
    s_and_b32 s51, s51, 7
    s_add_u32 s51, s51, 8
    s_mul_i32 s51, s51, 81920
    s_add_u32 s51, s51, s84
    s_add_u32 m0, s88, 106496
    s_nop 0
    buffer_load_dwordx4 v216, s[24:27], s51 offen offset:0 lds
    buffer_load_dwordx4 v217, s[24:27], s51 offen offset:1024 lds
    buffer_load_dwordx4 v218, s[24:27], s51 offen offset:2048 lds
    buffer_load_dwordx4 v219, s[24:27], s51 offen offset:3072 lds
    s_add_u32 m0, s88, 110592
    s_nop 0
    buffer_load_dwordx4 v220, s[24:27], s51 offen lds
    s_add_u32 s52, s63, 1
    s_and_b32 s52, s52, 7
    s_add_u32 s52, s52, 8
    s_lshl_b32 s52, s52, 14
    s_add_u32 s52, s52, s83
    s_add_u32 m0, s45, 0
    s_nop 0
    buffer_load_dwordx4 v221, s[20:23], s52 offen offset:0 sc1 lds
    buffer_load_dwordx4 v221, s[20:23], s52 offen offset:1024 sc1 lds
    buffer_load_dwordx4 v221, s[20:23], s52 offen offset:2048 sc1 lds
    buffer_load_dwordx4 v221, s[20:23], s52 offen offset:3072 sc1 lds
    s_waitcnt vmcnt(9)
    s_barrier
    s_add_u32 s51, s63, 2
    s_and_b32 s51, s51, 7
    s_add_u32 s51, s51, 8
    s_mul_i32 s51, s51, 81920
    s_add_u32 s51, s51, s84
    s_add_u32 m0, s88, 86016
    s_nop 0
    buffer_load_dwordx4 v216, s[24:27], s51 offen offset:0 lds
    buffer_load_dwordx4 v217, s[24:27], s51 offen offset:1024 lds
    buffer_load_dwordx4 v218, s[24:27], s51 offen offset:2048 lds
    buffer_load_dwordx4 v219, s[24:27], s51 offen offset:3072 lds
    s_add_u32 m0, s88, 90112
    s_nop 0
    buffer_load_dwordx4 v220, s[24:27], s51 offen lds
    s_add_u32 s52, s63, 2
    s_and_b32 s52, s52, 7
    s_add_u32 s52, s52, 8
    s_lshl_b32 s52, s52, 14
    s_add_u32 s52, s52, s83
    s_add_u32 m0, s45, 16384
    s_nop 0
    buffer_load_dwordx4 v221, s[20:23], s52 offen offset:0 sc1 lds
    buffer_load_dwordx4 v221, s[20:23], s52 offen offset:1024 sc1 lds
    buffer_load_dwordx4 v221, s[20:23], s52 offen offset:2048 sc1 lds
    buffer_load_dwordx4 v221, s[20:23], s52 offen offset:3072 sc1 lds
    s_waitcnt vmcnt(9)
    s_barrier
    s_add_u32 s51, s63, 3
    s_and_b32 s51, s51, 7
    s_add_u32 s51, s51, 8
    s_mul_i32 s51, s51, 81920
    s_add_u32 s51, s51, s84
    s_add_u32 m0, s88, 65536
    s_nop 0
    buffer_load_dwordx4 v216, s[24:27], s51 offen offset:0 lds
    buffer_load_dwordx4 v217, s[24:27], s51 offen offset:1024 lds
    buffer_load_dwordx4 v218, s[24:27], s51 offen offset:2048 lds
    buffer_load_dwordx4 v219, s[24:27], s51 offen offset:3072 lds
    s_add_u32 m0, s88, 69632
    s_nop 0
    buffer_load_dwordx4 v220, s[24:27], s51 offen lds
    s_add_u32 s52, s63, 3
    s_and_b32 s52, s52, 7
    s_add_u32 s52, s52, 8
    s_lshl_b32 s52, s52, 14
    s_add_u32 s52, s52, s83
    s_add_u32 m0, s45, 32768
    s_nop 0
    buffer_load_dwordx4 v221, s[20:23], s52 offen offset:0 sc1 lds
    buffer_load_dwordx4 v221, s[20:23], s52 offen offset:1024 sc1 lds
    buffer_load_dwordx4 v221, s[20:23], s52 offen offset:2048 sc1 lds
    buffer_load_dwordx4 v221, s[20:23], s52 offen offset:3072 sc1 lds
    s_waitcnt vmcnt(9)
    s_barrier
    s_add_u32 s51, s63, 4
    s_and_b32 s51, s51, 7
    s_add_u32 s51, s51, 8
    s_mul_i32 s51, s51, 81920
    s_add_u32 s51, s51, s84
    s_add_u32 m0, s88, 126976
    s_nop 0
    buffer_load_dwordx4 v216, s[24:27], s51 offen offset:0 lds
    buffer_load_dwordx4 v217, s[24:27], s51 offen offset:1024 lds
    buffer_load_dwordx4 v218, s[24:27], s51 offen offset:2048 lds
    buffer_load_dwordx4 v219, s[24:27], s51 offen offset:3072 lds
    s_add_u32 m0, s88, 131072
    s_nop 0
    buffer_load_dwordx4 v220, s[24:27], s51 offen lds
    s_add_u32 s52, s63, 4
    s_and_b32 s52, s52, 7
    s_add_u32 s52, s52, 8
    s_lshl_b32 s52, s52, 14
    s_add_u32 s52, s52, s83
    s_add_u32 m0, s45, 147456
    s_nop 0
    buffer_load_dwordx4 v221, s[20:23], s52 offen offset:0 sc1 lds
    buffer_load_dwordx4 v221, s[20:23], s52 offen offset:1024 sc1 lds
    buffer_load_dwordx4 v221, s[20:23], s52 offen offset:2048 sc1 lds
    buffer_load_dwordx4 v221, s[20:23], s52 offen offset:3072 sc1 lds
    s_waitcnt vmcnt(9)
    s_barrier
    s_add_u32 s51, s63, 5
    s_and_b32 s51, s51, 7
    s_add_u32 s51, s51, 8
    s_mul_i32 s51, s51, 81920
    s_add_u32 s51, s51, s84
    s_add_u32 m0, s88, 106496
    s_nop 0
    buffer_load_dwordx4 v216, s[24:27], s51 offen offset:0 lds
    buffer_load_dwordx4 v217, s[24:27], s51 offen offset:1024 lds
    buffer_load_dwordx4 v218, s[24:27], s51 offen offset:2048 lds
    buffer_load_dwordx4 v219, s[24:27], s51 offen offset:3072 lds
    s_add_u32 m0, s88, 110592
    s_nop 0
    buffer_load_dwordx4 v220, s[24:27], s51 offen lds
    s_add_u32 s52, s63, 5
    s_and_b32 s52, s52, 7
    s_add_u32 s52, s52, 8
    s_lshl_b32 s52, s52, 14
    s_add_u32 s52, s52, s83
    s_add_u32 m0, s45, 0
    s_nop 0
    buffer_load_dwordx4 v221, s[20:23], s52 offen offset:0 sc1 lds
    buffer_load_dwordx4 v221, s[20:23], s52 offen offset:1024 sc1 lds
    buffer_load_dwordx4 v221, s[20:23], s52 offen offset:2048 sc1 lds
    buffer_load_dwordx4 v221, s[20:23], s52 offen offset:3072 sc1 lds
    s_waitcnt vmcnt(9)
    s_barrier
    s_add_u32 s51, s63, 6
    s_and_b32 s51, s51, 7
    s_add_u32 s51, s51, 8
    s_mul_i32 s51, s51, 81920
    s_add_u32 s51, s51, s84
    s_add_u32 m0, s88, 86016
    s_nop 0
    buffer_load_dwordx4 v216, s[24:27], s51 offen offset:0 lds
    buffer_load_dwordx4 v217, s[24:27], s51 offen offset:1024 lds
    buffer_load_dwordx4 v218, s[24:27], s51 offen offset:2048 lds
    buffer_load_dwordx4 v219, s[24:27], s51 offen offset:3072 lds
    s_add_u32 m0, s88, 90112
    s_nop 0
    buffer_load_dwordx4 v220, s[24:27], s51 offen lds
    s_add_u32 s52, s63, 6
    s_and_b32 s52, s52, 7
    s_add_u32 s52, s52, 8
    s_lshl_b32 s52, s52, 14
    s_add_u32 s52, s52, s83
    s_add_u32 m0, s45, 16384
    s_nop 0
    buffer_load_dwordx4 v221, s[20:23], s52 offen offset:0 sc1 lds
    buffer_load_dwordx4 v221, s[20:23], s52 offen offset:1024 sc1 lds
    buffer_load_dwordx4 v221, s[20:23], s52 offen offset:2048 sc1 lds
    buffer_load_dwordx4 v221, s[20:23], s52 offen offset:3072 sc1 lds
    s_waitcnt vmcnt(9)
    s_barrier
    s_add_u32 s51, s63, 7
    s_and_b32 s51, s51, 7
    s_add_u32 s51, s51, 8
    s_mul_i32 s51, s51, 81920
    s_add_u32 s51, s51, s84
    s_add_u32 m0, s88, 65536
    s_nop 0
    buffer_load_dwordx4 v216, s[24:27], s51 offen offset:0 lds
    buffer_load_dwordx4 v217, s[24:27], s51 offen offset:1024 lds
    buffer_load_dwordx4 v218, s[24:27], s51 offen offset:2048 lds
    buffer_load_dwordx4 v219, s[24:27], s51 offen offset:3072 lds
    s_add_u32 m0, s88, 69632
    s_nop 0
    buffer_load_dwordx4 v220, s[24:27], s51 offen lds
    s_add_u32 s52, s63, 7
    s_and_b32 s52, s52, 7
    s_add_u32 s52, s52, 8
    s_lshl_b32 s52, s52, 14
    s_add_u32 s52, s52, s83
    s_add_u32 m0, s45, 32768
    s_nop 0
    buffer_load_dwordx4 v221, s[20:23], s52 offen offset:0 sc1 lds
    buffer_load_dwordx4 v221, s[20:23], s52 offen offset:1024 sc1 lds
    buffer_load_dwordx4 v221, s[20:23], s52 offen offset:2048 sc1 lds
    buffer_load_dwordx4 v221, s[20:23], s52 offen offset:3072 sc1 lds
    s_waitcnt vmcnt(9)
    s_barrier
    s_waitcnt vmcnt(0)
    s_barrier
L_end:
    s_endpgm
L_rare0:
    s_waitcnt lgkmcnt(0)
    s_nop 7
    v_max3_f32 v14, v112, v113, v114
    v_max3_f32 v14, v14, v115, v120
    v_max3_f32 v14, v14, v121, v122
    v_max_f32 v14, v14, v123
    v_mov_b32 v15, v14
    s_nop 1
    v_permlane32_swap_b32 v14, v15
    v_max_f32 v14, v14, v15
    v_mov_b32 v15, v14
    s_nop 1
    v_permlane16_swap_b32 v14, v15
    v_max_f32 v14, v14, v15
    v_ceil_f32 v14, v14
    v_max_f32 v14, s50, v14
    v_max_f32 v15, 0, v14
    v_min_f32 v15, 0x43800000, v15
    v_cvt_i32_f32 v15, v15
    v_sub_u32 v15, 0, v15
    v_ldexp_f32 v129, 1.0, v15
    v_sub_f32 v112, v112, v14
    v_sub_f32 v113, v113, v14
    v_sub_f32 v114, v114, v14
    v_sub_f32 v115, v115, v14
    v_sub_f32 v120, v120, v14
    v_sub_f32 v121, v121, v14
    v_sub_f32 v122, v122, v14
    v_sub_f32 v123, v123, v14
    v_sub_f32 v144, v144, v14
    v_sub_f32 v145, v145, v14
    v_sub_f32 v146, v146, v14
    v_sub_f32 v147, v147, v14
    v_max3_f32 v14, v116, v117, v118
    v_max3_f32 v14, v14, v119, v124
    v_max3_f32 v14, v14, v125, v126
    v_max_f32 v14, v14, v127
    v_mov_b32 v15, v14
    s_nop 1
    v_permlane32_swap_b32 v14, v15
    v_max_f32 v14, v14, v15
    v_mov_b32 v15, v14
    s_nop 1
    v_permlane16_swap_b32 v14, v15
    v_max_f32 v14, v14, v15
    v_ceil_f32 v14, v14
    v_max_f32 v14, s50, v14
    v_max_f32 v15, 0, v14
    v_min_f32 v15, 0x43800000, v15
    v_cvt_i32_f32 v15, v15
    v_sub_u32 v15, 0, v15
    v_ldexp_f32 v130, 1.0, v15
    v_sub_f32 v116, v116, v14
    v_sub_f32 v117, v117, v14
    v_sub_f32 v118, v118, v14
    v_sub_f32 v119, v119, v14
    v_sub_f32 v124, v124, v14
    v_sub_f32 v125, v125, v14
    v_sub_f32 v126, v126, v14
    v_sub_f32 v127, v127, v14
    v_sub_f32 v148, v148, v14
    v_sub_f32 v149, v149, v14
    v_sub_f32 v150, v150, v14
    v_sub_f32 v151, v151, v14
    s_cmp_lg_u32 s50, 0
    s_cbranch_scc1 L_rare0_done
    v_mul_f32 v152, v152, v129
    v_mul_f32 v153, v153, v129
    v_mul_f32 v154, v154, v129
    v_mul_f32 v155, v155, v129
    v_mul_f32 v48, v48, v129
    v_mul_f32 v49, v49, v129
    v_mul_f32 v50, v50, v129
    v_mul_f32 v51, v51, v129
    v_mul_f32 v56, v56, v129
    v_mul_f32 v57, v57, v129
    v_mul_f32 v58, v58, v129
    v_mul_f32 v59, v59, v129
    v_mul_f32 v64, v64, v129
    v_mul_f32 v65, v65, v129
    v_mul_f32 v66, v66, v129
    v_mul_f32 v67, v67, v129
    v_mul_f32 v72, v72, v129
    v_mul_f32 v73, v73, v129
    v_mul_f32 v74, v74, v129
    v_mul_f32 v75, v75, v129
    v_mul_f32 v80, v80, v129
    v_mul_f32 v81, v81, v129
    v_mul_f32 v82, v82, v129
    v_mul_f32 v83, v83, v129
    v_mul_f32 v88, v88, v129
    v_mul_f32 v89, v89, v129
    v_mul_f32 v90, v90, v129
    v_mul_f32 v91, v91, v129
    v_mul_f32 v96, v96, v129
    v_mul_f32 v97, v97, v129
    v_mul_f32 v98, v98, v129
    v_mul_f32 v99, v99, v129
    v_mul_f32 v104, v104, v129
    v_mul_f32 v105, v105, v129
    v_mul_f32 v106, v106, v129
    v_mul_f32 v107, v107, v129
    v_lshlrev_b32 v14, 16, v168
    v_and_b32 v128, 0xffff0000, v168
    v_mul_f32 v14, v14, v129
    v_mul_f32 v128, v128, v129
    v_cvt_pk_bf16_f32 v168, v14, v128
    v_lshlrev_b32 v14, 16, v169
    v_and_b32 v128, 0xffff0000, v169
    v_mul_f32 v14, v14, v129
    v_mul_f32 v128, v128, v129
    v_cvt_pk_bf16_f32 v169, v14, v128
    v_lshlrev_b32 v14, 16, v170
    v_and_b32 v128, 0xffff0000, v170
    v_mul_f32 v14, v14, v129
    v_mul_f32 v128, v128, v129
    v_cvt_pk_bf16_f32 v170, v14, v128
    v_lshlrev_b32 v14, 16, v171
    v_and_b32 v128, 0xffff0000, v171
    v_mul_f32 v14, v14, v129
    v_mul_f32 v128, v128, v129
    v_cvt_pk_bf16_f32 v171, v14, v128
    v_mul_f32 v156, v156, v130
    v_mul_f32 v157, v157, v130
    v_mul_f32 v158, v158, v130
    v_mul_f32 v159, v159, v130
    v_mul_f32 v52, v52, v130
    v_mul_f32 v53, v53, v130
    v_mul_f32 v54, v54, v130
    v_mul_f32 v55, v55, v130
    v_mul_f32 v60, v60, v130
    v_mul_f32 v61, v61, v130
    v_mul_f32 v62, v62, v130
    v_mul_f32 v63, v63, v130
    v_mul_f32 v68, v68, v130
    v_mul_f32 v69, v69, v130
    v_mul_f32 v70, v70, v130
    v_mul_f32 v71, v71, v130
    v_mul_f32 v76, v76, v130
    v_mul_f32 v77, v77, v130
    v_mul_f32 v78, v78, v130
    v_mul_f32 v79, v79, v130
    v_mul_f32 v84, v84, v130
    v_mul_f32 v85, v85, v130
    v_mul_f32 v86, v86, v130
    v_mul_f32 v87, v87, v130
    v_mul_f32 v92, v92, v130
    v_mul_f32 v93, v93, v130
    v_mul_f32 v94, v94, v130
    v_mul_f32 v95, v95, v130
    v_mul_f32 v100, v100, v130
    v_mul_f32 v101, v101, v130
    v_mul_f32 v102, v102, v130
    v_mul_f32 v103, v103, v130
    v_mul_f32 v108, v108, v130
    v_mul_f32 v109, v109, v130
    v_mul_f32 v110, v110, v130
    v_mul_f32 v111, v111, v130
    v_lshlrev_b32 v14, 16, v172
    v_and_b32 v128, 0xffff0000, v172
    v_mul_f32 v14, v14, v130
    v_mul_f32 v128, v128, v130
    v_cvt_pk_bf16_f32 v172, v14, v128
    v_lshlrev_b32 v14, 16, v173
    v_and_b32 v128, 0xffff0000, v173
    v_mul_f32 v14, v14, v130
    v_mul_f32 v128, v128, v130
    v_cvt_pk_bf16_f32 v173, v14, v128
    v_lshlrev_b32 v14, 16, v174
    v_and_b32 v128, 0xffff0000, v174
    v_mul_f32 v14, v14, v130
    v_mul_f32 v128, v128, v130
    v_cvt_pk_bf16_f32 v174, v14, v128
    v_lshlrev_b32 v14, 16, v175
    v_and_b32 v128, 0xffff0000, v175
    v_mul_f32 v14, v14, v130
    v_mul_f32 v128, v128, v130
    v_cvt_pk_bf16_f32 v175, v14, v128
L_rare0_done:
    s_mov_b32 s49, 0x41000000
    s_mov_b32 s50, 0
    s_branch L_back0
L_rare1:
    s_waitcnt lgkmcnt(0)
    s_nop 7
    v_max3_f32 v14, v128, v129, v130
    v_max3_f32 v14, v14, v131, v136
    v_max3_f32 v14, v14, v137, v138
    v_max_f32 v14, v14, v139
    v_mov_b32 v15, v14
    s_nop 1
    v_permlane32_swap_b32 v14, v15
    v_max_f32 v14, v14, v15
    v_mov_b32 v15, v14
    s_nop 1
    v_permlane16_swap_b32 v14, v15
    v_max_f32 v14, v14, v15
    v_ceil_f32 v14, v14
    v_max_f32 v14, s50, v14
    v_max_f32 v15, 0, v14
    v_min_f32 v15, 0x43800000, v15
    v_cvt_i32_f32 v15, v15
    v_sub_u32 v15, 0, v15
    v_ldexp_f32 v113, 1.0, v15
    v_sub_f32 v128, v128, v14
    v_sub_f32 v129, v129, v14
    v_sub_f32 v130, v130, v14
    v_sub_f32 v131, v131, v14
    v_sub_f32 v136, v136, v14
    v_sub_f32 v137, v137, v14
    v_sub_f32 v138, v138, v14
    v_sub_f32 v139, v139, v14
    v_sub_f32 v144, v144, v14
    v_sub_f32 v145, v145, v14
    v_sub_f32 v146, v146, v14
    v_sub_f32 v147, v147, v14
    v_max3_f32 v14, v132, v133, v134
    v_max3_f32 v14, v14, v135, v140
    v_max3_f32 v14, v14, v141, v142
    v_max_f32 v14, v14, v143
    v_mov_b32 v15, v14
    s_nop 1
    v_permlane32_swap_b32 v14, v15
    v_max_f32 v14, v14, v15
    v_mov_b32 v15, v14
    s_nop 1
    v_permlane16_swap_b32 v14, v15
    v_max_f32 v14, v14, v15
    v_ceil_f32 v14, v14
    v_max_f32 v14, s50, v14
    v_max_f32 v15, 0, v14
    v_min_f32 v15, 0x43800000, v15
    v_cvt_i32_f32 v15, v15
    v_sub_u32 v15, 0, v15
    v_ldexp_f32 v114, 1.0, v15
    v_sub_f32 v132, v132, v14
    v_sub_f32 v133, v133, v14
    v_sub_f32 v134, v134, v14
    v_sub_f32 v135, v135, v14
    v_sub_f32 v140, v140, v14
    v_sub_f32 v141, v141, v14
    v_sub_f32 v142, v142, v14
    v_sub_f32 v143, v143, v14
    v_sub_f32 v148, v148, v14
    v_sub_f32 v149, v149, v14
    v_sub_f32 v150, v150, v14
    v_sub_f32 v151, v151, v14
    v_mul_f32 v152, v152, v113
    v_mul_f32 v153, v153, v113
    v_mul_f32 v154, v154, v113
    v_mul_f32 v155, v155, v113
    v_mul_f32 v48, v48, v113
    v_mul_f32 v49, v49, v113
    v_mul_f32 v50, v50, v113
    v_mul_f32 v51, v51, v113
    v_mul_f32 v56, v56, v113
    v_mul_f32 v57, v57, v113
    v_mul_f32 v58, v58, v113
    v_mul_f32 v59, v59, v113
    v_mul_f32 v64, v64, v113
    v_mul_f32 v65, v65, v113
    v_mul_f32 v66, v66, v113
    v_mul_f32 v67, v67, v113
    v_mul_f32 v72, v72, v113
    v_mul_f32 v73, v73, v113
    v_mul_f32 v74, v74, v113
    v_mul_f32 v75, v75, v113
    v_mul_f32 v80, v80, v113
    v_mul_f32 v81, v81, v113
    v_mul_f32 v82, v82, v113
    v_mul_f32 v83, v83, v113
    v_mul_f32 v88, v88, v113
    v_mul_f32 v89, v89, v113
    v_mul_f32 v90, v90, v113
    v_mul_f32 v91, v91, v113
    v_mul_f32 v96, v96, v113
    v_mul_f32 v97, v97, v113
    v_mul_f32 v98, v98, v113
    v_mul_f32 v99, v99, v113
    v_mul_f32 v104, v104, v113
    v_mul_f32 v105, v105, v113
    v_mul_f32 v106, v106, v113
    v_mul_f32 v107, v107, v113
    v_lshlrev_b32 v14, 16, v160
    v_and_b32 v112, 0xffff0000, v160
    v_mul_f32 v14, v14, v113
    v_mul_f32 v112, v112, v113
    v_cvt_pk_bf16_f32 v160, v14, v112
    v_lshlrev_b32 v14, 16, v161
    v_and_b32 v112, 0xffff0000, v161
    v_mul_f32 v14, v14, v113
    v_mul_f32 v112, v112, v113
    v_cvt_pk_bf16_f32 v161, v14, v112
    v_lshlrev_b32 v14, 16, v162
    v_and_b32 v112, 0xffff0000, v162
    v_mul_f32 v14, v14, v113
    v_mul_f32 v112, v112, v113
    v_cvt_pk_bf16_f32 v162, v14, v112
    v_lshlrev_b32 v14, 16, v163
    v_and_b32 v112, 0xffff0000, v163
    v_mul_f32 v14, v14, v113
    v_mul_f32 v112, v112, v113
    v_cvt_pk_bf16_f32 v163, v14, v112
    v_mul_f32 v156, v156, v114
    v_mul_f32 v157, v157, v114
    v_mul_f32 v158, v158, v114
    v_mul_f32 v159, v159, v114
    v_mul_f32 v52, v52, v114
    v_mul_f32 v53, v53, v114
    v_mul_f32 v54, v54, v114
    v_mul_f32 v55, v55, v114
    v_mul_f32 v60, v60, v114
    v_mul_f32 v61, v61, v114
    v_mul_f32 v62, v62, v114
    v_mul_f32 v63, v63, v114
    v_mul_f32 v68, v68, v114
    v_mul_f32 v69, v69, v114
    v_mul_f32 v70, v70, v114
    v_mul_f32 v71, v71, v114
    v_mul_f32 v76, v76, v114
    v_mul_f32 v77, v77, v114
    v_mul_f32 v78, v78, v114
    v_mul_f32 v79, v79, v114
    v_mul_f32 v84, v84, v114
    v_mul_f32 v85, v85, v114
    v_mul_f32 v86, v86, v114
    v_mul_f32 v87, v87, v114
    v_mul_f32 v92, v92, v114
    v_mul_f32 v93, v93, v114
    v_mul_f32 v94, v94, v114
    v_mul_f32 v95, v95, v114
    v_mul_f32 v100, v100, v114
    v_mul_f32 v101, v101, v114
    v_mul_f32 v102, v102, v114
    v_mul_f32 v103, v103, v114
    v_mul_f32 v108, v108, v114
    v_mul_f32 v109, v109, v114
    v_mul_f32 v110, v110, v114
    v_mul_f32 v111, v111, v114
    v_lshlrev_b32 v14, 16, v164
    v_and_b32 v112, 0xffff0000, v164
    v_mul_f32 v14, v14, v114
    v_mul_f32 v112, v112, v114
    v_cvt_pk_bf16_f32 v164, v14, v112
    v_lshlrev_b32 v14, 16, v165
    v_and_b32 v112, 0xffff0000, v165
    v_mul_f32 v14, v14, v114
    v_mul_f32 v112, v112, v114
    v_cvt_pk_bf16_f32 v165, v14, v112
    v_lshlrev_b32 v14, 16, v166
    v_and_b32 v112, 0xffff0000, v166
    v_mul_f32 v14, v14, v114
    v_mul_f32 v112, v112, v114
    v_cvt_pk_bf16_f32 v166, v14, v112
    v_lshlrev_b32 v14, 16, v167
    v_and_b32 v112, 0xffff0000, v167
    v_mul_f32 v14, v14, v114
    v_mul_f32 v112, v112, v114
    v_cvt_pk_bf16_f32 v167, v14, v112
    s_mov_b32 s49, 0x41000000
    s_mov_b32 s50, 0
    s_branch L_back1
L_codeend:
.section .rodata,"a"
.p2align 6
.amdhsa_kernel standalone__gqa_block_cached__near_ridge_kernel
  .amdhsa_next_free_vgpr 256
  .amdhsa_next_free_sgpr 102
  .amdhsa_accum_offset 256
  .amdhsa_group_segment_fixed_size 0
  .amdhsa_kernarg_size 64
  .amdhsa_user_sgpr_count 2
  .amdhsa_user_sgpr_kernarg_segment_ptr 1
  .amdhsa_system_sgpr_workgroup_id_x 1
  .amdhsa_float_denorm_mode_32 3
.end_amdhsa_kernel
```
